```python
import torch

def _softmax(x, axis=-1):
    return torch.softmax(x, dim=axis)
def _gelu(x):
    return torch.nn.functional.gelu(x, approximate="tanh")
def _silu(x):
    return torch.nn.functional.silu(x)
def _sigmoid(x):
    return torch.sigmoid(x)
def _layernorm(x, axis=-1, eps=1e-5):
    m = x.mean(dim=axis, keepdim=True)
    v = x.var(dim=axis, keepdim=True, unbiased=False)
    return (x - m) / torch.sqrt(v + eps)
def _scatter_add(tgt, idx, src, axis=0):
    return tgt.clone().index_add_(axis, idx, src)
def _segment_sum(src, seg, n):
    out = torch.zeros((n,) + src.shape[1:], dtype=src.dtype)
    return out.index_add_(0, seg, src)
def _pad(x, pw):
    flat = tuple(v for pair in reversed(pw) for v in pair)
    return torch.nn.functional.pad(x, flat)

kernel_name = 'interleave_layers__softmax_full_mha__mixer_s_mlp__prompt'

def setup_inputs():

    _w = (lambda a: (lambda t: t.to(torch.bfloat16) if t.is_floating_point() else t)(torch.as_tensor(a)))
    def _A_setup():
        B, S, D = 1, 2048, 448
        return {
            "x": _w((lambda *s: torch.randn(*s, dtype=torch.bfloat16) * 0.05)(B, S, D)),
            "wqkv": _w((lambda *s: torch.randn(*s, dtype=torch.bfloat16) * 0.05)(D, 3 * D)),
            "wo": _w((lambda *s: torch.randn(*s, dtype=torch.bfloat16) * 0.05)(D, D)),
        }
    _A_in = _A_setup()

    def _B_setup():
        B, S, D, F = 1, 2048, 448, 1792
        return {
            "x":  _w((lambda *s: torch.randn(*s, dtype=torch.bfloat16) * 0.05)(B, S, D)),
            "w1": _w((lambda *s: torch.randn(*s, dtype=torch.bfloat16) * 0.8)(D, D) * (D ** -0.5)),
            "w2": _w((lambda *s: torch.randn(*s, dtype=torch.bfloat16) * 0.8)(D, D) * (D ** -0.5)),
            "w3": _w((lambda *s: torch.randn(*s, dtype=torch.bfloat16) * 0.8)(D, F) * (D ** -0.5)),
            "w4": _w((lambda *s: torch.randn(*s, dtype=torch.bfloat16) * 0.8)(F, D) * (F ** -0.5)),
        }
    _B_in = _B_setup()

    return {
        "A_x": _A_in["x"],
        "A_wqkv": _A_in["wqkv"],
        "A_wo": _A_in["wo"],
        "B_x": _B_in["x"],
        "B_w1": _B_in["w1"],
        "B_w2": _B_in["w2"],
        "B_w3": _B_in["w3"],
        "B_w4": _B_in["w4"],
    }

def reference(A_x, A_wqkv, A_wo, B_x, B_w1, B_w2, B_w3, B_w4):
    def _A_ref(x, wqkv, wo):
        B, S, D = x.shape
        H = 16; Dh = D // H
        qkv = (lambda x, *d: x.permute(*d))((x @ wqkv).reshape(B, S, 3, H, Dh), 2, 0, 3, 1, 4)
        q, k, v = qkv[0], qkv[1], qkv[2]
        scale = Dh ** -0.5
        scores = torch.einsum("bhqd,bhkd->bhqk", q, k) * scale
        p = _softmax(scores, axis=-1)
        o = torch.einsum("bhqk,bhkd->bhqd", p, v)
        return (lambda x, *d: x.permute(*d))(o, 0, 2, 1, 3).reshape(B, S, D) @ wo

    def _B_ref(x, w1, w2, w3, w4):
        B, S, D = x.shape
        h = _gelu(_layernorm(x, axis=-1) @ w1)
        c = D // 4
        g0 = _pad(h[:, :, 0*c:1*c], ((0, 0), (1, 0), (0, 0)))[:, :S, :]
        g1 = _pad(h[:, :, 1*c:2*c], ((0, 0), (0, 1), (0, 0)))[:, 1:, :]
        g2 = _pad(h[:, :, 2*c:3*c], ((0, 0), (2, 0), (0, 0)))[:, :S, :]
        g3 = _pad(h[:, :, 3*c:   ], ((0, 0), (0, 2), (0, 0)))[:, 2:, :]
        hs = torch.concatenate([g0, g1, g2, g3], axis=-1) @ w2
        x1 = x + hs
        h2 = _gelu(_layernorm(x1, axis=-1) @ w3) @ w4
        return x1 + h2

    x = A_x
    x = x + _A_ref(_layernorm(x, axis=-1), A_wqkv, A_wo)
    x = x + _B_ref(_layernorm(x, axis=-1), B_w1, B_w2, B_w3, B_w4)
    x = x + _A_ref(_layernorm(x, axis=-1), A_wqkv, A_wo)
    x = x + _B_ref(_layernorm(x, axis=-1), B_w1, B_w2, B_w3, B_w4)
    return x
```

```asm
; @launch grid=(256,1,1) block=(256,1,1) lds=163840
.amdgcn_target "amdgcn-amd-amdhsa--gfx950"
.text
.globl interleave_layers__softmax_full_mha__mixer_s_mlp__prompt_kernel
.p2align 8
.type interleave_layers__softmax_full_mha__mixer_s_mlp__prompt_kernel,@function
interleave_layers__softmax_full_mha__mixer_s_mlp__prompt_kernel:
    s_cmp_ge_u32 s2, 256
    s_cbranch_scc1 L_exit
    s_load_dwordx2 s[4:5], s[0:1], 0
    s_load_dwordx2 s[40:41], s[0:1], 80
    s_load_dwordx2 s[8:9], s[0:1], 8
    s_load_dwordx2 s[36:37], s[0:1], 72
    s_load_dwordx2 s[12:13], s[0:1], 16
    s_load_dwordx2 s[16:17], s[0:1], 32
    s_load_dwordx2 s[20:21], s[0:1], 40
    s_load_dwordx2 s[24:25], s[0:1], 48
    s_load_dwordx2 s[28:29], s[0:1], 56
    s_load_dwordx2 s[32:33], s[0:1], 64
    s_lshr_b32 s46, s2, 3
    v_lshrrev_b32 v10, 6, v0
    v_and_b32 v1, 63, v0
    v_readfirstlane_b32 s44, v10
    s_lshr_b32 s73, s2, 6
    s_lshl_b32 s73, s73, 2
    s_or_b32 s73, s73, s44
    s_cmp_eq_u32 s73, 3
    s_cbranch_scc1 L_nopf
    s_getpc_b64 s[96:97]
L_pc:
    s_lshl_b32 s72, s46, 11
    v_lshl_add_u32 v250, v0, 3, s72
    s_mov_b32 s72, L_exit-L_pc-8
    v_min_u32 v250, s72, v250
    v_mov_b32 v251, s97
    v_add_co_u32 v250, vcc, s96, v250
    s_nop 1
    v_addc_co_u32 v251, vcc, 0, v251, vcc
    global_load_dwordx2 v[248:249], v[250:251], off
L_nopf:
    s_and_b32 s45, s2, 7
    s_lshr_b32 s72, s46, 4
    s_lshl_b32 s73, s45, 1
    s_add_u32 s51, s72, s73
    s_lshl_b32 s49, s51, 2
    s_add_u32 s49, s49, s44
    v_lshrrev_b32 v253, 2, v1
    v_mul_u32_u24 v253, 896, v253
    v_lshrrev_b32 v15, 4, v1
    v_xor_b32 v15, v15, v1
    v_and_b32 v15, 3, v15
    v_lshlrev_b32 v15, 4, v15
    v_add_u32 v253, v253, v15
    s_mul_i32 s74, s49, 28672
    s_mul_i32 s78, s44, 28672
    s_cmp_eq_u32 s44, 2
    s_cselect_b32 s78, 86016, s78
    s_cmp_eq_u32 s44, 3
    s_cselect_b32 s78, 135168, s78
    s_and_b32 s76, s46, 15
    s_mul_i32 s77, s76, 37
    s_lshr_b32 s77, s77, 8
    s_mul_i32 s77, s77, 7
    s_sub_u32 s76, s76, s77
    s_mul_i32 s76, s76, 1
    s_lshl_b32 s77, s76, 7
    s_add_u32 s77, s77, s74
    s_lshl_b32 s76, s76, 12
    s_add_u32 m0, s78, s76
    s_add_u32 s99, s77, 13312
    s_add_u32 s100, s77, 64
    s_add_u32 s101, s77, 13376
    s_mov_b32 s6, 1835008
    s_mov_b32 s7, 0x20000
    s_mov_b32 s10, 1204224
    s_mov_b32 s11, 0x20000
    s_mov_b32 s14, 401408
    s_mov_b32 s15, 0x20000
    s_mov_b32 s18, 401408
    s_mov_b32 s19, 0x20000
    s_mov_b32 s22, 401408
    s_mov_b32 s23, 0x20000
    s_mov_b32 s26, 1605632
    s_mov_b32 s27, 0x20000
    s_mov_b32 s30, 1605632
    s_mov_b32 s31, 0x20000
    s_mov_b32 s34, 1835008
    s_mov_b32 s35, 0x20000
    s_mov_b32 s38, 256
    s_mov_b32 s39, 0x20000
    s_mov_b32 s42, 142606336
    s_mov_b32 s43, 0x20000
    v_lshlrev_b32 v2, 4, v1
    v_lshlrev_b32 v3, 2, v1
    s_and_b32 s50, s46, 15
    s_waitcnt lgkmcnt(0)
    s_cmp_lg_u32 s44, 3
    s_cbranch_scc1 L_init_1
    v_mov_b32 v244, 0
    v_mov_b32 v245, 0
    v_mov_b32 v246, 0
    v_mov_b32 v247, 0
    s_lshl_b32 s72, s46, 14
    s_lshl_b32 s73, s45, 10
    s_add_u32 s72, s72, s73
    s_and_b32 s73, s46, 1
    s_lshl_b32 s73, s73, 13
    s_add_u32 s72, s72, s73
    s_xor_b32 s73, s72, 0x2000
    s_mov_b32 s67, 0
    s_cmp_lt_u32 s2, 64
    s_cbranch_scc1 L_init_1_t
    buffer_store_dwordx4 v[244:247], v2, s[40:43], s72 offen sc1
    buffer_store_dwordx4 v[244:247], v2, s[40:43], s73 offen sc1
    s_branch L_init_1_n
.p2align 6
L_init_1_t:
    buffer_store_dwordx4 v[244:247], v2, s[40:43], s72 offen sc1
    buffer_store_dwordx4 v[244:247], v2, s[40:43], s73 offen sc1
    s_waitcnt vmcnt(1)
    s_memtime s[96:97]
    s_waitcnt vmcnt(0)
    s_memtime s[86:87]
    s_getreg_b32 s72, hwreg(HW_REG_XCC_ID, 2, 1)
    s_xor_b32 s72, s72, s46
    s_and_b32 s72, s72, 1
    s_cselect_b32 s67, 8, 0x80
    s_waitcnt lgkmcnt(0)
    s_sub_u32 s86, s86, s96
    s_cmp_gt_u32 s86, 130
    s_cselect_b32 s67, s67, 0
    s_getpc_b64 s[96:97]
L_pc_2:
    s_sub_u32 s96, s96, L_pc_2-L_pc
    s_subb_u32 s97, s97, 0
    s_lshl_b32 s72, s46, 2
    s_add_u32 s72, s72, s44
    s_lshl_b32 s72, s72, 9
    v_lshl_add_u32 v250, v1, 3, s72
    s_mov_b32 s72, L_exit-L_pc-8
    v_min_u32 v250, s72, v250
    v_mov_b32 v251, s97
    v_add_co_u32 v250, vcc, s96, v250
    s_nop 1
    v_addc_co_u32 v251, vcc, 0, v251, vcc
    global_load_dwordx2 v[248:249], v[250:251], off
L_init_1_n:
    s_mov_b64 exec, -1
L_init_1:
    buffer_load_dwordx4 v253, s[4:7], s77 offen offset:0 lds
    buffer_load_dwordx4 v253, s[4:7], s99 offen offset:1024 lds
    s_add_u32 m0, m0, 2048
    s_nop 0
    buffer_load_dwordx4 v253, s[4:7], s100 offen offset:0 lds
    buffer_load_dwordx4 v253, s[4:7], s101 offen offset:1024 lds
    s_add_u32 s77, s77, 128
    s_add_u32 s76, s76, 4096
    s_cmp_eq_u32 s76, 28672
    s_cselect_b32 s76, 0, s76
    s_cselect_b32 s77, s74, s77
    s_add_u32 m0, s78, s76
    s_add_u32 s99, s77, 13312
    s_add_u32 s100, s77, 64
    s_add_u32 s101, s77, 13376
    buffer_load_dwordx4 v253, s[4:7], s77 offen offset:0 lds
    buffer_load_dwordx4 v253, s[4:7], s99 offen offset:1024 lds
    s_add_u32 m0, m0, 2048
    s_nop 0
    buffer_load_dwordx4 v253, s[4:7], s100 offen offset:0 lds
    buffer_load_dwordx4 v253, s[4:7], s101 offen offset:1024 lds
    s_add_u32 s77, s77, 128
    s_add_u32 s76, s76, 4096
    s_cmp_eq_u32 s76, 28672
    s_cselect_b32 s76, 0, s76
    s_cselect_b32 s77, s74, s77
    s_add_u32 m0, s78, s76
    s_add_u32 s99, s77, 13312
    s_add_u32 s100, s77, 64
    s_add_u32 s101, s77, 13376
    buffer_load_dwordx4 v253, s[4:7], s77 offen offset:0 lds
    buffer_load_dwordx4 v253, s[4:7], s99 offen offset:1024 lds
    s_add_u32 m0, m0, 2048
    s_nop 0
    buffer_load_dwordx4 v253, s[4:7], s100 offen offset:0 lds
    buffer_load_dwordx4 v253, s[4:7], s101 offen offset:1024 lds
    s_add_u32 s77, s77, 128
    s_add_u32 s76, s76, 4096
    s_cmp_eq_u32 s76, 28672
    s_cselect_b32 s76, 0, s76
    s_cselect_b32 s77, s74, s77
    s_add_u32 m0, s78, s76
    s_add_u32 s99, s77, 13312
    s_add_u32 s100, s77, 64
    s_add_u32 s101, s77, 13376
    buffer_load_dwordx4 v253, s[4:7], s77 offen offset:0 lds
    buffer_load_dwordx4 v253, s[4:7], s99 offen offset:1024 lds
    s_add_u32 m0, m0, 2048
    s_nop 0
    buffer_load_dwordx4 v253, s[4:7], s100 offen offset:0 lds
    buffer_load_dwordx4 v253, s[4:7], s101 offen offset:1024 lds
    s_add_u32 s77, s77, 128
    s_add_u32 s76, s76, 4096
    s_cmp_eq_u32 s76, 28672
    s_cselect_b32 s76, 0, s76
    s_cselect_b32 s77, s74, s77
    s_add_u32 m0, s78, s76
    s_add_u32 s99, s77, 13312
    s_add_u32 s100, s77, 64
    s_add_u32 s101, s77, 13376
    buffer_load_dwordx4 v253, s[4:7], s77 offen offset:0 lds
    buffer_load_dwordx4 v253, s[4:7], s99 offen offset:1024 lds
    s_add_u32 m0, m0, 2048
    s_nop 0
    buffer_load_dwordx4 v253, s[4:7], s100 offen offset:0 lds
    buffer_load_dwordx4 v253, s[4:7], s101 offen offset:1024 lds
    s_add_u32 s77, s77, 128
    s_add_u32 s76, s76, 4096
    s_cmp_eq_u32 s76, 28672
    s_cselect_b32 s76, 0, s76
    s_cselect_b32 s77, s74, s77
    s_add_u32 m0, s78, s76
    s_add_u32 s99, s77, 13312
    s_add_u32 s100, s77, 64
    s_add_u32 s101, s77, 13376
    buffer_load_dwordx4 v253, s[4:7], s77 offen offset:0 lds
    buffer_load_dwordx4 v253, s[4:7], s99 offen offset:1024 lds
    s_add_u32 m0, m0, 2048
    s_nop 0
    buffer_load_dwordx4 v253, s[4:7], s100 offen offset:0 lds
    buffer_load_dwordx4 v253, s[4:7], s101 offen offset:1024 lds
    s_add_u32 s77, s77, 128
    s_add_u32 s76, s76, 4096
    s_cmp_eq_u32 s76, 28672
    s_cselect_b32 s76, 0, s76
    s_cselect_b32 s77, s74, s77
    s_add_u32 m0, s78, s76
    s_add_u32 s99, s77, 13312
    s_add_u32 s100, s77, 64
    s_add_u32 s101, s77, 13376
    buffer_load_dwordx4 v253, s[4:7], s77 offen offset:0 lds
    buffer_load_dwordx4 v253, s[4:7], s99 offen offset:1024 lds
    s_add_u32 m0, m0, 2048
    s_nop 0
    buffer_load_dwordx4 v253, s[4:7], s100 offen offset:0 lds
    buffer_load_dwordx4 v253, s[4:7], s101 offen offset:1024 lds
    v_lshrrev_b32 v252, 2, v1
    v_mul_u32_u24 v252, 2688, v252
    v_and_b32 v15, 3, v1
    v_lshlrev_b32 v15, 4, v15
    v_add_u32 v252, v252, v15
    s_mul_i32 s100, s50, 56
    s_lshr_b32 s76, s44, 1
    s_and_b32 s77, s44, 1
    s_mul_i32 s98, s76, 43008
    s_mul_i32 s99, s77, 896
    s_add_u32 s98, s98, s99
    s_add_u32 s98, s98, s100
    s_add_u32 s98, s98, 896
    s_lshl_b32 s99, s76, 10
    s_mul_i32 s77, s77, 57344
    s_add_u32 s99, s99, s77
    s_add_u32 s99, s99, 57344
    s_mul_i32 s76, s44, 43008
    s_add_u32 s100, s100, s76
    s_lshl_b32 s101, s44, 10
    s_add_u32 s101, s101, 86016
    s_mul_i32 s76, s51, 7
    s_lshr_b32 s76, s76, 3
    s_sub_u32 s79, 14, s76
    s_mul_i32 s75, s76, 86016
    s_add_u32 s75, s75, s98
    s_lshl_b32 s77, s76, 11
    s_add_u32 m0, s77, s99
    s_lshr_b32 s76, s76, 1
    s_sub_u32 s62, 7, s76
    s_mov_b32 s47, 0
    s_mov_b32 s48, 4194304
    v_bfe_u32 v5, v1, 2, 2
    v_lshlrev_b32 v5, 6, v5
    v_bfe_u32 v10, v1, 4, 1
    v_lshlrev_b32 v10, 5, v10
    v_add_u32 v5, v5, v10
    v_and_b32 v10, 3, v1
    v_lshlrev_b32 v10, 3, v10
    v_add_u32 v5, v5, v10
    v_lshrrev_b32 v10, 5, v1
    v_lshlrev_b32 v10, 9, v10
    v_add_u32 v4, v5, v10
    v_lshrrev_b32 v6, 5, v1
    v_lshlrev_b32 v6, 2, v6
    v_bfe_u32 v15, v1, 2, 2
    v_add_u32 v6, v6, v15
    v_mul_u32_u24 v6, 896, v6
    v_bfe_u32 v15, v1, 4, 1
    v_lshlrev_b32 v15, 6, v15
    v_add_u32 v6, v6, v15
    v_and_b32 v15, 3, v1
    v_lshlrev_b32 v15, 4, v15
    v_add_u32 v6, v6, v15
    s_mov_b32 s82, 0
    s_mov_b32 s83, -1
    s_mov_b32 s84, 0xf0000000
    s_mov_b32 s85, 0xf0000000
    s_mov_b32 s88, 0x3f803f80
    s_mov_b32 s90, 0x3b124925
    s_mov_b32 s91, 0x3727c5ac
    s_mov_b32 s92, 0xc0135761
    s_mov_b32 s93, 0xbdd2d3e8
    s_mov_b32 s94, 0x3e8b97f6
    s_mov_b32 s95, 0x43660000
    s_mov_b32 s3, 0x418b9ec4
    s_mul_i32 s72, s46, 37
    s_lshr_b32 s72, s72, 8
    s_mul_i32 s73, s72, 7
    s_sub_u32 s54, s46, s73
    s_lshl_b32 s73, s45, 2
    s_add_u32 s53, s72, s73
    s_lshr_b32 s72, s72, 1
    s_mul_i32 s73, s72, 14
    s_sub_u32 s56, s46, s73
    s_lshl_b32 s73, s45, 1
    s_add_u32 s55, s72, s73
    s_lshr_b32 s58, s44, 1
    s_and_b32 s59, s44, 1
    s_lshl_b32 s60, s53, 1
    s_add_u32 s60, s60, s59
    s_lshl_b32 s61, s2, 11
    s_add_u32 s61, s61, 1048576
    s_lshl_b32 s71, s46, 14
    s_lshl_b32 s72, s45, 10
    s_add_u32 s71, s71, s72
    s_and_b32 s72, s50, 1
    s_mul_i32 s72, s72, 262144
    s_lshr_b32 s73, s50, 1
    s_lshl_b32 s73, s73, 10
    s_add_u32 s72, s72, s73
    s_add_u32 s64, s72, 0
    s_and_b32 s72, s50, 1
    s_mul_i32 s72, s72, 229376
    s_lshr_b32 s73, s50, 1
    s_lshl_b32 s73, s73, 10
    s_add_u32 s72, s72, s73
    s_add_u32 s65, s72, 4
    s_and_b32 s72, s55, 1
    s_mul_i32 s72, s72, 229376
    s_lshr_b32 s73, s55, 1
    s_lshl_b32 s73, s73, 10
    s_add_u32 s72, s72, s73
    s_add_u32 s68, s72, 16
    s_and_b32 s72, s55, 1
    s_mul_i32 s72, s72, 262144
    s_lshr_b32 s73, s55, 1
    s_lshl_b32 s73, s73, 10
    s_add_u32 s72, s72, s73
    s_add_u32 s70, s72, 24
    s_sub_u32 s72, s46, s54
    s_lshl_b32 s72, s72, 14
    s_lshl_b32 s73, s45, 10
    s_add_u32 s72, s72, s73
    s_add_u32 s66, s72, 8
    s_mov_b32 s0, 0x7f7f7f
    s_mov_b32 s1, 0
    s_mov_b32 s89, 21
    s_cmp_eq_u32 s53, 0
    s_cselect_b32 s0, 0x7f7f00, s0
    s_cselect_b32 s89, 14, s89
    s_cmp_eq_u32 s53, 31
    s_cselect_b32 s0, 0x7f7f, s0
    s_cselect_b32 s89, 14, s89
    v_lshlrev_b32 v0, 14, v1
    v_accvgpr_write_b32 a238, 1
    v_mov_b32 v200, 0
    v_mov_b32 v201, 0
    v_mov_b32 v202, 0
    v_mov_b32 v203, 0
    s_waitcnt vmcnt(0)
    v_and_b32 v254, 31, v1
    v_lshlrev_b32 v254, 6, v254
    v_add_u32 v254, s78, v254
    v_bfe_u32 v15, v1, 2, 2
    v_lshrrev_b32 v255, 5, v1
    v_xor_b32 v15, v15, v255
    v_xor_b32 v255, 2, v15
    v_lshlrev_b32 v255, 4, v255
    v_add_u32 v255, v255, v254
    v_lshlrev_b32 v15, 4, v15
    v_add_u32 v254, v254, v15
    ds_read_b128 v[16:19], v254 offset:0
    ds_read_b128 v[20:23], v255 offset:0
    ds_read_b128 v[24:27], v254 offset:2048
    ds_read_b128 v[28:31], v255 offset:2048
    ds_read_b128 v[32:35], v254 offset:4096
    ds_read_b128 v[36:39], v255 offset:4096
    ds_read_b128 v[40:43], v254 offset:6144
    ds_read_b128 v[44:47], v255 offset:6144
    ds_read_b128 v[48:51], v254 offset:8192
    ds_read_b128 v[52:55], v255 offset:8192
    ds_read_b128 v[56:59], v254 offset:10240
    ds_read_b128 v[60:63], v255 offset:10240
    ds_read_b128 v[64:67], v254 offset:12288
    ds_read_b128 v[68:71], v255 offset:12288
    ds_read_b128 v[72:75], v254 offset:14336
    ds_read_b128 v[76:79], v255 offset:14336
    ds_read_b128 v[80:83], v254 offset:16384
    ds_read_b128 v[84:87], v255 offset:16384
    ds_read_b128 v[88:91], v254 offset:18432
    ds_read_b128 v[92:95], v255 offset:18432
    ds_read_b128 v[96:99], v254 offset:20480
    ds_read_b128 v[100:103], v255 offset:20480
    ds_read_b128 v[104:107], v254 offset:22528
    ds_read_b128 v[108:111], v255 offset:22528
    ds_read_b128 v[112:115], v254 offset:24576
    ds_read_b128 v[116:119], v255 offset:24576
    ds_read_b128 v[120:123], v254 offset:26624
    ds_read_b128 v[124:127], v255 offset:26624
    s_cmp_lg_u32 s44, 3
    s_cbranch_scc1 L_init_3
    s_getreg_b32 s73, hwreg(HW_REG_XCC_ID, 0, 3)
    s_lshl_b32 s73, s73, 2
    s_lshl_b32 s73, 1, s73
    s_add_u32 s73, s73, s67
    v_mov_b32_e64 v244, s73
    s_and_b32 s72, s2, 63
    s_lshl_b32 s72, s72, 2
    s_mov_b64 exec, 1
    buffer_atomic_add v244, v3, s[36:39], s72 offen sc1
    s_mov_b64 exec, -1
L_init_3:
    s_waitcnt lgkmcnt(15)
    v_dot2_f32_bf16 v200, v16, s88, v200
    s_waitcnt lgkmcnt(0)
    s_barrier
    buffer_load_dwordx4 v252, s[8:11], s75 offen  lds
    v_dot2_f32_bf16 v201, v16, v16, v201
    v_dot2_f32_bf16 v202, v17, s88, v202
    v_dot2_f32_bf16 v203, v17, v17, v203
    v_dot2_f32_bf16 v200, v18, s88, v200
    v_dot2_f32_bf16 v201, v18, v18, v201
    v_dot2_f32_bf16 v202, v19, s88, v202
    v_dot2_f32_bf16 v203, v19, v19, v203
    v_dot2_f32_bf16 v200, v20, s88, v200
    v_dot2_f32_bf16 v201, v20, v20, v201
    v_dot2_f32_bf16 v202, v21, s88, v202
    v_dot2_f32_bf16 v203, v21, v21, v203
    v_dot2_f32_bf16 v200, v22, s88, v200
    v_dot2_f32_bf16 v201, v22, v22, v201
    v_dot2_f32_bf16 v202, v23, s88, v202
    v_dot2_f32_bf16 v203, v23, v23, v203
    v_dot2_f32_bf16 v200, v24, s88, v200
    v_dot2_f32_bf16 v201, v24, v24, v201
    v_dot2_f32_bf16 v202, v25, s88, v202
    v_dot2_f32_bf16 v203, v25, v25, v203
    v_dot2_f32_bf16 v200, v26, s88, v200
    v_dot2_f32_bf16 v201, v26, v26, v201
    v_dot2_f32_bf16 v202, v27, s88, v202
    v_dot2_f32_bf16 v203, v27, v27, v203
    v_dot2_f32_bf16 v200, v28, s88, v200
    v_dot2_f32_bf16 v201, v28, v28, v201
    v_dot2_f32_bf16 v202, v29, s88, v202
    v_dot2_f32_bf16 v203, v29, v29, v203
    v_dot2_f32_bf16 v200, v30, s88, v200
    v_dot2_f32_bf16 v201, v30, v30, v201
    v_dot2_f32_bf16 v202, v31, s88, v202
    v_dot2_f32_bf16 v203, v31, v31, v203
    v_dot2_f32_bf16 v200, v32, s88, v200
    v_dot2_f32_bf16 v201, v32, v32, v201
    v_dot2_f32_bf16 v202, v33, s88, v202
    v_dot2_f32_bf16 v203, v33, v33, v203
    s_add_u32 s75, s75, 86016
    s_add_u32 m0, m0, 2048
    s_cmp_eq_u32 s79, 1
    s_cselect_b32 s75, s98, s75
    s_cselect_b32 m0, s99, m0
    s_nop 0
    buffer_load_dwordx4 v252, s[8:11], s75 offen  lds
    v_dot2_f32_bf16 v200, v34, s88, v200
    v_dot2_f32_bf16 v201, v34, v34, v201
    v_dot2_f32_bf16 v202, v35, s88, v202
    v_dot2_f32_bf16 v203, v35, v35, v203
    v_dot2_f32_bf16 v200, v36, s88, v200
    v_dot2_f32_bf16 v201, v36, v36, v201
    v_dot2_f32_bf16 v202, v37, s88, v202
    v_dot2_f32_bf16 v203, v37, v37, v203
    v_dot2_f32_bf16 v200, v38, s88, v200
    v_dot2_f32_bf16 v201, v38, v38, v201
    v_dot2_f32_bf16 v202, v39, s88, v202
    v_dot2_f32_bf16 v203, v39, v39, v203
    v_dot2_f32_bf16 v200, v40, s88, v200
    v_dot2_f32_bf16 v201, v40, v40, v201
    v_dot2_f32_bf16 v202, v41, s88, v202
    v_dot2_f32_bf16 v203, v41, v41, v203
    v_dot2_f32_bf16 v200, v42, s88, v200
    v_dot2_f32_bf16 v201, v42, v42, v201
    v_dot2_f32_bf16 v202, v43, s88, v202
    v_dot2_f32_bf16 v203, v43, v43, v203
    v_dot2_f32_bf16 v200, v44, s88, v200
    v_dot2_f32_bf16 v201, v44, v44, v201
    v_dot2_f32_bf16 v202, v45, s88, v202
    v_dot2_f32_bf16 v203, v45, v45, v203
    v_dot2_f32_bf16 v200, v46, s88, v200
    v_dot2_f32_bf16 v201, v46, v46, v201
    v_dot2_f32_bf16 v202, v47, s88, v202
    v_dot2_f32_bf16 v203, v47, v47, v203
    v_dot2_f32_bf16 v200, v48, s88, v200
    v_dot2_f32_bf16 v201, v48, v48, v201
    v_dot2_f32_bf16 v202, v49, s88, v202
    v_dot2_f32_bf16 v203, v49, v49, v203
    v_dot2_f32_bf16 v200, v50, s88, v200
    v_dot2_f32_bf16 v201, v50, v50, v201
    v_dot2_f32_bf16 v202, v51, s88, v202
    v_dot2_f32_bf16 v203, v51, v51, v203
    s_add_u32 s75, s75, 86016
    s_add_u32 m0, m0, 2048
    s_cmp_eq_u32 s79, 2
    s_cselect_b32 s75, s98, s75
    s_cselect_b32 m0, s99, m0
    s_nop 0
    buffer_load_dwordx4 v252, s[8:11], s75 offen  lds
    v_dot2_f32_bf16 v200, v52, s88, v200
    v_dot2_f32_bf16 v201, v52, v52, v201
    v_dot2_f32_bf16 v202, v53, s88, v202
    v_dot2_f32_bf16 v203, v53, v53, v203
    v_dot2_f32_bf16 v200, v54, s88, v200
    v_dot2_f32_bf16 v201, v54, v54, v201
    v_dot2_f32_bf16 v202, v55, s88, v202
    v_dot2_f32_bf16 v203, v55, v55, v203
    v_dot2_f32_bf16 v200, v56, s88, v200
    v_dot2_f32_bf16 v201, v56, v56, v201
    v_dot2_f32_bf16 v202, v57, s88, v202
    v_dot2_f32_bf16 v203, v57, v57, v203
    v_dot2_f32_bf16 v200, v58, s88, v200
    v_dot2_f32_bf16 v201, v58, v58, v201
    v_dot2_f32_bf16 v202, v59, s88, v202
    v_dot2_f32_bf16 v203, v59, v59, v203
    v_dot2_f32_bf16 v200, v60, s88, v200
    v_dot2_f32_bf16 v201, v60, v60, v201
    v_dot2_f32_bf16 v202, v61, s88, v202
    v_dot2_f32_bf16 v203, v61, v61, v203
    v_dot2_f32_bf16 v200, v62, s88, v200
    v_dot2_f32_bf16 v201, v62, v62, v201
    v_dot2_f32_bf16 v202, v63, s88, v202
    v_dot2_f32_bf16 v203, v63, v63, v203
    v_dot2_f32_bf16 v200, v64, s88, v200
    v_dot2_f32_bf16 v201, v64, v64, v201
    v_dot2_f32_bf16 v202, v65, s88, v202
    v_dot2_f32_bf16 v203, v65, v65, v203
    v_dot2_f32_bf16 v200, v66, s88, v200
    v_dot2_f32_bf16 v201, v66, v66, v201
    v_dot2_f32_bf16 v202, v67, s88, v202
    v_dot2_f32_bf16 v203, v67, v67, v203
    v_dot2_f32_bf16 v200, v68, s88, v200
    v_dot2_f32_bf16 v201, v68, v68, v201
    v_dot2_f32_bf16 v202, v69, s88, v202
    v_dot2_f32_bf16 v203, v69, v69, v203
    s_add_u32 s75, s75, 86016
    s_add_u32 m0, m0, 2048
    s_cmp_eq_u32 s79, 3
    s_cselect_b32 s75, s98, s75
    s_cselect_b32 m0, s99, m0
    s_nop 0
    buffer_load_dwordx4 v252, s[8:11], s75 offen  lds
    v_dot2_f32_bf16 v200, v70, s88, v200
    v_dot2_f32_bf16 v201, v70, v70, v201
    v_dot2_f32_bf16 v202, v71, s88, v202
    v_dot2_f32_bf16 v203, v71, v71, v203
    v_dot2_f32_bf16 v200, v72, s88, v200
    v_dot2_f32_bf16 v201, v72, v72, v201
    v_dot2_f32_bf16 v202, v73, s88, v202
    v_dot2_f32_bf16 v203, v73, v73, v203
    v_dot2_f32_bf16 v200, v74, s88, v200
    v_dot2_f32_bf16 v201, v74, v74, v201
    v_dot2_f32_bf16 v202, v75, s88, v202
    v_dot2_f32_bf16 v203, v75, v75, v203
    v_dot2_f32_bf16 v200, v76, s88, v200
    v_dot2_f32_bf16 v201, v76, v76, v201
    v_dot2_f32_bf16 v202, v77, s88, v202
    v_dot2_f32_bf16 v203, v77, v77, v203
    v_dot2_f32_bf16 v200, v78, s88, v200
    v_dot2_f32_bf16 v201, v78, v78, v201
    v_dot2_f32_bf16 v202, v79, s88, v202
    v_dot2_f32_bf16 v203, v79, v79, v203
    v_dot2_f32_bf16 v200, v80, s88, v200
    v_dot2_f32_bf16 v201, v80, v80, v201
    v_dot2_f32_bf16 v202, v81, s88, v202
    v_dot2_f32_bf16 v203, v81, v81, v203
    v_dot2_f32_bf16 v200, v82, s88, v200
    v_dot2_f32_bf16 v201, v82, v82, v201
    v_dot2_f32_bf16 v202, v83, s88, v202
    v_dot2_f32_bf16 v203, v83, v83, v203
    v_dot2_f32_bf16 v200, v84, s88, v200
    v_dot2_f32_bf16 v201, v84, v84, v201
    v_dot2_f32_bf16 v202, v85, s88, v202
    v_dot2_f32_bf16 v203, v85, v85, v203
    v_dot2_f32_bf16 v200, v86, s88, v200
    v_dot2_f32_bf16 v201, v86, v86, v201
    v_dot2_f32_bf16 v202, v87, s88, v202
    s_add_u32 s75, s75, 86016
    s_add_u32 m0, m0, 2048
    s_cmp_eq_u32 s79, 4
    s_cselect_b32 s75, s98, s75
    s_cselect_b32 m0, s99, m0
    s_nop 0
    buffer_load_dwordx4 v252, s[8:11], s75 offen  lds
    v_dot2_f32_bf16 v203, v87, v87, v203
    v_dot2_f32_bf16 v200, v88, s88, v200
    v_dot2_f32_bf16 v201, v88, v88, v201
    v_dot2_f32_bf16 v202, v89, s88, v202
    v_dot2_f32_bf16 v203, v89, v89, v203
    v_dot2_f32_bf16 v200, v90, s88, v200
    v_dot2_f32_bf16 v201, v90, v90, v201
    v_dot2_f32_bf16 v202, v91, s88, v202
    v_dot2_f32_bf16 v203, v91, v91, v203
    v_dot2_f32_bf16 v200, v92, s88, v200
    v_dot2_f32_bf16 v201, v92, v92, v201
    v_dot2_f32_bf16 v202, v93, s88, v202
    v_dot2_f32_bf16 v203, v93, v93, v203
    v_dot2_f32_bf16 v200, v94, s88, v200
    v_dot2_f32_bf16 v201, v94, v94, v201
    v_dot2_f32_bf16 v202, v95, s88, v202
    v_dot2_f32_bf16 v203, v95, v95, v203
    v_dot2_f32_bf16 v200, v96, s88, v200
    v_dot2_f32_bf16 v201, v96, v96, v201
    v_dot2_f32_bf16 v202, v97, s88, v202
    v_dot2_f32_bf16 v203, v97, v97, v203
    v_dot2_f32_bf16 v200, v98, s88, v200
    v_dot2_f32_bf16 v201, v98, v98, v201
    v_dot2_f32_bf16 v202, v99, s88, v202
    v_dot2_f32_bf16 v203, v99, v99, v203
    v_dot2_f32_bf16 v200, v100, s88, v200
    v_dot2_f32_bf16 v201, v100, v100, v201
    v_dot2_f32_bf16 v202, v101, s88, v202
    v_dot2_f32_bf16 v203, v101, v101, v203
    v_dot2_f32_bf16 v200, v102, s88, v200
    v_dot2_f32_bf16 v201, v102, v102, v201
    v_dot2_f32_bf16 v202, v103, s88, v202
    v_dot2_f32_bf16 v203, v103, v103, v203
    v_dot2_f32_bf16 v200, v104, s88, v200
    v_dot2_f32_bf16 v201, v104, v104, v201
    v_dot2_f32_bf16 v202, v105, s88, v202
    s_add_u32 s75, s75, 86016
    s_add_u32 m0, m0, 2048
    s_cmp_eq_u32 s79, 5
    s_cselect_b32 s75, s98, s75
    s_cselect_b32 m0, s99, m0
    s_nop 0
    buffer_load_dwordx4 v252, s[8:11], s75 offen  lds
    v_dot2_f32_bf16 v203, v105, v105, v203
    v_dot2_f32_bf16 v200, v106, s88, v200
    v_dot2_f32_bf16 v201, v106, v106, v201
    v_dot2_f32_bf16 v202, v107, s88, v202
    v_dot2_f32_bf16 v203, v107, v107, v203
    v_dot2_f32_bf16 v200, v108, s88, v200
    v_dot2_f32_bf16 v201, v108, v108, v201
    v_dot2_f32_bf16 v202, v109, s88, v202
    v_dot2_f32_bf16 v203, v109, v109, v203
    v_dot2_f32_bf16 v200, v110, s88, v200
    v_dot2_f32_bf16 v201, v110, v110, v201
    v_dot2_f32_bf16 v202, v111, s88, v202
    v_dot2_f32_bf16 v203, v111, v111, v203
    v_dot2_f32_bf16 v200, v112, s88, v200
    v_dot2_f32_bf16 v201, v112, v112, v201
    v_dot2_f32_bf16 v202, v113, s88, v202
    v_dot2_f32_bf16 v203, v113, v113, v203
    v_dot2_f32_bf16 v200, v114, s88, v200
    v_dot2_f32_bf16 v201, v114, v114, v201
    v_dot2_f32_bf16 v202, v115, s88, v202
    v_dot2_f32_bf16 v203, v115, v115, v203
    v_dot2_f32_bf16 v200, v116, s88, v200
    v_dot2_f32_bf16 v201, v116, v116, v201
    v_dot2_f32_bf16 v202, v117, s88, v202
    v_dot2_f32_bf16 v203, v117, v117, v203
    v_dot2_f32_bf16 v200, v118, s88, v200
    v_dot2_f32_bf16 v201, v118, v118, v201
    v_dot2_f32_bf16 v202, v119, s88, v202
    v_dot2_f32_bf16 v203, v119, v119, v203
    v_dot2_f32_bf16 v200, v120, s88, v200
    v_dot2_f32_bf16 v201, v120, v120, v201
    v_dot2_f32_bf16 v202, v121, s88, v202
    v_dot2_f32_bf16 v203, v121, v121, v203
    v_dot2_f32_bf16 v200, v122, s88, v200
    v_dot2_f32_bf16 v201, v122, v122, v201
    v_dot2_f32_bf16 v202, v123, s88, v202
    s_add_u32 s75, s75, 86016
    s_add_u32 m0, m0, 2048
    s_cmp_eq_u32 s79, 6
    s_cselect_b32 s75, s98, s75
    s_cselect_b32 m0, s99, m0
    s_nop 0
    buffer_load_dwordx4 v252, s[8:11], s75 offen  lds
    v_dot2_f32_bf16 v203, v123, v123, v203
    v_dot2_f32_bf16 v200, v124, s88, v200
    v_dot2_f32_bf16 v201, v124, v124, v201
    v_dot2_f32_bf16 v202, v125, s88, v202
    v_dot2_f32_bf16 v203, v125, v125, v203
    v_dot2_f32_bf16 v200, v126, s88, v200
    v_dot2_f32_bf16 v201, v126, v126, v201
    v_dot2_f32_bf16 v202, v127, s88, v202
    v_dot2_f32_bf16 v203, v127, v127, v203
    s_nop 2
    v_pk_add_f32 v[200:201], v[200:201], v[202:203]
    v_mov_b32 v202, v200
    s_nop 1
    v_permlane32_swap_b32 v202, v200
    v_add_f32 v200, v200, v202
    v_mov_b32 v202, v201
    s_nop 1
    v_permlane32_swap_b32 v202, v201
    v_add_f32 v201, v201, v202
    v_mul_f32 v202, s90, v200
    v_mul_f32 v203, s90, v201
    v_fma_f32 v203, -v202, v202, v203
    v_max_f32 v203, 0, v203
    v_add_f32 v203, s91, v203
    v_rsq_f32 v204, v203
    s_nop 0
    v_mul_f32 v202, v202, v204
    v_mov_b32 v206, s94
    v_lshlrev_b32 v208, 16, v16
    v_and_b32 v209, 0xffff0000, v16
    v_lshlrev_b32 v210, 16, v17
    v_and_b32 v211, 0xffff0000, v17
    v_lshlrev_b32 v212, 16, v18
    v_and_b32 v213, 0xffff0000, v18
    v_lshlrev_b32_e64 v214, 16, v19
    v_and_b32 v215, 0xffff0000, v19
    v_pk_fma_f32 v[208:209], v[208:209], v[204:205], v[202:203] op_sel_hi:[1,0,0] neg_lo:[0,0,1] neg_hi:[0,0,1]
    v_pk_fma_f32 v[210:211], v[210:211], v[204:205], v[202:203] op_sel_hi:[1,0,0] neg_lo:[0,0,1] neg_hi:[0,0,1]
    v_pk_fma_f32 v[212:213], v[212:213], v[204:205], v[202:203] op_sel_hi:[1,0,0] neg_lo:[0,0,1] neg_hi:[0,0,1]
    v_pk_fma_f32 v[214:215], v[214:215], v[204:205], v[202:203] op_sel_hi:[1,0,0] neg_lo:[0,0,1] neg_hi:[0,0,1]
    s_add_u32 s75, s75, 86016
    s_add_u32 m0, m0, 2048
    s_cmp_eq_u32 s79, 7
    s_cselect_b32 s75, s98, s75
    s_cselect_b32 m0, s99, m0
    s_nop 0
    buffer_load_dwordx4 v252, s[8:11], s75 offen  lds
    v_cvt_pk_bf16_f32 v16, v208, v209
    v_cvt_pk_bf16_f32 v17, v210, v211
    v_cvt_pk_bf16_f32 v18, v212, v213
    v_cvt_pk_bf16_f32 v19, v214, v215
    v_lshlrev_b32 v208, 16, v20
    v_and_b32 v209, 0xffff0000, v20
    v_lshlrev_b32 v210, 16, v21
    v_and_b32 v211, 0xffff0000, v21
    v_lshlrev_b32 v212, 16, v22
    v_and_b32 v213, 0xffff0000, v22
    v_lshlrev_b32 v214, 16, v23
    v_and_b32 v215, 0xffff0000, v23
    v_pk_fma_f32 v[208:209], v[208:209], v[204:205], v[202:203] op_sel_hi:[1,0,0] neg_lo:[0,0,1] neg_hi:[0,0,1]
    v_pk_fma_f32 v[210:211], v[210:211], v[204:205], v[202:203] op_sel_hi:[1,0,0] neg_lo:[0,0,1] neg_hi:[0,0,1]
    v_pk_fma_f32 v[212:213], v[212:213], v[204:205], v[202:203] op_sel_hi:[1,0,0] neg_lo:[0,0,1] neg_hi:[0,0,1]
    v_pk_fma_f32 v[214:215], v[214:215], v[204:205], v[202:203] op_sel_hi:[1,0,0] neg_lo:[0,0,1] neg_hi:[0,0,1]
    v_cvt_pk_bf16_f32 v20, v208, v209
    v_cvt_pk_bf16_f32 v21, v210, v211
    v_cvt_pk_bf16_f32 v22, v212, v213
    v_cvt_pk_bf16_f32 v23, v214, v215
    v_lshlrev_b32 v208, 16, v24
    v_and_b32 v209, 0xffff0000, v24
    v_lshlrev_b32 v210, 16, v25
    v_and_b32 v211, 0xffff0000, v25
    v_lshlrev_b32 v212, 16, v26
    v_and_b32 v213, 0xffff0000, v26
    v_lshlrev_b32 v214, 16, v27
    v_and_b32 v215, 0xffff0000, v27
    v_pk_fma_f32 v[208:209], v[208:209], v[204:205], v[202:203] op_sel_hi:[1,0,0] neg_lo:[0,0,1] neg_hi:[0,0,1]
    v_pk_fma_f32 v[210:211], v[210:211], v[204:205], v[202:203] op_sel_hi:[1,0,0] neg_lo:[0,0,1] neg_hi:[0,0,1]
    v_pk_fma_f32 v[212:213], v[212:213], v[204:205], v[202:203] op_sel_hi:[1,0,0] neg_lo:[0,0,1] neg_hi:[0,0,1]
    v_pk_fma_f32 v[214:215], v[214:215], v[204:205], v[202:203] op_sel_hi:[1,0,0] neg_lo:[0,0,1] neg_hi:[0,0,1]
    v_cvt_pk_bf16_f32 v24, v208, v209
    v_cvt_pk_bf16_f32 v25, v210, v211
    v_cvt_pk_bf16_f32 v26, v212, v213
    s_add_u32 s75, s75, 86016
    s_add_u32 m0, m0, 2048
    s_cmp_eq_u32 s79, 8
    s_cselect_b32 s75, s98, s75
    s_cselect_b32 m0, s99, m0
    s_nop 0
    buffer_load_dwordx4 v252, s[8:11], s75 offen  lds
    v_cvt_pk_bf16_f32 v27, v214, v215
    v_lshlrev_b32 v208, 16, v28
    v_and_b32 v209, 0xffff0000, v28
    v_lshlrev_b32 v210, 16, v29
    v_and_b32 v211, 0xffff0000, v29
    v_lshlrev_b32 v212, 16, v30
    v_and_b32 v213, 0xffff0000, v30
    v_lshlrev_b32 v214, 16, v31
    v_and_b32 v215, 0xffff0000, v31
    v_pk_fma_f32 v[208:209], v[208:209], v[204:205], v[202:203] op_sel_hi:[1,0,0] neg_lo:[0,0,1] neg_hi:[0,0,1]
    v_pk_fma_f32 v[210:211], v[210:211], v[204:205], v[202:203] op_sel_hi:[1,0,0] neg_lo:[0,0,1] neg_hi:[0,0,1]
    v_pk_fma_f32 v[212:213], v[212:213], v[204:205], v[202:203] op_sel_hi:[1,0,0] neg_lo:[0,0,1] neg_hi:[0,0,1]
    v_pk_fma_f32 v[214:215], v[214:215], v[204:205], v[202:203] op_sel_hi:[1,0,0] neg_lo:[0,0,1] neg_hi:[0,0,1]
    v_cvt_pk_bf16_f32 v28, v208, v209
    v_cvt_pk_bf16_f32 v29, v210, v211
    v_cvt_pk_bf16_f32 v30, v212, v213
    v_cvt_pk_bf16_f32 v31, v214, v215
    v_lshlrev_b32 v208, 16, v32
    v_and_b32 v209, 0xffff0000, v32
    v_lshlrev_b32 v210, 16, v33
    v_and_b32 v211, 0xffff0000, v33
    v_lshlrev_b32 v212, 16, v34
    v_and_b32 v213, 0xffff0000, v34
    v_lshlrev_b32 v214, 16, v35
    v_and_b32 v215, 0xffff0000, v35
    v_pk_fma_f32 v[208:209], v[208:209], v[204:205], v[202:203] op_sel_hi:[1,0,0] neg_lo:[0,0,1] neg_hi:[0,0,1]
    v_pk_fma_f32 v[210:211], v[210:211], v[204:205], v[202:203] op_sel_hi:[1,0,0] neg_lo:[0,0,1] neg_hi:[0,0,1]
    v_pk_fma_f32 v[212:213], v[212:213], v[204:205], v[202:203] op_sel_hi:[1,0,0] neg_lo:[0,0,1] neg_hi:[0,0,1]
    v_pk_fma_f32 v[214:215], v[214:215], v[204:205], v[202:203] op_sel_hi:[1,0,0] neg_lo:[0,0,1] neg_hi:[0,0,1]
    v_cvt_pk_bf16_f32 v32, v208, v209
    v_cvt_pk_bf16_f32 v33, v210, v211
    v_cvt_pk_bf16_f32 v34, v212, v213
    v_cvt_pk_bf16_f32 v35, v214, v215
    v_lshlrev_b32 v208, 16, v36
    v_and_b32 v209, 0xffff0000, v36
    v_lshlrev_b32 v210, 16, v37
    s_add_u32 s75, s75, 86016
    s_add_u32 m0, m0, 2048
    s_cmp_eq_u32 s79, 9
    s_cselect_b32 s75, s98, s75
    s_cselect_b32 m0, s99, m0
    s_nop 0
    buffer_load_dwordx4 v252, s[8:11], s75 offen  lds
    v_and_b32 v211, 0xffff0000, v37
    v_lshlrev_b32 v212, 16, v38
    v_and_b32 v213, 0xffff0000, v38
    v_lshlrev_b32 v214, 16, v39
    v_and_b32 v215, 0xffff0000, v39
    v_pk_fma_f32 v[208:209], v[208:209], v[204:205], v[202:203] op_sel_hi:[1,0,0] neg_lo:[0,0,1] neg_hi:[0,0,1]
    v_pk_fma_f32 v[210:211], v[210:211], v[204:205], v[202:203] op_sel_hi:[1,0,0] neg_lo:[0,0,1] neg_hi:[0,0,1]
    v_pk_fma_f32 v[212:213], v[212:213], v[204:205], v[202:203] op_sel_hi:[1,0,0] neg_lo:[0,0,1] neg_hi:[0,0,1]
    v_pk_fma_f32 v[214:215], v[214:215], v[204:205], v[202:203] op_sel_hi:[1,0,0] neg_lo:[0,0,1] neg_hi:[0,0,1]
    v_cvt_pk_bf16_f32 v36, v208, v209
    v_cvt_pk_bf16_f32 v37, v210, v211
    v_cvt_pk_bf16_f32 v38, v212, v213
    v_cvt_pk_bf16_f32 v39, v214, v215
    v_lshlrev_b32 v208, 16, v40
    v_and_b32 v209, 0xffff0000, v40
    v_lshlrev_b32 v210, 16, v41
    v_and_b32 v211, 0xffff0000, v41
    v_lshlrev_b32 v212, 16, v42
    v_and_b32 v213, 0xffff0000, v42
    v_lshlrev_b32 v214, 16, v43
    v_and_b32 v215, 0xffff0000, v43
    v_pk_fma_f32 v[208:209], v[208:209], v[204:205], v[202:203] op_sel_hi:[1,0,0] neg_lo:[0,0,1] neg_hi:[0,0,1]
    v_pk_fma_f32 v[210:211], v[210:211], v[204:205], v[202:203] op_sel_hi:[1,0,0] neg_lo:[0,0,1] neg_hi:[0,0,1]
    v_pk_fma_f32 v[212:213], v[212:213], v[204:205], v[202:203] op_sel_hi:[1,0,0] neg_lo:[0,0,1] neg_hi:[0,0,1]
    v_pk_fma_f32 v[214:215], v[214:215], v[204:205], v[202:203] op_sel_hi:[1,0,0] neg_lo:[0,0,1] neg_hi:[0,0,1]
    v_cvt_pk_bf16_f32 v40, v208, v209
    v_cvt_pk_bf16_f32 v41, v210, v211
    v_cvt_pk_bf16_f32 v42, v212, v213
    v_cvt_pk_bf16_f32 v43, v214, v215
    v_lshlrev_b32 v208, 16, v44
    v_and_b32 v209, 0xffff0000, v44
    v_lshlrev_b32 v210, 16, v45
    v_and_b32 v211, 0xffff0000, v45
    v_lshlrev_b32 v212, 16, v46
    v_and_b32 v213, 0xffff0000, v46
    v_lshlrev_b32 v214, 16, v47
    s_add_u32 s75, s75, 86016
    s_add_u32 m0, m0, 2048
    s_cmp_eq_u32 s79, 10
    s_cselect_b32 s75, s98, s75
    s_cselect_b32 m0, s99, m0
    s_nop 0
    buffer_load_dwordx4 v252, s[8:11], s75 offen  lds
    v_and_b32 v215, 0xffff0000, v47
    v_pk_fma_f32 v[208:209], v[208:209], v[204:205], v[202:203] op_sel_hi:[1,0,0] neg_lo:[0,0,1] neg_hi:[0,0,1]
    v_pk_fma_f32 v[210:211], v[210:211], v[204:205], v[202:203] op_sel_hi:[1,0,0] neg_lo:[0,0,1] neg_hi:[0,0,1]
    v_pk_fma_f32 v[212:213], v[212:213], v[204:205], v[202:203] op_sel_hi:[1,0,0] neg_lo:[0,0,1] neg_hi:[0,0,1]
    v_pk_fma_f32 v[214:215], v[214:215], v[204:205], v[202:203] op_sel_hi:[1,0,0] neg_lo:[0,0,1] neg_hi:[0,0,1]
    v_cvt_pk_bf16_f32 v44, v208, v209
    v_cvt_pk_bf16_f32 v45, v210, v211
    v_cvt_pk_bf16_f32 v46, v212, v213
    v_cvt_pk_bf16_f32 v47, v214, v215
    v_lshlrev_b32 v208, 16, v48
    v_and_b32 v209, 0xffff0000, v48
    v_lshlrev_b32 v210, 16, v49
    v_and_b32 v211, 0xffff0000, v49
    v_lshlrev_b32 v212, 16, v50
    v_and_b32 v213, 0xffff0000, v50
    v_lshlrev_b32 v214, 16, v51
    v_and_b32 v215, 0xffff0000, v51
    v_pk_fma_f32 v[208:209], v[208:209], v[204:205], v[202:203] op_sel_hi:[1,0,0] neg_lo:[0,0,1] neg_hi:[0,0,1]
    v_pk_fma_f32 v[210:211], v[210:211], v[204:205], v[202:203] op_sel_hi:[1,0,0] neg_lo:[0,0,1] neg_hi:[0,0,1]
    v_pk_fma_f32 v[212:213], v[212:213], v[204:205], v[202:203] op_sel_hi:[1,0,0] neg_lo:[0,0,1] neg_hi:[0,0,1]
    v_pk_fma_f32 v[214:215], v[214:215], v[204:205], v[202:203] op_sel_hi:[1,0,0] neg_lo:[0,0,1] neg_hi:[0,0,1]
    v_cvt_pk_bf16_f32 v48, v208, v209
    v_cvt_pk_bf16_f32 v49, v210, v211
    v_cvt_pk_bf16_f32 v50, v212, v213
    v_cvt_pk_bf16_f32 v51, v214, v215
    v_lshlrev_b32 v208, 16, v52
    v_and_b32 v209, 0xffff0000, v52
    v_lshlrev_b32 v210, 16, v53
    v_and_b32 v211, 0xffff0000, v53
    v_lshlrev_b32 v212, 16, v54
    v_and_b32 v213, 0xffff0000, v54
    v_lshlrev_b32 v214, 16, v55
    v_and_b32 v215, 0xffff0000, v55
    v_pk_fma_f32 v[208:209], v[208:209], v[204:205], v[202:203] op_sel_hi:[1,0,0] neg_lo:[0,0,1] neg_hi:[0,0,1]
    v_pk_fma_f32 v[210:211], v[210:211], v[204:205], v[202:203] op_sel_hi:[1,0,0] neg_lo:[0,0,1] neg_hi:[0,0,1]
    s_add_u32 s75, s75, 86016
    s_add_u32 m0, m0, 2048
    s_cmp_eq_u32 s79, 11
    s_cselect_b32 s75, s98, s75
    s_cselect_b32 m0, s99, m0
    s_nop 0
    buffer_load_dwordx4 v252, s[8:11], s75 offen  lds
    v_pk_fma_f32 v[212:213], v[212:213], v[204:205], v[202:203] op_sel_hi:[1,0,0] neg_lo:[0,0,1] neg_hi:[0,0,1]
    v_pk_fma_f32 v[214:215], v[214:215], v[204:205], v[202:203] op_sel_hi:[1,0,0] neg_lo:[0,0,1] neg_hi:[0,0,1]
    v_cvt_pk_bf16_f32 v52, v208, v209
    v_cvt_pk_bf16_f32 v53, v210, v211
    v_cvt_pk_bf16_f32 v54, v212, v213
    v_cvt_pk_bf16_f32 v55, v214, v215
    v_lshlrev_b32 v208, 16, v56
    v_and_b32 v209, 0xffff0000, v56
    v_lshlrev_b32 v210, 16, v57
    v_and_b32 v211, 0xffff0000, v57
    v_lshlrev_b32 v212, 16, v58
    v_and_b32 v213, 0xffff0000, v58
    v_lshlrev_b32 v214, 16, v59
    v_and_b32 v215, 0xffff0000, v59
    v_pk_fma_f32 v[208:209], v[208:209], v[204:205], v[202:203] op_sel_hi:[1,0,0] neg_lo:[0,0,1] neg_hi:[0,0,1]
    v_pk_fma_f32 v[210:211], v[210:211], v[204:205], v[202:203] op_sel_hi:[1,0,0] neg_lo:[0,0,1] neg_hi:[0,0,1]
    v_pk_fma_f32 v[212:213], v[212:213], v[204:205], v[202:203] op_sel_hi:[1,0,0] neg_lo:[0,0,1] neg_hi:[0,0,1]
    v_pk_fma_f32 v[214:215], v[214:215], v[204:205], v[202:203] op_sel_hi:[1,0,0] neg_lo:[0,0,1] neg_hi:[0,0,1]
    v_cvt_pk_bf16_f32 v56, v208, v209
    v_cvt_pk_bf16_f32 v57, v210, v211
    v_cvt_pk_bf16_f32 v58, v212, v213
    v_cvt_pk_bf16_f32 v59, v214, v215
    v_lshlrev_b32 v208, 16, v60
    v_and_b32 v209, 0xffff0000, v60
    v_lshlrev_b32 v210, 16, v61
    v_and_b32 v211, 0xffff0000, v61
    v_lshlrev_b32 v212, 16, v62
    v_and_b32 v213, 0xffff0000, v62
    v_lshlrev_b32 v214, 16, v63
    v_and_b32 v215, 0xffff0000, v63
    v_pk_fma_f32 v[208:209], v[208:209], v[204:205], v[202:203] op_sel_hi:[1,0,0] neg_lo:[0,0,1] neg_hi:[0,0,1]
    v_pk_fma_f32 v[210:211], v[210:211], v[204:205], v[202:203] op_sel_hi:[1,0,0] neg_lo:[0,0,1] neg_hi:[0,0,1]
    v_pk_fma_f32 v[212:213], v[212:213], v[204:205], v[202:203] op_sel_hi:[1,0,0] neg_lo:[0,0,1] neg_hi:[0,0,1]
    v_pk_fma_f32 v[214:215], v[214:215], v[204:205], v[202:203] op_sel_hi:[1,0,0] neg_lo:[0,0,1] neg_hi:[0,0,1]
    v_cvt_pk_bf16_f32 v60, v208, v209
    v_cvt_pk_bf16_f32 v61, v210, v211
    s_add_u32 s75, s75, 86016
    s_add_u32 m0, m0, 2048
    s_cmp_eq_u32 s79, 12
    s_cselect_b32 s75, s98, s75
    s_cselect_b32 m0, s99, m0
    s_nop 0
    buffer_load_dwordx4 v252, s[8:11], s75 offen  lds
    v_cvt_pk_bf16_f32 v62, v212, v213
    v_cvt_pk_bf16_f32 v63, v214, v215
    v_lshlrev_b32 v208, 16, v64
    v_and_b32 v209, 0xffff0000, v64
    v_lshlrev_b32 v210, 16, v65
    v_and_b32 v211, 0xffff0000, v65
    v_lshlrev_b32 v212, 16, v66
    v_and_b32 v213, 0xffff0000, v66
    v_lshlrev_b32 v214, 16, v67
    v_and_b32 v215, 0xffff0000, v67
    v_pk_fma_f32 v[208:209], v[208:209], v[204:205], v[202:203] op_sel_hi:[1,0,0] neg_lo:[0,0,1] neg_hi:[0,0,1]
    v_pk_fma_f32 v[210:211], v[210:211], v[204:205], v[202:203] op_sel_hi:[1,0,0] neg_lo:[0,0,1] neg_hi:[0,0,1]
    v_pk_fma_f32 v[212:213], v[212:213], v[204:205], v[202:203] op_sel_hi:[1,0,0] neg_lo:[0,0,1] neg_hi:[0,0,1]
    v_pk_fma_f32 v[214:215], v[214:215], v[204:205], v[202:203] op_sel_hi:[1,0,0] neg_lo:[0,0,1] neg_hi:[0,0,1]
    v_cvt_pk_bf16_f32 v64, v208, v209
    v_cvt_pk_bf16_f32 v65, v210, v211
    v_cvt_pk_bf16_f32 v66, v212, v213
    v_cvt_pk_bf16_f32 v67, v214, v215
    v_lshlrev_b32 v208, 16, v68
    v_and_b32 v209, 0xffff0000, v68
    v_lshlrev_b32 v210, 16, v69
    v_and_b32 v211, 0xffff0000, v69
    v_lshlrev_b32 v212, 16, v70
    v_and_b32 v213, 0xffff0000, v70
    v_lshlrev_b32 v214, 16, v71
    v_and_b32 v215, 0xffff0000, v71
    v_pk_fma_f32 v[208:209], v[208:209], v[204:205], v[202:203] op_sel_hi:[1,0,0] neg_lo:[0,0,1] neg_hi:[0,0,1]
    v_pk_fma_f32 v[210:211], v[210:211], v[204:205], v[202:203] op_sel_hi:[1,0,0] neg_lo:[0,0,1] neg_hi:[0,0,1]
    v_pk_fma_f32 v[212:213], v[212:213], v[204:205], v[202:203] op_sel_hi:[1,0,0] neg_lo:[0,0,1] neg_hi:[0,0,1]
    v_pk_fma_f32 v[214:215], v[214:215], v[204:205], v[202:203] op_sel_hi:[1,0,0] neg_lo:[0,0,1] neg_hi:[0,0,1]
    v_cvt_pk_bf16_f32 v68, v208, v209
    v_cvt_pk_bf16_f32 v69, v210, v211
    v_cvt_pk_bf16_f32 v70, v212, v213
    v_cvt_pk_bf16_f32 v71, v214, v215
    v_lshlrev_b32_e64 v208, 16, v72
    v_and_b32 v209, 0xffff0000, v72
    s_add_u32 s75, s75, 86016
    s_add_u32 m0, m0, 2048
    s_cmp_eq_u32 s79, 13
    s_cselect_b32 s75, s98, s75
    s_cselect_b32 m0, s99, m0
    s_nop 0
    buffer_load_dwordx4 v252, s[8:11], s75 offen  lds
    v_lshlrev_b32 v210, 16, v73
    v_and_b32 v211, 0xffff0000, v73
    v_lshlrev_b32 v212, 16, v74
    v_and_b32 v213, 0xffff0000, v74
    v_lshlrev_b32_e64 v214, 16, v75
    v_and_b32 v215, 0xffff0000, v75
    v_pk_fma_f32 v[208:209], v[208:209], v[204:205], v[202:203] op_sel_hi:[1,0,0] neg_lo:[0,0,1] neg_hi:[0,0,1]
    v_pk_fma_f32 v[210:211], v[210:211], v[204:205], v[202:203] op_sel_hi:[1,0,0] neg_lo:[0,0,1] neg_hi:[0,0,1]
    v_pk_fma_f32 v[212:213], v[212:213], v[204:205], v[202:203] op_sel_hi:[1,0,0] neg_lo:[0,0,1] neg_hi:[0,0,1]
    v_pk_fma_f32 v[214:215], v[214:215], v[204:205], v[202:203] op_sel_hi:[1,0,0] neg_lo:[0,0,1] neg_hi:[0,0,1]
    v_cvt_pk_bf16_f32 v72, v208, v209
    v_cvt_pk_bf16_f32 v73, v210, v211
    v_cvt_pk_bf16_f32 v74, v212, v213
    v_cvt_pk_bf16_f32 v75, v214, v215
    v_lshlrev_b32 v208, 16, v76
    v_and_b32 v209, 0xffff0000, v76
    v_lshlrev_b32 v210, 16, v77
    v_and_b32 v211, 0xffff0000, v77
    v_lshlrev_b32 v212, 16, v78
    v_and_b32 v213, 0xffff0000, v78
    v_lshlrev_b32 v214, 16, v79
    v_and_b32 v215, 0xffff0000, v79
    v_pk_fma_f32 v[208:209], v[208:209], v[204:205], v[202:203] op_sel_hi:[1,0,0] neg_lo:[0,0,1] neg_hi:[0,0,1]
    v_pk_fma_f32 v[210:211], v[210:211], v[204:205], v[202:203] op_sel_hi:[1,0,0] neg_lo:[0,0,1] neg_hi:[0,0,1]
    v_pk_fma_f32 v[212:213], v[212:213], v[204:205], v[202:203] op_sel_hi:[1,0,0] neg_lo:[0,0,1] neg_hi:[0,0,1]
    v_pk_fma_f32 v[214:215], v[214:215], v[204:205], v[202:203] op_sel_hi:[1,0,0] neg_lo:[0,0,1] neg_hi:[0,0,1]
    v_cvt_pk_bf16_f32 v76, v208, v209
    v_cvt_pk_bf16_f32 v77, v210, v211
    v_cvt_pk_bf16_f32 v78, v212, v213
    v_cvt_pk_bf16_f32 v79, v214, v215
    v_lshlrev_b32 v208, 16, v80
    v_and_b32 v209, 0xffff0000, v80
    v_lshlrev_b32 v210, 16, v81
    v_and_b32 v211, 0xffff0000, v81
    v_lshlrev_b32 v212, 16, v82
    v_and_b32 v213, 0xffff0000, v82
    v_lshlrev_b32 v214, 16, v83
    v_and_b32 v215, 0xffff0000, v83
    v_pk_fma_f32 v[208:209], v[208:209], v[204:205], v[202:203] op_sel_hi:[1,0,0] neg_lo:[0,0,1] neg_hi:[0,0,1]
    v_pk_fma_f32 v[210:211], v[210:211], v[204:205], v[202:203] op_sel_hi:[1,0,0] neg_lo:[0,0,1] neg_hi:[0,0,1]
    v_pk_fma_f32 v[212:213], v[212:213], v[204:205], v[202:203] op_sel_hi:[1,0,0] neg_lo:[0,0,1] neg_hi:[0,0,1]
    v_pk_fma_f32 v[214:215], v[214:215], v[204:205], v[202:203] op_sel_hi:[1,0,0] neg_lo:[0,0,1] neg_hi:[0,0,1]
    v_cvt_pk_bf16_f32 v80, v208, v209
    v_cvt_pk_bf16_f32 v81, v210, v211
    v_cvt_pk_bf16_f32 v82, v212, v213
    v_cvt_pk_bf16_f32 v83, v214, v215
    v_lshlrev_b32 v208, 16, v84
    v_and_b32 v209, 0xffff0000, v84
    v_lshlrev_b32 v210, 16, v85
    v_and_b32 v211, 0xffff0000, v85
    v_lshlrev_b32 v212, 16, v86
    v_and_b32 v213, 0xffff0000, v86
    v_lshlrev_b32 v214, 16, v87
    v_and_b32 v215, 0xffff0000, v87
    v_pk_fma_f32 v[208:209], v[208:209], v[204:205], v[202:203] op_sel_hi:[1,0,0] neg_lo:[0,0,1] neg_hi:[0,0,1]
    v_pk_fma_f32 v[210:211], v[210:211], v[204:205], v[202:203] op_sel_hi:[1,0,0] neg_lo:[0,0,1] neg_hi:[0,0,1]
    v_pk_fma_f32 v[212:213], v[212:213], v[204:205], v[202:203] op_sel_hi:[1,0,0] neg_lo:[0,0,1] neg_hi:[0,0,1]
    v_pk_fma_f32 v[214:215], v[214:215], v[204:205], v[202:203] op_sel_hi:[1,0,0] neg_lo:[0,0,1] neg_hi:[0,0,1]
    v_cvt_pk_bf16_f32 v84, v208, v209
    v_cvt_pk_bf16_f32 v85, v210, v211
    v_cvt_pk_bf16_f32 v86, v212, v213
    v_cvt_pk_bf16_f32 v87, v214, v215
    v_lshlrev_b32 v208, 16, v88
    v_and_b32 v209, 0xffff0000, v88
    v_lshlrev_b32 v210, 16, v89
    v_and_b32 v211, 0xffff0000, v89
    v_lshlrev_b32 v212, 16, v90
    v_and_b32 v213, 0xffff0000, v90
    v_lshlrev_b32 v214, 16, v91
    v_and_b32 v215, 0xffff0000, v91
    v_pk_fma_f32 v[208:209], v[208:209], v[204:205], v[202:203] op_sel_hi:[1,0,0] neg_lo:[0,0,1] neg_hi:[0,0,1]
    v_pk_fma_f32 v[210:211], v[210:211], v[204:205], v[202:203] op_sel_hi:[1,0,0] neg_lo:[0,0,1] neg_hi:[0,0,1]
    v_pk_fma_f32 v[212:213], v[212:213], v[204:205], v[202:203] op_sel_hi:[1,0,0] neg_lo:[0,0,1] neg_hi:[0,0,1]
    v_pk_fma_f32 v[214:215], v[214:215], v[204:205], v[202:203] op_sel_hi:[1,0,0] neg_lo:[0,0,1] neg_hi:[0,0,1]
    v_cvt_pk_bf16_f32 v88, v208, v209
    v_cvt_pk_bf16_f32 v89, v210, v211
    v_cvt_pk_bf16_f32 v90, v212, v213
    v_cvt_pk_bf16_f32 v91, v214, v215
    v_lshlrev_b32 v208, 16, v92
    v_and_b32 v209, 0xffff0000, v92
    v_lshlrev_b32 v210, 16, v93
    v_and_b32 v211, 0xffff0000, v93
    v_lshlrev_b32 v212, 16, v94
    v_and_b32 v213, 0xffff0000, v94
    v_lshlrev_b32 v214, 16, v95
    v_and_b32 v215, 0xffff0000, v95
    v_pk_fma_f32 v[208:209], v[208:209], v[204:205], v[202:203] op_sel_hi:[1,0,0] neg_lo:[0,0,1] neg_hi:[0,0,1]
    v_pk_fma_f32 v[210:211], v[210:211], v[204:205], v[202:203] op_sel_hi:[1,0,0] neg_lo:[0,0,1] neg_hi:[0,0,1]
    v_pk_fma_f32 v[212:213], v[212:213], v[204:205], v[202:203] op_sel_hi:[1,0,0] neg_lo:[0,0,1] neg_hi:[0,0,1]
    v_pk_fma_f32 v[214:215], v[214:215], v[204:205], v[202:203] op_sel_hi:[1,0,0] neg_lo:[0,0,1] neg_hi:[0,0,1]
    v_cvt_pk_bf16_f32 v92, v208, v209
    v_cvt_pk_bf16_f32 v93, v210, v211
    v_cvt_pk_bf16_f32 v94, v212, v213
    v_cvt_pk_bf16_f32 v95, v214, v215
    v_lshlrev_b32 v208, 16, v96
    v_and_b32 v209, 0xffff0000, v96
    v_lshlrev_b32 v210, 16, v97
    v_and_b32 v211, 0xffff0000, v97
    v_lshlrev_b32 v212, 16, v98
    v_and_b32 v213, 0xffff0000, v98
    v_lshlrev_b32 v214, 16, v99
    v_and_b32 v215, 0xffff0000, v99
    v_pk_fma_f32 v[208:209], v[208:209], v[204:205], v[202:203] op_sel_hi:[1,0,0] neg_lo:[0,0,1] neg_hi:[0,0,1]
    v_pk_fma_f32 v[210:211], v[210:211], v[204:205], v[202:203] op_sel_hi:[1,0,0] neg_lo:[0,0,1] neg_hi:[0,0,1]
    v_pk_fma_f32 v[212:213], v[212:213], v[204:205], v[202:203] op_sel_hi:[1,0,0] neg_lo:[0,0,1] neg_hi:[0,0,1]
    v_pk_fma_f32 v[214:215], v[214:215], v[204:205], v[202:203] op_sel_hi:[1,0,0] neg_lo:[0,0,1] neg_hi:[0,0,1]
    v_cvt_pk_bf16_f32 v96, v208, v209
    v_cvt_pk_bf16_f32 v97, v210, v211
    v_cvt_pk_bf16_f32 v98, v212, v213
    v_cvt_pk_bf16_f32 v99, v214, v215
    v_lshlrev_b32 v208, 16, v100
    v_and_b32 v209, 0xffff0000, v100
    v_lshlrev_b32 v210, 16, v101
    v_and_b32 v211, 0xffff0000, v101
    v_lshlrev_b32 v212, 16, v102
    v_and_b32 v213, 0xffff0000, v102
    v_lshlrev_b32 v214, 16, v103
    v_and_b32 v215, 0xffff0000, v103
    v_pk_fma_f32 v[208:209], v[208:209], v[204:205], v[202:203] op_sel_hi:[1,0,0] neg_lo:[0,0,1] neg_hi:[0,0,1]
    v_pk_fma_f32 v[210:211], v[210:211], v[204:205], v[202:203] op_sel_hi:[1,0,0] neg_lo:[0,0,1] neg_hi:[0,0,1]
    v_pk_fma_f32 v[212:213], v[212:213], v[204:205], v[202:203] op_sel_hi:[1,0,0] neg_lo:[0,0,1] neg_hi:[0,0,1]
    v_pk_fma_f32 v[214:215], v[214:215], v[204:205], v[202:203] op_sel_hi:[1,0,0] neg_lo:[0,0,1] neg_hi:[0,0,1]
    v_cvt_pk_bf16_f32 v100, v208, v209
    v_cvt_pk_bf16_f32 v101, v210, v211
    v_cvt_pk_bf16_f32 v102, v212, v213
    v_cvt_pk_bf16_f32 v103, v214, v215
    v_lshlrev_b32 v208, 16, v104
    v_and_b32 v209, 0xffff0000, v104
    v_lshlrev_b32 v210, 16, v105
    v_and_b32 v211, 0xffff0000, v105
    v_lshlrev_b32 v212, 16, v106
    v_and_b32 v213, 0xffff0000, v106
    v_lshlrev_b32 v214, 16, v107
    v_and_b32 v215, 0xffff0000, v107
    v_pk_fma_f32 v[208:209], v[208:209], v[204:205], v[202:203] op_sel_hi:[1,0,0] neg_lo:[0,0,1] neg_hi:[0,0,1]
    v_pk_fma_f32 v[210:211], v[210:211], v[204:205], v[202:203] op_sel_hi:[1,0,0] neg_lo:[0,0,1] neg_hi:[0,0,1]
    v_pk_fma_f32 v[212:213], v[212:213], v[204:205], v[202:203] op_sel_hi:[1,0,0] neg_lo:[0,0,1] neg_hi:[0,0,1]
    v_pk_fma_f32 v[214:215], v[214:215], v[204:205], v[202:203] op_sel_hi:[1,0,0] neg_lo:[0,0,1] neg_hi:[0,0,1]
    v_cvt_pk_bf16_f32 v104, v208, v209
    v_cvt_pk_bf16_f32 v105, v210, v211
    v_cvt_pk_bf16_f32 v106, v212, v213
    v_cvt_pk_bf16_f32 v107, v214, v215
    v_lshlrev_b32 v208, 16, v108
    v_and_b32 v209, 0xffff0000, v108
    v_lshlrev_b32 v210, 16, v109
    v_and_b32 v211, 0xffff0000, v109
    v_lshlrev_b32 v212, 16, v110
    v_and_b32 v213, 0xffff0000, v110
    v_lshlrev_b32 v214, 16, v111
    v_and_b32 v215, 0xffff0000, v111
    v_pk_fma_f32 v[208:209], v[208:209], v[204:205], v[202:203] op_sel_hi:[1,0,0] neg_lo:[0,0,1] neg_hi:[0,0,1]
    v_pk_fma_f32 v[210:211], v[210:211], v[204:205], v[202:203] op_sel_hi:[1,0,0] neg_lo:[0,0,1] neg_hi:[0,0,1]
    v_pk_fma_f32 v[212:213], v[212:213], v[204:205], v[202:203] op_sel_hi:[1,0,0] neg_lo:[0,0,1] neg_hi:[0,0,1]
    v_pk_fma_f32 v[214:215], v[214:215], v[204:205], v[202:203] op_sel_hi:[1,0,0] neg_lo:[0,0,1] neg_hi:[0,0,1]
    v_cvt_pk_bf16_f32 v108, v208, v209
    v_cvt_pk_bf16_f32 v109, v210, v211
    v_cvt_pk_bf16_f32 v110, v212, v213
    v_cvt_pk_bf16_f32 v111, v214, v215
    v_lshlrev_b32 v208, 16, v112
    v_and_b32 v209, 0xffff0000, v112
    v_lshlrev_b32 v210, 16, v113
    v_and_b32 v211, 0xffff0000, v113
    v_lshlrev_b32 v212, 16, v114
    v_and_b32 v213, 0xffff0000, v114
    v_lshlrev_b32 v214, 16, v115
    v_and_b32 v215, 0xffff0000, v115
    v_pk_fma_f32 v[208:209], v[208:209], v[204:205], v[202:203] op_sel_hi:[1,0,0] neg_lo:[0,0,1] neg_hi:[0,0,1]
    v_pk_fma_f32 v[210:211], v[210:211], v[204:205], v[202:203] op_sel_hi:[1,0,0] neg_lo:[0,0,1] neg_hi:[0,0,1]
    v_pk_fma_f32 v[212:213], v[212:213], v[204:205], v[202:203] op_sel_hi:[1,0,0] neg_lo:[0,0,1] neg_hi:[0,0,1]
    v_pk_fma_f32 v[214:215], v[214:215], v[204:205], v[202:203] op_sel_hi:[1,0,0] neg_lo:[0,0,1] neg_hi:[0,0,1]
    v_cvt_pk_bf16_f32 v112, v208, v209
    v_cvt_pk_bf16_f32 v113, v210, v211
    v_cvt_pk_bf16_f32 v114, v212, v213
    v_cvt_pk_bf16_f32 v115, v214, v215
    v_lshlrev_b32 v208, 16, v116
    v_and_b32 v209, 0xffff0000, v116
    v_lshlrev_b32 v210, 16, v117
    v_and_b32 v211, 0xffff0000, v117
    v_lshlrev_b32 v212, 16, v118
    v_and_b32 v213, 0xffff0000, v118
    v_lshlrev_b32 v214, 16, v119
    v_and_b32 v215, 0xffff0000, v119
    v_pk_fma_f32 v[208:209], v[208:209], v[204:205], v[202:203] op_sel_hi:[1,0,0] neg_lo:[0,0,1] neg_hi:[0,0,1]
    v_pk_fma_f32 v[210:211], v[210:211], v[204:205], v[202:203] op_sel_hi:[1,0,0] neg_lo:[0,0,1] neg_hi:[0,0,1]
    v_pk_fma_f32 v[212:213], v[212:213], v[204:205], v[202:203] op_sel_hi:[1,0,0] neg_lo:[0,0,1] neg_hi:[0,0,1]
    v_pk_fma_f32 v[214:215], v[214:215], v[204:205], v[202:203] op_sel_hi:[1,0,0] neg_lo:[0,0,1] neg_hi:[0,0,1]
    v_cvt_pk_bf16_f32 v116, v208, v209
    v_cvt_pk_bf16_f32 v117, v210, v211
    v_cvt_pk_bf16_f32 v118, v212, v213
    v_cvt_pk_bf16_f32 v119, v214, v215
    v_lshlrev_b32 v208, 16, v120
    v_and_b32 v209, 0xffff0000, v120
    v_lshlrev_b32 v210, 16, v121
    v_and_b32 v211, 0xffff0000, v121
    v_lshlrev_b32 v212, 16, v122
    v_and_b32 v213, 0xffff0000, v122
    v_lshlrev_b32 v214, 16, v123
    v_and_b32 v215, 0xffff0000, v123
    v_pk_fma_f32 v[208:209], v[208:209], v[204:205], v[202:203] op_sel_hi:[1,0,0] neg_lo:[0,0,1] neg_hi:[0,0,1]
    v_pk_fma_f32 v[210:211], v[210:211], v[204:205], v[202:203] op_sel_hi:[1,0,0] neg_lo:[0,0,1] neg_hi:[0,0,1]
    v_pk_fma_f32 v[212:213], v[212:213], v[204:205], v[202:203] op_sel_hi:[1,0,0] neg_lo:[0,0,1] neg_hi:[0,0,1]
    v_pk_fma_f32 v[214:215], v[214:215], v[204:205], v[202:203] op_sel_hi:[1,0,0] neg_lo:[0,0,1] neg_hi:[0,0,1]
    v_cvt_pk_bf16_f32 v120, v208, v209
    v_cvt_pk_bf16_f32 v121, v210, v211
    v_cvt_pk_bf16_f32 v122, v212, v213
    v_cvt_pk_bf16_f32 v123, v214, v215
    v_lshlrev_b32 v208, 16, v124
    v_and_b32 v209, 0xffff0000, v124
    v_lshlrev_b32 v210, 16, v125
    v_and_b32 v211, 0xffff0000, v125
    v_lshlrev_b32 v212, 16, v126
    v_and_b32 v213, 0xffff0000, v126
    v_lshlrev_b32 v214, 16, v127
    v_and_b32 v215, 0xffff0000, v127
    v_pk_fma_f32 v[208:209], v[208:209], v[204:205], v[202:203] op_sel_hi:[1,0,0] neg_lo:[0,0,1] neg_hi:[0,0,1]
    v_pk_fma_f32 v[210:211], v[210:211], v[204:205], v[202:203] op_sel_hi:[1,0,0] neg_lo:[0,0,1] neg_hi:[0,0,1]
    v_pk_fma_f32 v[212:213], v[212:213], v[204:205], v[202:203] op_sel_hi:[1,0,0] neg_lo:[0,0,1] neg_hi:[0,0,1]
    v_pk_fma_f32 v[214:215], v[214:215], v[204:205], v[202:203] op_sel_hi:[1,0,0] neg_lo:[0,0,1] neg_hi:[0,0,1]
    v_cvt_pk_bf16_f32 v124, v208, v209
    v_cvt_pk_bf16_f32 v125, v210, v211
    v_cvt_pk_bf16_f32 v126, v212, v213
    v_cvt_pk_bf16_f32 v127, v214, v215
    v_lshrrev_b32 v10, 5, v1
    v_lshlrev_b32 v10, 9, v10
    s_mov_b32 s72, 57344
    v_add3_u32 v10, v10, v5, s72
    v_add_u32 v11, 256, v10
    v_add_u32 v12, 57344, v10
    v_add_u32 v13, 57344, v11
    buffer_load_dword v251, v3, s[36:39], 0 offen sc1
    s_waitcnt vmcnt(1)
    s_barrier
    ds_read_b64_tr_b16 v[176:177], v10 offset:0
    ds_read_b64_tr_b16 v[178:179], v11 offset:0
    ds_read_b64_tr_b16 v[180:181], v12 offset:0
    ds_read_b64_tr_b16 v[182:183], v13 offset:0
    ds_read_b64_tr_b16 v[184:185], v10 offset:1024
    ds_read_b64_tr_b16 v[186:187], v11 offset:1024
    ds_read_b64_tr_b16 v[188:189], v12 offset:1024
    ds_read_b64_tr_b16 v[190:191], v13 offset:1024
    ds_read_b64_tr_b16 v[192:193], v10 offset:2048
    ds_read_b64_tr_b16 v[194:195], v11 offset:2048
    s_waitcnt lgkmcnt(8)
    v_mfma_f32_32x32x16_bf16 v[128:143], v[176:179], v[16:19], 0
    s_mul_i32 s75, s76, 172032
    s_add_u32 s75, s75, s100
    s_lshl_b32 s77, s76, 12
    s_add_u32 m0, s77, s101
    s_waitcnt lgkmcnt(4)
    ds_read_b64_tr_b16 v[196:197], v12 offset:2048
    ds_read_b64_tr_b16 v[198:199], v13 offset:2048
    v_mfma_f32_32x32x16_bf16 v[160:175], v[16:19], v[180:183], 0
    buffer_load_dwordx4 v252, s[8:11], s75 offen  lds
    ds_read_b64_tr_b16 v[176:177], v10 offset:3072
    ds_read_b64_tr_b16 v[178:179], v11 offset:3072
    v_mfma_f32_32x32x16_bf16 v[128:143], v[184:187], v[20:23], v[128:143]
    s_waitcnt lgkmcnt(4)
    ds_read_b64_tr_b16 v[180:181], v12 offset:3072
    ds_read_b64_tr_b16 v[182:183], v13 offset:3072
    v_mfma_f32_32x32x16_bf16 v[160:175], v[20:23], v[188:191], v[160:175]
    ds_read_b64_tr_b16 v[184:185], v10 offset:4096
    ds_read_b64_tr_b16 v[186:187], v11 offset:4096
    v_mfma_f32_32x32x16_bf16 v[128:143], v[192:195], v[24:27], v[128:143]
    s_waitcnt lgkmcnt(4)
    ds_read_b64_tr_b16 v[188:189], v12 offset:4096
    ds_read_b64_tr_b16 v[190:191], v13 offset:4096
    v_mfma_f32_32x32x16_bf16 v[160:175], v[24:27], v[196:199], v[160:175]
    ds_read_b64_tr_b16 v[192:193], v10 offset:5120
    ds_read_b64_tr_b16 v[194:195], v11 offset:5120
    v_mfma_f32_32x32x16_bf16 v[128:143], v[176:179], v[28:31], v[128:143]
    s_waitcnt lgkmcnt(4)
    ds_read_b64_tr_b16 v[196:197], v12 offset:5120
    ds_read_b64_tr_b16 v[198:199], v13 offset:5120
    v_mfma_f32_32x32x16_bf16 v[160:175], v[28:31], v[180:183], v[160:175]
    s_add_u32 s75, s75, 172032
    s_add_u32 m0, m0, 4096
    s_cmp_eq_u32 s62, 1
    s_cselect_b32 s75, s100, s75
    s_cselect_b32 m0, s101, m0
    ds_read_b64_tr_b16 v[176:177], v10 offset:6144
    ds_read_b64_tr_b16 v[178:179], v11 offset:6144
    v_mfma_f32_32x32x16_bf16 v[128:143], v[184:187], v[32:35], v[128:143]
    buffer_load_dwordx4 v252, s[8:11], s75 offen  lds
    s_waitcnt lgkmcnt(4)
    ds_read_b64_tr_b16 v[180:181], v12 offset:6144
    ds_read_b64_tr_b16 v[182:183], v13 offset:6144
    v_mfma_f32_32x32x16_bf16 v[160:175], v[32:35], v[188:191], v[160:175]
    ds_read_b64_tr_b16 v[184:185], v10 offset:7168
    ds_read_b64_tr_b16 v[186:187], v11 offset:7168
    v_mfma_f32_32x32x16_bf16 v[128:143], v[192:195], v[36:39], v[128:143]
    s_waitcnt lgkmcnt(4)
    ds_read_b64_tr_b16 v[188:189], v12 offset:7168
    ds_read_b64_tr_b16 v[190:191], v13 offset:7168
    v_mfma_f32_32x32x16_bf16 v[160:175], v[36:39], v[196:199], v[160:175]
    ds_read_b64_tr_b16 v[192:193], v10 offset:8192
    ds_read_b64_tr_b16 v[194:195], v11 offset:8192
    v_mfma_f32_32x32x16_bf16 v[128:143], v[176:179], v[40:43], v[128:143]
    s_waitcnt lgkmcnt(4)
    ds_read_b64_tr_b16 v[196:197], v12 offset:8192
    ds_read_b64_tr_b16 v[198:199], v13 offset:8192
    v_mfma_f32_32x32x16_bf16 v[160:175], v[40:43], v[180:183], v[160:175]
    ds_read_b64_tr_b16 v[176:177], v10 offset:9216
    ds_read_b64_tr_b16 v[178:179], v11 offset:9216
    v_mfma_f32_32x32x16_bf16 v[128:143], v[184:187], v[44:47], v[128:143]
    s_add_u32 s75, s75, 172032
    s_add_u32 m0, m0, 4096
    s_cmp_eq_u32 s62, 2
    s_cselect_b32 s75, s100, s75
    s_cselect_b32 m0, s101, m0
    s_waitcnt lgkmcnt(4)
    ds_read_b64_tr_b16 v[180:181], v12 offset:9216
    ds_read_b64_tr_b16 v[182:183], v13 offset:9216
    v_mfma_f32_32x32x16_bf16 v[160:175], v[44:47], v[188:191], v[160:175]
    buffer_load_dwordx4 v252, s[8:11], s75 offen  lds
    ds_read_b64_tr_b16 v[184:185], v10 offset:10240
    ds_read_b64_tr_b16 v[186:187], v11 offset:10240
    v_mfma_f32_32x32x16_bf16 v[128:143], v[192:195], v[48:51], v[128:143]
    s_waitcnt lgkmcnt(4)
    ds_read_b64_tr_b16 v[188:189], v12 offset:10240
    ds_read_b64_tr_b16 v[190:191], v13 offset:10240
    v_mfma_f32_32x32x16_bf16 v[160:175], v[48:51], v[196:199], v[160:175]
    ds_read_b64_tr_b16 v[192:193], v10 offset:11264
    ds_read_b64_tr_b16 v[194:195], v11 offset:11264
    v_mfma_f32_32x32x16_bf16 v[128:143], v[176:179], v[52:55], v[128:143]
    s_waitcnt lgkmcnt(4)
    ds_read_b64_tr_b16 v[196:197], v12 offset:11264
    ds_read_b64_tr_b16 v[198:199], v13 offset:11264
    v_mfma_f32_32x32x16_bf16 v[160:175], v[52:55], v[180:183], v[160:175]
    ds_read_b64_tr_b16 v[176:177], v10 offset:12288
    ds_read_b64_tr_b16 v[178:179], v11 offset:12288
    v_mfma_f32_32x32x16_bf16 v[128:143], v[184:187], v[56:59], v[128:143]
    s_waitcnt lgkmcnt(4)
    ds_read_b64_tr_b16 v[180:181], v12 offset:12288
    ds_read_b64_tr_b16 v[182:183], v13 offset:12288
    v_mfma_f32_32x32x16_bf16 v[160:175], v[56:59], v[188:191], v[160:175]
    s_add_u32 s75, s75, 172032
    s_add_u32 m0, m0, 4096
    s_cmp_eq_u32 s62, 3
    s_cselect_b32 s75, s100, s75
    s_cselect_b32 m0, s101, m0
    ds_read_b64_tr_b16 v[184:185], v10 offset:13312
    ds_read_b64_tr_b16 v[186:187], v11 offset:13312
    v_mfma_f32_32x32x16_bf16 v[128:143], v[192:195], v[60:63], v[128:143]
    buffer_load_dwordx4 v252, s[8:11], s75 offen  lds
    s_waitcnt lgkmcnt(4)
    ds_read_b64_tr_b16 v[188:189], v12 offset:13312
    ds_read_b64_tr_b16 v[190:191], v13 offset:13312
    v_mfma_f32_32x32x16_bf16 v[160:175], v[60:63], v[196:199], v[160:175]
    ds_read_b64_tr_b16 v[192:193], v10 offset:14336
    ds_read_b64_tr_b16 v[194:195], v11 offset:14336
    v_mfma_f32_32x32x16_bf16 v[128:143], v[176:179], v[64:67], v[128:143]
    s_waitcnt lgkmcnt(4)
    ds_read_b64_tr_b16 v[196:197], v12 offset:14336
    ds_read_b64_tr_b16 v[198:199], v13 offset:14336
    v_mfma_f32_32x32x16_bf16 v[160:175], v[64:67], v[180:183], v[160:175]
    ds_read_b64_tr_b16 v[176:177], v10 offset:15360
    ds_read_b64_tr_b16 v[178:179], v11 offset:15360
    v_mfma_f32_32x32x16_bf16 v[128:143], v[184:187], v[68:71], v[128:143]
    s_waitcnt lgkmcnt(4)
    ds_read_b64_tr_b16 v[180:181], v12 offset:15360
    ds_read_b64_tr_b16 v[182:183], v13 offset:15360
    v_mfma_f32_32x32x16_bf16 v[160:175], v[68:71], v[188:191], v[160:175]
    ds_read_b64_tr_b16 v[184:185], v10 offset:16384
    ds_read_b64_tr_b16 v[186:187], v11 offset:16384
    v_mfma_f32_32x32x16_bf16 v[128:143], v[192:195], v[72:75], v[128:143]
    s_add_u32 s75, s75, 172032
    s_add_u32 m0, m0, 4096
    s_cmp_eq_u32 s62, 4
    s_cselect_b32 s75, s100, s75
    s_cselect_b32 m0, s101, m0
    s_waitcnt lgkmcnt(4)
    ds_read_b64_tr_b16 v[188:189], v12 offset:16384
    ds_read_b64_tr_b16 v[190:191], v13 offset:16384
    v_mfma_f32_32x32x16_bf16 v[160:175], v[72:75], v[196:199], v[160:175]
    buffer_load_dwordx4 v252, s[8:11], s75 offen  lds
    ds_read_b64_tr_b16 v[192:193], v10 offset:17408
    ds_read_b64_tr_b16 v[194:195], v11 offset:17408
    v_mfma_f32_32x32x16_bf16 v[128:143], v[176:179], v[76:79], v[128:143]
    s_waitcnt lgkmcnt(4)
    ds_read_b64_tr_b16 v[196:197], v12 offset:17408
    ds_read_b64_tr_b16 v[198:199], v13 offset:17408
    v_mfma_f32_32x32x16_bf16 v[160:175], v[76:79], v[180:183], v[160:175]
    ds_read_b64_tr_b16 v[176:177], v10 offset:18432
    ds_read_b64_tr_b16 v[178:179], v11 offset:18432
    v_mfma_f32_32x32x16_bf16 v[128:143], v[184:187], v[80:83], v[128:143]
    s_waitcnt lgkmcnt(4)
    ds_read_b64_tr_b16 v[180:181], v12 offset:18432
    ds_read_b64_tr_b16 v[182:183], v13 offset:18432
    v_mfma_f32_32x32x16_bf16 v[160:175], v[80:83], v[188:191], v[160:175]
    ds_read_b64_tr_b16 v[184:185], v10 offset:19456
    ds_read_b64_tr_b16 v[186:187], v11 offset:19456
    v_mfma_f32_32x32x16_bf16 v[128:143], v[192:195], v[84:87], v[128:143]
    s_waitcnt lgkmcnt(4)
    ds_read_b64_tr_b16 v[188:189], v12 offset:19456
    ds_read_b64_tr_b16 v[190:191], v13 offset:19456
    v_mfma_f32_32x32x16_bf16 v[160:175], v[84:87], v[196:199], v[160:175]
    s_add_u32 s75, s75, 172032
    s_add_u32 m0, m0, 4096
    s_cmp_eq_u32 s62, 5
    s_cselect_b32 s75, s100, s75
    s_cselect_b32 m0, s101, m0
    ds_read_b64_tr_b16 v[192:193], v10 offset:20480
    ds_read_b64_tr_b16 v[194:195], v11 offset:20480
    v_mfma_f32_32x32x16_bf16 v[128:143], v[176:179], v[88:91], v[128:143]
    buffer_load_dwordx4 v252, s[8:11], s75 offen  lds
    s_waitcnt lgkmcnt(4)
    ds_read_b64_tr_b16 v[196:197], v12 offset:20480
    ds_read_b64_tr_b16 v[198:199], v13 offset:20480
    v_mfma_f32_32x32x16_bf16 v[160:175], v[88:91], v[180:183], v[160:175]
    ds_read_b64_tr_b16 v[176:177], v10 offset:21504
    ds_read_b64_tr_b16 v[178:179], v11 offset:21504
    v_mfma_f32_32x32x16_bf16 v[128:143], v[184:187], v[92:95], v[128:143]
    s_waitcnt lgkmcnt(4)
    ds_read_b64_tr_b16 v[180:181], v12 offset:21504
    ds_read_b64_tr_b16 v[182:183], v13 offset:21504
    v_mfma_f32_32x32x16_bf16 v[160:175], v[92:95], v[188:191], v[160:175]
    ds_read_b64_tr_b16 v[184:185], v10 offset:22528
    ds_read_b64_tr_b16 v[186:187], v11 offset:22528
    v_mfma_f32_32x32x16_bf16 v[128:143], v[192:195], v[96:99], v[128:143]
    s_waitcnt lgkmcnt(4)
    ds_read_b64_tr_b16 v[188:189], v12 offset:22528
    ds_read_b64_tr_b16 v[190:191], v13 offset:22528
    v_mfma_f32_32x32x16_bf16 v[160:175], v[96:99], v[196:199], v[160:175]
    ds_read_b64_tr_b16 v[192:193], v10 offset:23552
    ds_read_b64_tr_b16 v[194:195], v11 offset:23552
    v_mfma_f32_32x32x16_bf16 v[128:143], v[176:179], v[100:103], v[128:143]
    s_add_u32 s75, s75, 172032
    s_add_u32 m0, m0, 4096
    s_cmp_eq_u32 s62, 6
    s_cselect_b32 s75, s100, s75
    s_cselect_b32 m0, s101, m0
    s_waitcnt lgkmcnt(4)
    ds_read_b64_tr_b16 v[196:197], v12 offset:23552
    ds_read_b64_tr_b16 v[198:199], v13 offset:23552
    v_mfma_f32_32x32x16_bf16 v[160:175], v[100:103], v[180:183], v[160:175]
    buffer_load_dwordx4 v252, s[8:11], s75 offen  lds
    ds_read_b64_tr_b16 v[176:177], v10 offset:24576
    ds_read_b64_tr_b16 v[178:179], v11 offset:24576
    v_mfma_f32_32x32x16_bf16 v[128:143], v[184:187], v[104:107], v[128:143]
    s_waitcnt lgkmcnt(4)
    ds_read_b64_tr_b16 v[180:181], v12 offset:24576
    ds_read_b64_tr_b16 v[182:183], v13 offset:24576
    v_mfma_f32_32x32x16_bf16 v[160:175], v[104:107], v[188:191], v[160:175]
    ds_read_b64_tr_b16 v[184:185], v10 offset:25600
    ds_read_b64_tr_b16 v[186:187], v11 offset:25600
    v_mfma_f32_32x32x16_bf16 v[128:143], v[192:195], v[108:111], v[128:143]
    s_waitcnt lgkmcnt(4)
    ds_read_b64_tr_b16 v[188:189], v12 offset:25600
    ds_read_b64_tr_b16 v[190:191], v13 offset:25600
    v_mfma_f32_32x32x16_bf16 v[160:175], v[108:111], v[196:199], v[160:175]
    ds_read_b64_tr_b16 v[192:193], v10 offset:26624
    ds_read_b64_tr_b16 v[194:195], v11 offset:26624
    v_mfma_f32_32x32x16_bf16 v[128:143], v[176:179], v[112:115], v[128:143]
    s_waitcnt lgkmcnt(4)
    ds_read_b64_tr_b16 v[196:197], v12 offset:26624
    ds_read_b64_tr_b16 v[198:199], v13 offset:26624
    v_mfma_f32_32x32x16_bf16 v[160:175], v[112:115], v[180:183], v[160:175]
    ds_read_b64_tr_b16 v[176:177], v10 offset:27648
    ds_read_b64_tr_b16 v[178:179], v11 offset:27648
    v_mfma_f32_32x32x16_bf16 v[128:143], v[184:187], v[116:119], v[128:143]
    s_waitcnt lgkmcnt(4)
    ds_read_b64_tr_b16 v[180:181], v12 offset:27648
    ds_read_b64_tr_b16 v[182:183], v13 offset:27648
    v_mfma_f32_32x32x16_bf16 v[160:175], v[116:119], v[188:191], v[160:175]
    v_mfma_f32_32x32x16_bf16 v[128:143], v[192:195], v[120:123], v[128:143]
    s_waitcnt lgkmcnt(2)
    v_mfma_f32_32x32x16_bf16 v[160:175], v[120:123], v[196:199], v[160:175]
    v_mfma_f32_32x32x16_bf16 v[128:143], v[176:179], v[124:127], v[128:143]
    s_waitcnt lgkmcnt(0)
    v_mfma_f32_32x32x16_bf16 v[160:175], v[124:127], v[180:183], v[160:175]
    s_waitcnt vmcnt(0)
    v_lshrrev_b32 v250, 4, v251
    v_and_b32 v250, 0x07070707, v250
    v_and_b32 v249, 0x07070707, v251
    v_add_u32 v250, v250, v249
    v_sad_u8 v250, v250, 0, 0
    v_cmp_gt_u32 vcc, 4, v250
    s_cbranch_vccz L_chk_4
    s_mov_b32 s73, 0
L_ip_5_loop:
    buffer_load_dword v251, v3, s[36:39], 0 offen sc1
    s_add_u32 s73, s73, 1
    s_cmp_gt_u32 s73, 0x40000
    s_cbranch_scc1 L_ip_5_out
    s_waitcnt vmcnt(0)
    v_lshrrev_b32 v250, 4, v251
    v_and_b32 v250, 0x07070707, v250
    v_and_b32 v249, 0x07070707, v251
    v_add_u32 v250, v250, v249
    v_sad_u8 v250, v250, 0, 0
    v_cmp_gt_u32 vcc, 4, v250
    s_cbranch_vccnz L_ip_5_loop
L_ip_5_out:
    s_waitcnt vmcnt(0)
L_chk_4:
    s_getreg_b32 s73, hwreg(HW_REG_XCC_ID, 0, 3)
    s_lshl_b32 s73, s73, 2
    s_lshl_b32 s73, 4, s73
    v_and_b32 v250, 0x77777777, v251
    v_cmp_ne_u32 vcc, s73, v250
    s_mov_b32 s86, 0x01010101
    s_mov_b32 s87, 0x01010101
    s_lshl_b64 s[86:87], s[86:87], s45
    s_and_b64 s[86:87], s[86:87], vcc
    s_cselect_b32 s63, 0, 1
    v_cmp_lt_u32 vcc, 0xffff, v250
    s_nop 0
    s_and_b32 s67, vcc_lo, 0xff
    v_and_b32 v250, 0x8, v251
    v_cmp_ne_u32 vcc, 0, v250
    s_nop 0
    s_bcnt1_i32_b64 s74, vcc
    v_and_b32 v250, 0x80, v251
    v_cmp_ne_u32 vcc, 0, v250
    s_nop 0
    s_bcnt1_i32_b64 s75, vcc
    s_xor_b32 s73, s67, 0xff
    s_cmp_gt_u32 s74, s75
    s_cselect_b32 s67, s73, s67
    s_lshr_b32 s69, s67, s45
    s_and_b32 s69, s69, 1
    s_lshl_b32 s69, s69, 13
    s_add_u32 s71, s71, s69
    s_add_u32 s66, s66, s69
    s_add_u32 s68, s68, s69
    s_add_u32 s70, s70, s69
    s_lshr_b32 s73, s50, 1
    s_lshr_b32 s73, s67, s73
    s_and_b32 s73, s73, 1
    s_lshl_b32 s73, s73, 13
    s_add_u32 s64, s64, s73
    s_add_u32 s65, s65, s73
    s_barrier
    s_lshl_b32 s98, s51, 2
    s_add_u32 s98, s98, s44
    s_cmp_ge_u32 s98, 42
    s_cbranch_scc1 L_dump_6_a
    s_lshl_b32 s99, s98, 11
    s_add_u32 s99, s99, 57344
    v_add_u32 v240, s99, v2
    ds_read_b128 v[232:235], v240
    ds_read_b128 v[236:239], v240 offset:1024
L_dump_6_a:
    ds_read_b64_tr_b16 v[176:177], v10 offset:28672
    ds_read_b64_tr_b16 v[178:179], v11 offset:28672
    ds_read_b64_tr_b16 v[180:181], v10 offset:29696
    ds_read_b64_tr_b16 v[182:183], v11 offset:29696
    ds_read_b64_tr_b16 v[184:185], v10 offset:30720
    ds_read_b64_tr_b16 v[186:187], v11 offset:30720
    ds_read_b64_tr_b16 v[188:189], v10 offset:31744
    ds_read_b64_tr_b16 v[190:191], v11 offset:31744
    ds_read_b64_tr_b16 v[192:193], v10 offset:32768
    ds_read_b64_tr_b16 v[194:195], v11 offset:32768
    s_waitcnt lgkmcnt(8)
    v_mfma_f32_32x32x16_bf16 v[144:159], v[176:179], v[16:19], 0
    s_mov_b64 s[86:87], 0
    v_and_b32 v200, 31, v1
    v_cmp_eq_u32 vcc, 28, v200
    s_lshr_b32 s78, s50, 1
    s_waitcnt lgkmcnt(4)
    ds_read_b64_tr_b16 v[196:197], v10 offset:33792
    ds_read_b64_tr_b16 v[198:199], v11 offset:33792
    v_mfma_f32_32x32x16_bf16 v[144:159], v[180:183], v[20:23], v[144:159]
    v_mov_b32 v207, s88
    s_lshr_b32 s78, s67, s78
    s_and_b32 s78, s78, 1
    s_lshl_b32 s78, s78, 13
    ds_read_b64_tr_b16 v[176:177], v10 offset:34816
    ds_read_b64_tr_b16 v[178:179], v11 offset:34816
    v_mfma_f32_32x32x16_bf16 v[144:159], v[184:187], v[24:27], v[144:159]
    s_cmp_ge_u32 s98, 42
    s_cbranch_scc1 L_dump_6_b
    s_mul_i32 s99, s98, 37
    s_lshr_b32 s99, s99, 9
    s_mul_i32 s100, s99, 14
    s_sub_u32 s98, s98, s100
    s_lshl_b32 s99, s99, 2
    s_lshr_b32 s100, s98, 2
    s_add_u32 s99, s99, s100
    s_lshl_b32 s100, s50, 4
    s_add_u32 s99, s99, s100
    s_lshl_b32 s99, s99, 14
    s_and_b32 s98, s98, 3
    s_lshl_b32 s98, s98, 11
    s_add_u32 s99, s99, s98
    s_add_u32 s99, s99, 138412032
    s_add_u32 s100, s99, 8192
    buffer_store_dwordx4 v[232:235], v2, s[40:43], s99 offen sc1
    buffer_store_dwordx4 v[236:239], v2, s[40:43], s99 offen offset:1024 sc1
    buffer_store_dwordx4 v[232:235], v2, s[40:43], s100 offen sc1
    buffer_store_dwordx4 v[236:239], v2, s[40:43], s100 offen offset:1024 sc1
L_dump_6_b:
    s_waitcnt lgkmcnt(4)
    ds_read_b64_tr_b16 v[180:181], v10 offset:35840
    ds_read_b64_tr_b16 v[182:183], v11 offset:35840
    v_mfma_f32_32x32x16_bf16 v[144:159], v[188:191], v[28:31], v[144:159]
    v_cndmask_b32 v207, 0, v207, vcc
    s_lshl_b32 s79, s50, 5
    s_lshr_b32 s73, s49, 1
    s_add_u32 s79, s79, s73
    ds_read_b64_tr_b16 v[184:185], v10 offset:36864
    ds_read_b64_tr_b16 v[186:187], v11 offset:36864
    v_mfma_f32_32x32x16_bf16 v[144:159], v[192:195], v[32:35], v[144:159]
    s_lshl_b32 s79, s79, 14
    s_and_b32 s73, s44, 1
    s_lshl_b32 s73, s73, 12
    s_add_u32 s79, s79, s73
    s_waitcnt lgkmcnt(4)
    ds_read_b64_tr_b16 v[188:189], v10 offset:37888
    ds_read_b64_tr_b16 v[190:191], v11 offset:37888
    v_mfma_f32_32x32x16_bf16 v[144:159], v[196:199], v[36:39], v[144:159]
    s_add_u32 s79, s79, s48
    s_add_u32 s79, s79, 4194304
    ds_read_b64_tr_b16 v[192:193], v10 offset:38912
    ds_read_b64_tr_b16 v[194:195], v11 offset:38912
    v_mfma_f32_32x32x16_bf16 v[144:159], v[176:179], v[40:43], v[144:159]
    s_lshr_b32 s73, s79, 8
    s_xor_b32 s73, s73, s78
    s_and_b32 s73, s73, 0x2000
    s_or_b32 s79, s79, s73
    s_waitcnt lgkmcnt(4)
    ds_read_b64_tr_b16 v[196:197], v10 offset:39936
    ds_read_b64_tr_b16 v[198:199], v11 offset:39936
    v_mfma_f32_32x32x16_bf16 v[144:159], v[180:183], v[44:47], v[144:159]
    s_lshl_b32 s73, s50, 4
    s_add_u32 s73, s73, s51
    s_lshl_b32 s73, s73, 14
    s_add_u32 s73, s73, s48
    ds_read_b64_tr_b16 v[176:177], v10 offset:40960
    ds_read_b64_tr_b16 v[178:179], v11 offset:40960
    v_mfma_f32_32x32x16_bf16 v[144:159], v[184:187], v[48:51], v[144:159]
    s_lshr_b32 s96, s73, 8
    s_xor_b32 s96, s96, s78
    s_and_b32 s96, s96, 0x2000
    s_or_b32 s73, s73, s96
    s_waitcnt lgkmcnt(4)
    ds_read_b64_tr_b16 v[180:181], v10 offset:41984
    ds_read_b64_tr_b16 v[182:183], v11 offset:41984
    v_mfma_f32_32x32x16_bf16 v[144:159], v[188:191], v[52:55], v[144:159]
    s_lshl_b32 s96, s44, 11
    s_add_u32 s73, s73, s96
    v_mov_b32 v200, s88
    v_mov_b32 v201, 0x3f80
    ds_read_b64_tr_b16 v[184:185], v10 offset:43008
    ds_read_b64_tr_b16 v[186:187], v11 offset:43008
    v_mfma_f32_32x32x16_bf16 v[144:159], v[192:195], v[56:59], v[144:159]
    v_cvt_pk_bf16_f32 v208, v128, v129
    v_cvt_pk_bf16_f32 v209, v130, v131
    v_cvt_pk_bf16_f32 v210, v132, v133
    s_waitcnt lgkmcnt(4)
    ds_read_b64_tr_b16 v[188:189], v10 offset:44032
    ds_read_b64_tr_b16 v[190:191], v11 offset:44032
    v_mfma_f32_32x32x16_bf16 v[144:159], v[196:199], v[60:63], v[144:159]
    v_cvt_pk_bf16_f32 v211, v134, v135
    ds_read_b64_tr_b16 v[192:193], v10 offset:45056
    ds_read_b64_tr_b16 v[194:195], v11 offset:45056
    v_mfma_f32_32x32x16_bf16 v[144:159], v[176:179], v[64:67], v[144:159]
    buffer_store_dwordx4 v[208:211], v2, s[40:43], s79 offen offset:0 sc1
    s_waitcnt lgkmcnt(4)
    ds_read_b64_tr_b16 v[196:197], v10 offset:46080
    ds_read_b64_tr_b16 v[198:199], v11 offset:46080
    v_mfma_f32_32x32x16_bf16 v[144:159], v[180:183], v[68:71], v[144:159]
    v_cvt_pk_bf16_f32 v212, v136, v137
    v_cvt_pk_bf16_f32 v213, v138, v139
    v_cvt_pk_bf16_f32 v214, v140, v141
    ds_read_b64_tr_b16 v[176:177], v10 offset:47104
    ds_read_b64_tr_b16 v[178:179], v11 offset:47104
    v_mfma_f32_32x32x16_bf16 v[144:159], v[184:187], v[72:75], v[144:159]
    v_cndmask_b32 v214, v214, v200, s[82:83]
    v_cvt_pk_bf16_f32 v215, v142, v143
    v_cndmask_b32 v215, v215, v201, s[82:83]
    s_waitcnt lgkmcnt(4)
    ds_read_b64_tr_b16 v[180:181], v10 offset:48128
    ds_read_b64_tr_b16 v[182:183], v11 offset:48128
    v_mfma_f32_32x32x16_bf16 v[144:159], v[188:191], v[76:79], v[144:159]
    buffer_store_dwordx4 v[212:215], v2, s[40:43], s79 offen offset:1024 sc1
    ds_read_b64_tr_b16 v[184:185], v10 offset:49152
    ds_read_b64_tr_b16 v[186:187], v11 offset:49152
    v_mfma_f32_32x32x16_bf16 v[144:159], v[192:195], v[80:83], v[144:159]
    v_cvt_pk_bf16_f32 v160, v160, v161
    v_cndmask_b32 v160, v160, v207, s[84:85]
    v_cvt_pk_bf16_f32 v161, v162, v163
    s_waitcnt lgkmcnt(4)
    ds_read_b64_tr_b16 v[188:189], v10 offset:50176
    ds_read_b64_tr_b16 v[190:191], v11 offset:50176
    v_mfma_f32_32x32x16_bf16 v[144:159], v[196:199], v[84:87], v[144:159]
    v_cndmask_b32 v161, v161, v207, s[84:85]
    v_cvt_pk_bf16_f32 v162, v164, v165
    v_cndmask_b32 v162, v162, v207, s[84:85]
    ds_read_b64_tr_b16 v[192:193], v10 offset:51200
    ds_read_b64_tr_b16 v[194:195], v11 offset:51200
    v_mfma_f32_32x32x16_bf16 v[144:159], v[176:179], v[88:91], v[144:159]
    v_cvt_pk_bf16_f32 v163, v166, v167
    v_cndmask_b32 v163, v163, v207, s[84:85]
    s_waitcnt lgkmcnt(4)
    ds_read_b64_tr_b16 v[196:197], v10 offset:52224
    ds_read_b64_tr_b16 v[198:199], v11 offset:52224
    v_mfma_f32_32x32x16_bf16 v[144:159], v[180:183], v[92:95], v[144:159]
    buffer_store_dwordx4 v[160:163], v2, s[40:43], s79 offen offset:2048 sc1
    ds_read_b64_tr_b16 v[176:177], v10 offset:53248
    ds_read_b64_tr_b16 v[178:179], v11 offset:53248
    v_mfma_f32_32x32x16_bf16 v[144:159], v[184:187], v[96:99], v[144:159]
    v_cvt_pk_bf16_f32 v164, v168, v169
    v_cndmask_b32 v164, v164, v207, s[84:85]
    v_cvt_pk_bf16_f32 v165, v170, v171
    s_waitcnt lgkmcnt(4)
    ds_read_b64_tr_b16 v[180:181], v10 offset:54272
    ds_read_b64_tr_b16 v[182:183], v11 offset:54272
    v_mfma_f32_32x32x16_bf16 v[144:159], v[188:191], v[100:103], v[144:159]
    v_cndmask_b32 v165, v165, v207, s[84:85]
    v_cvt_pk_bf16_f32 v166, v172, v173
    v_cndmask_b32 v166, v166, v207, s[84:85]
    ds_read_b64_tr_b16 v[184:185], v10 offset:55296
    ds_read_b64_tr_b16 v[186:187], v11 offset:55296
    v_mfma_f32_32x32x16_bf16 v[144:159], v[192:195], v[104:107], v[144:159]
    v_cvt_pk_bf16_f32 v167, v174, v175
    v_cndmask_b32 v167, v167, v207, s[84:85]
    s_waitcnt lgkmcnt(4)
    ds_read_b64_tr_b16 v[188:189], v10 offset:56320
    ds_read_b64_tr_b16 v[190:191], v11 offset:56320
    v_mfma_f32_32x32x16_bf16 v[144:159], v[196:199], v[108:111], v[144:159]
    buffer_store_dwordx4 v[164:167], v2, s[40:43], s79 offen offset:3072 sc1
    v_mul_f32 v216, v128, v128
    v_mul_f32 v217, v129, v129
    v_mfma_f32_32x32x16_bf16 v[144:159], v[176:179], v[112:115], v[144:159]
    v_mul_f32 v218, v140, v140
    v_fmac_f32 v216, v130, v130
    v_fmac_f32 v217, v131, v131
    v_fmac_f32 v216, v132, v132
    v_fmac_f32 v217, v133, v133
    s_waitcnt lgkmcnt(2)
    v_mfma_f32_32x32x16_bf16 v[144:159], v[180:183], v[116:119], v[144:159]
    v_fmac_f32 v216, v134, v134
    v_fmac_f32 v217, v135, v135
    v_fmac_f32 v216, v136, v136
    v_fmac_f32 v217, v137, v137
    v_fmac_f32 v216, v138, v138
    v_mfma_f32_32x32x16_bf16 v[144:159], v[184:187], v[120:123], v[144:159]
    v_fmac_f32 v217, v139, v139
    v_fmac_f32 v218, v141, v141
    v_fmac_f32 v218, v142, v142
    v_fmac_f32 v218, v143, v143
    v_add_f32 v216, v216, v217
    s_waitcnt lgkmcnt(0)
    v_mfma_f32_32x32x16_bf16 v[144:159], v[188:191], v[124:127], v[144:159]
    v_cndmask_b32 v218, v218, 0, s[82:83]
    v_add_f32 v216, v216, v218
    v_mov_b32 v217, v216
    s_nop 1
    v_permlane32_swap_b32 v216, v217
    v_add_f32_e64 v216, v216, v217
    v_cmp_nge_f32 vcc, s95, v216
    s_nop 0
    s_or_b64 s[86:87], s[86:87], vcc
    s_nop 1
    v_pk_mul_f32 v[144:145], v[144:145], v[206:207] op_sel_hi:[1,0]
    v_pk_mul_f32 v[146:147], v[146:147], v[206:207] op_sel_hi:[1,0]
    v_pk_mul_f32 v[148:149], v[148:149], v[206:207] op_sel_hi:[1,0]
    v_pk_mul_f32 v[150:151], v[150:151], v[206:207] op_sel_hi:[1,0]
    v_pk_mul_f32 v[152:153], v[152:153], v[206:207] op_sel_hi:[1,0]
    v_pk_mul_f32 v[154:155], v[154:155], v[206:207] op_sel_hi:[1,0]
    v_pk_mul_f32 v[156:157], v[156:157], v[206:207] op_sel_hi:[1,0]
    v_pk_mul_f32 v[158:159], v[158:159], v[206:207] op_sel_hi:[1,0]
    v_cvt_pk_bf16_f32 v224, v144, v145
    v_cvt_pk_bf16_f32 v225, v146, v147
    v_cvt_pk_bf16_f32 v226, v148, v149
    v_cvt_pk_bf16_f32 v227, v150, v151
    buffer_store_dwordx4 v[224:227], v2, s[40:43], s73 offen offset:0 sc1
    v_cvt_pk_bf16_f32 v228, v152, v153
    v_cvt_pk_bf16_f32 v229, v154, v155
    v_cvt_pk_bf16_f32 v230, v156, v157
    v_cndmask_b32 v230, v230, 0, s[82:83]
    v_cvt_pk_bf16_f32 v231, v158, v159
    v_cndmask_b32 v231, v231, 0, s[82:83]
    buffer_store_dwordx4 v[228:231], v2, s[40:43], s73 offen offset:1024 sc1
    v_pk_mul_f32 v[216:217], v[144:145], v[144:145]
    v_pk_mul_f32 v[218:219], v[156:157], v[156:157]
    v_pk_fma_f32 v[216:217], v[146:147], v[146:147], v[216:217]
    v_pk_fma_f32 v[216:217], v[148:149], v[148:149], v[216:217]
    v_pk_fma_f32 v[216:217], v[150:151], v[150:151], v[216:217]
    v_pk_fma_f32 v[216:217], v[152:153], v[152:153], v[216:217]
    v_pk_fma_f32 v[216:217], v[154:155], v[154:155], v[216:217]
    v_pk_fma_f32 v[218:219], v[158:159], v[158:159], v[218:219]
    v_add_f32 v216, v216, v217
    v_add_f32 v218, v218, v219
    v_cndmask_b32 v218, v218, 0, s[82:83]
    v_add_f32 v216, v216, v218
    v_mov_b32 v217, v216
    s_nop 1
    v_permlane32_swap_b32 v216, v217
    v_add_f32 v216, v216, v217
    v_cmp_nge_f32 vcc, s3, v216
    s_nop 0
    s_or_b64 s[86:87], s[86:87], vcc
    s_nop 2
    s_branch L_qkv_out
L_qkv1:
    s_lshl_b32 s74, s49, 16
    s_add_u32 s74, s74, 33554432
    s_lshr_b32 s72, s74, 8
    s_xor_b32 s72, s72, s69
    s_and_b32 s72, s72, 0x2000
    s_or_b32 s74, s74, s72
    s_cmp_lg_u32 s44, 0
    s_cbranch_scc1 L_poll_7_done
    s_mov_b64 exec, s[80:81]
    buffer_load_dword a233, v3, s[40:43], s52 offen sc1
    s_mov_b32 s73, 0
L_poll_7_loop:
    s_waitcnt vmcnt(1)
    v_accvgpr_read_b32 v11, a232
    v_cmp_gt_u32 vcc, s57, v11
    s_cbranch_vccz L_poll_7_out
    buffer_load_dword a232, v3, s[40:43], s52 offen sc1
    s_waitcnt vmcnt(1)
    v_accvgpr_read_b32 v11, a233
    v_cmp_gt_u32 vcc, s57, v11
    s_cbranch_vccz L_poll_7_out
    buffer_load_dword a233, v3, s[40:43], s52 offen sc1
    s_add_u32 s73, s73, 1
    s_cmp_lt_u32 s73, 0x20000
    s_cbranch_scc1 L_poll_7_loop
L_poll_7_out:
    s_mov_b64 exec, -1
    s_waitcnt vmcnt(1) lgkmcnt(0)
    s_branch L_poll_7_b
L_poll_7_done:
    s_waitcnt vmcnt(0) lgkmcnt(0)
L_poll_7_b:
    s_barrier
    buffer_load_dwordx4 v[16:19], v2, s[40:43], s74 offen offset:0 sc1
    buffer_load_dwordx4 v[20:23], v2, s[40:43], s74 offen offset:1024 sc1
    buffer_load_dwordx4 v[24:27], v2, s[40:43], s74 offen offset:2048 sc1
    buffer_load_dwordx4 v[28:31], v2, s[40:43], s74 offen offset:3072 sc1
    s_add_u32 s74, s74, 4096
    buffer_load_dwordx4 v[32:35], v2, s[40:43], s74 offen offset:0 sc1
    buffer_load_dwordx4 v[36:39], v2, s[40:43], s74 offen offset:1024 sc1
    buffer_load_dwordx4 v[40:43], v2, s[40:43], s74 offen offset:2048 sc1
    buffer_load_dwordx4 v[44:47], v2, s[40:43], s74 offen offset:3072 sc1
    v_lshrrev_b32 v10, 5, v1
    v_lshlrev_b32_e64 v10, 8, v10
    s_mov_b32 s72, 57344
    v_add3_u32 v10, v10, v5, s72
    v_add_u32 v11, 512, v10
    v_add_u32 v12, 57344, v10
    v_add_u32 v13, 57344, v11
    ds_read_b64_tr_b16 v[176:177], v10 offset:0
    ds_read_b64_tr_b16 v[178:179], v11 offset:0
    ds_read_b64_tr_b16 v[180:181], v12 offset:0
    ds_read_b64_tr_b16 v[182:183], v13 offset:0
    ds_read_b64_tr_b16 v[184:185], v10 offset:1024
    ds_read_b64_tr_b16 v[186:187], v11 offset:1024
    ds_read_b64_tr_b16 v[188:189], v12 offset:1024
    ds_read_b64_tr_b16 v[190:191], v13 offset:1024
    ds_read_b64_tr_b16 v[192:193], v10 offset:2048
    ds_read_b64_tr_b16 v[194:195], v11 offset:2048
    s_waitcnt vmcnt(7) lgkmcnt(8)
    v_mfma_f32_32x32x16_bf16 v[128:143], v[176:179], v[16:19], 0
    s_add_u32 s74, s74, 12288
    buffer_load_dwordx4 v[48:51], v2, s[40:43], s74 offen offset:0 sc1
    s_waitcnt lgkmcnt(4)
    ds_read_b64_tr_b16 v[196:197], v12 offset:2048
    ds_read_b64_tr_b16 v[198:199], v13 offset:2048
    v_mfma_f32_32x32x16_bf16 v[160:175], v[16:19], v[180:183], 0
    s_lshl_b32 s77, s49, 14
    s_add_u32 s77, s77, 56623104
    s_lshr_b32 s72, s77, 8
    s_xor_b32 s72, s72, s69
    s_and_b32 s72, s72, 0x2000
    s_or_b32 s77, s77, s72
    v_lshrrev_b32_e64 v158, 5, v1
    v_mul_u32_u24 v158, 1536, v158
    v_lshl_add_u32 v158, v1, 3, v158
    buffer_load_dwordx2 v[144:145], v158, s[40:43], s77 offen offset:0 sc1
    ds_read_b64_tr_b16 v[176:177], v10 offset:3072
    ds_read_b64_tr_b16 v[178:179], v11 offset:3072
    s_waitcnt vmcnt(8)
    v_mfma_f32_32x32x16_bf16 v[128:143], v[184:187], v[20:23], v[128:143]
    buffer_load_dwordx4 v[52:55], v2, s[40:43], s74 offen offset:1024 sc1
    s_waitcnt lgkmcnt(4)
    ds_read_b64_tr_b16 v[180:181], v12 offset:3072
    ds_read_b64_tr_b16 v[182:183], v13 offset:3072
    v_mfma_f32_32x32x16_bf16 v[160:175], v[20:23], v[188:191], v[160:175]
    buffer_load_dwordx2 v[146:147], v158, s[40:43], s77 offen offset:256 sc1
    ds_read_b64_tr_b16 v[184:185], v10 offset:4096
    ds_read_b64_tr_b16 v[186:187], v11 offset:4096
    s_waitcnt vmcnt(9)
    v_mfma_f32_32x32x16_bf16 v[128:143], v[192:195], v[24:27], v[128:143]
    buffer_load_dwordx4 v[56:59], v2, s[40:43], s74 offen offset:2048 sc1
    s_waitcnt lgkmcnt(4)
    ds_read_b64_tr_b16 v[188:189], v12 offset:4096
    ds_read_b64_tr_b16 v[190:191], v13 offset:4096
    v_mfma_f32_32x32x16_bf16 v[160:175], v[24:27], v[196:199], v[160:175]
    buffer_load_dwordx2 v[148:149], v158, s[40:43], s77 offen offset:512 sc1
    ds_read_b64_tr_b16 v[192:193], v10 offset:5120
    ds_read_b64_tr_b16 v[194:195], v11 offset:5120
    s_waitcnt vmcnt(10)
    v_mfma_f32_32x32x16_bf16 v[128:143], v[176:179], v[28:31], v[128:143]
    buffer_load_dwordx4 v[60:63], v2, s[40:43], s74 offen offset:3072 sc1
    s_waitcnt lgkmcnt(4)
    ds_read_b64_tr_b16 v[196:197], v12 offset:5120
    ds_read_b64_tr_b16 v[198:199], v13 offset:5120
    v_mfma_f32_32x32x16_bf16 v[160:175], v[28:31], v[180:183], v[160:175]
    buffer_load_dwordx2 v[150:151], v158, s[40:43], s77 offen offset:768 sc1
    ds_read_b64_tr_b16 v[176:177], v10 offset:6144
    ds_read_b64_tr_b16 v[178:179], v11 offset:6144
    s_waitcnt vmcnt(11)
    v_mfma_f32_32x32x16_bf16 v[128:143], v[184:187], v[32:35], v[128:143]
    s_add_u32 s74, s74, 4096
    buffer_load_dwordx4 v[64:67], v2, s[40:43], s74 offen offset:0 sc1
    s_waitcnt lgkmcnt(4)
    ds_read_b64_tr_b16 v[180:181], v12 offset:6144
    ds_read_b64_tr_b16 v[182:183], v13 offset:6144
    v_mfma_f32_32x32x16_bf16 v[160:175], v[32:35], v[188:191], v[160:175]
    buffer_load_dwordx2 v[152:153], v158, s[40:43], s77 offen offset:1024 sc1
    ds_read_b64_tr_b16 v[184:185], v10 offset:7168
    ds_read_b64_tr_b16 v[186:187], v11 offset:7168
    s_waitcnt vmcnt(12)
    v_mfma_f32_32x32x16_bf16 v[128:143], v[192:195], v[36:39], v[128:143]
    buffer_load_dwordx4 v[68:71], v2, s[40:43], s74 offen offset:1024 sc1
    s_waitcnt lgkmcnt(4)
    ds_read_b64_tr_b16 v[188:189], v12 offset:7168
    ds_read_b64_tr_b16 v[190:191], v13 offset:7168
    v_mfma_f32_32x32x16_bf16 v[160:175], v[36:39], v[196:199], v[160:175]
    buffer_load_dwordx2 v[154:155], v158, s[40:43], s77 offen offset:1280 sc1
    ds_read_b64_tr_b16 v[192:193], v10 offset:8192
    ds_read_b64_tr_b16 v[194:195], v11 offset:8192
    s_waitcnt vmcnt(13)
    v_mfma_f32_32x32x16_bf16 v[128:143], v[176:179], v[40:43], v[128:143]
    buffer_load_dwordx4 v[72:75], v2, s[40:43], s74 offen offset:2048 sc1
    s_waitcnt lgkmcnt(4)
    ds_read_b64_tr_b16 v[196:197], v12 offset:8192
    ds_read_b64_tr_b16 v[198:199], v13 offset:8192
    v_mfma_f32_32x32x16_bf16 v[160:175], v[40:43], v[180:183], v[160:175]
    buffer_load_dwordx2 v[156:157], v158, s[40:43], s77 offen offset:1536 sc1
    ds_read_b64_tr_b16 v[176:177], v10 offset:9216
    ds_read_b64_tr_b16 v[178:179], v11 offset:9216
    s_waitcnt vmcnt(14)
    v_mfma_f32_32x32x16_bf16 v[128:143], v[184:187], v[44:47], v[128:143]
    buffer_load_dwordx4 v[76:79], v2, s[40:43], s74 offen offset:3072 sc1
    s_waitcnt lgkmcnt(4)
    ds_read_b64_tr_b16 v[180:181], v12 offset:9216
    ds_read_b64_tr_b16 v[182:183], v13 offset:9216
    v_mfma_f32_32x32x16_bf16 v[160:175], v[44:47], v[188:191], v[160:175]
    ds_read_b64_tr_b16 v[184:185], v10 offset:10240
    ds_read_b64_tr_b16 v[186:187], v11 offset:10240
    s_waitcnt vmcnt(14)
    v_mfma_f32_32x32x16_bf16 v[128:143], v[192:195], v[48:51], v[128:143]
    s_add_u32 s74, s74, 12288
    buffer_load_dwordx4 v[80:83], v2, s[40:43], s74 offen offset:0 sc1
    s_waitcnt lgkmcnt(4)
    ds_read_b64_tr_b16 v[188:189], v12 offset:10240
    ds_read_b64_tr_b16 v[190:191], v13 offset:10240
    v_mfma_f32_32x32x16_bf16 v[160:175], v[48:51], v[196:199], v[160:175]
    ds_read_b64_tr_b16 v[192:193], v10 offset:11264
    ds_read_b64_tr_b16 v[194:195], v11 offset:11264
    s_waitcnt vmcnt(13)
    v_mfma_f32_32x32x16_bf16 v[128:143], v[176:179], v[52:55], v[128:143]
    buffer_load_dwordx4 v[84:87], v2, s[40:43], s74 offen offset:1024 sc1
    s_waitcnt lgkmcnt(4)
    ds_read_b64_tr_b16 v[196:197], v12 offset:11264
    ds_read_b64_tr_b16 v[198:199], v13 offset:11264
    v_mfma_f32_32x32x16_bf16 v[160:175], v[52:55], v[180:183], v[160:175]
    ds_read_b64_tr_b16 v[176:177], v10 offset:12288
    ds_read_b64_tr_b16 v[178:179], v11 offset:12288
    s_waitcnt vmcnt(12)
    v_mfma_f32_32x32x16_bf16 v[128:143], v[184:187], v[56:59], v[128:143]
    buffer_load_dwordx4 v[88:91], v2, s[40:43], s74 offen offset:2048 sc1
    s_waitcnt lgkmcnt(4)
    ds_read_b64_tr_b16 v[180:181], v12 offset:12288
    ds_read_b64_tr_b16 v[182:183], v13 offset:12288
    v_mfma_f32_32x32x16_bf16 v[160:175], v[56:59], v[188:191], v[160:175]
    ds_read_b64_tr_b16 v[184:185], v10 offset:13312
    ds_read_b64_tr_b16 v[186:187], v11 offset:13312
    s_waitcnt vmcnt(11)
    v_mfma_f32_32x32x16_bf16 v[128:143], v[192:195], v[60:63], v[128:143]
    buffer_load_dwordx4 v[92:95], v2, s[40:43], s74 offen offset:3072 sc1
    s_waitcnt lgkmcnt(4)
    ds_read_b64_tr_b16 v[188:189], v12 offset:13312
    ds_read_b64_tr_b16 v[190:191], v13 offset:13312
    v_mfma_f32_32x32x16_bf16 v[160:175], v[60:63], v[196:199], v[160:175]
    ds_read_b64_tr_b16 v[192:193], v10 offset:14336
    ds_read_b64_tr_b16 v[194:195], v11 offset:14336
    s_waitcnt vmcnt(10)
    v_mfma_f32_32x32x16_bf16 v[128:143], v[176:179], v[64:67], v[128:143]
    s_add_u32 s74, s74, 4096
    buffer_load_dwordx4 v[96:99], v2, s[40:43], s74 offen offset:0 sc1
    s_waitcnt lgkmcnt(4)
    ds_read_b64_tr_b16 v[196:197], v12 offset:14336
    ds_read_b64_tr_b16 v[198:199], v13 offset:14336
    v_mfma_f32_32x32x16_bf16 v[160:175], v[64:67], v[180:183], v[160:175]
    ds_read_b64_tr_b16 v[176:177], v10 offset:15360
    ds_read_b64_tr_b16 v[178:179], v11 offset:15360
    s_waitcnt vmcnt(9)
    v_mfma_f32_32x32x16_bf16 v[128:143], v[184:187], v[68:71], v[128:143]
    buffer_load_dwordx4 v[100:103], v2, s[40:43], s74 offen offset:1024 sc1
    s_waitcnt lgkmcnt(4)
    ds_read_b64_tr_b16 v[180:181], v12 offset:15360
    ds_read_b64_tr_b16 v[182:183], v13 offset:15360
    v_mfma_f32_32x32x16_bf16 v[160:175], v[68:71], v[188:191], v[160:175]
    ds_read_b64_tr_b16 v[184:185], v10 offset:16384
    ds_read_b64_tr_b16 v[186:187], v11 offset:16384
    s_waitcnt vmcnt(8)
    v_mfma_f32_32x32x16_bf16 v[128:143], v[192:195], v[72:75], v[128:143]
    buffer_load_dwordx4 v[104:107], v2, s[40:43], s74 offen offset:2048 sc1
    s_waitcnt lgkmcnt(4)
    ds_read_b64_tr_b16 v[188:189], v12 offset:16384
    ds_read_b64_tr_b16 v[190:191], v13 offset:16384
    v_mfma_f32_32x32x16_bf16 v[160:175], v[72:75], v[196:199], v[160:175]
    v_add_f32 v144, v144, v146
    v_add_f32 v145, v145, v147
    v_add_f32 v148, v148, v150
    v_add_f32 v149, v149, v151
    ds_read_b64_tr_b16 v[192:193], v10 offset:17408
    ds_read_b64_tr_b16 v[194:195], v11 offset:17408
    s_waitcnt vmcnt(7)
    v_mfma_f32_32x32x16_bf16 v[128:143], v[176:179], v[76:79], v[128:143]
    buffer_load_dwordx4 v[108:111], v2, s[40:43], s74 offen offset:3072 sc1
    s_waitcnt lgkmcnt(4)
    ds_read_b64_tr_b16 v[196:197], v12 offset:17408
    ds_read_b64_tr_b16 v[198:199], v13 offset:17408
    v_mfma_f32_32x32x16_bf16 v[160:175], v[76:79], v[180:183], v[160:175]
    v_add_f32 v152, v152, v154
    v_add_f32 v153, v153, v155
    v_add_f32 v144, v144, v148
    v_add_f32 v145, v145, v149
    ds_read_b64_tr_b16 v[176:177], v10 offset:18432
    ds_read_b64_tr_b16 v[178:179], v11 offset:18432
    s_waitcnt vmcnt(7)
    v_mfma_f32_32x32x16_bf16 v[128:143], v[184:187], v[80:83], v[128:143]
    s_add_u32 s74, s74, 12288
    buffer_load_dwordx4 v[112:115], v2, s[40:43], s74 offen offset:0 sc1
    s_waitcnt lgkmcnt(4)
    ds_read_b64_tr_b16 v[180:181], v12 offset:18432
    ds_read_b64_tr_b16 v[182:183], v13 offset:18432
    v_mfma_f32_32x32x16_bf16 v[160:175], v[80:83], v[188:191], v[160:175]
    v_add_f32 v152, v152, v156
    v_add_f32 v153, v153, v157
    v_add_f32 v144, v144, v152
    v_add_f32 v145, v145, v153
    ds_read_b64_tr_b16 v[184:185], v10 offset:19456
    ds_read_b64_tr_b16 v[186:187], v11 offset:19456
    s_waitcnt vmcnt(7)
    v_mfma_f32_32x32x16_bf16 v[128:143], v[192:195], v[84:87], v[128:143]
    buffer_load_dwordx4 v[116:119], v2, s[40:43], s74 offen offset:1024 sc1
    s_waitcnt lgkmcnt(4)
    ds_read_b64_tr_b16 v[188:189], v12 offset:19456
    ds_read_b64_tr_b16 v[190:191], v13 offset:19456
    v_mfma_f32_32x32x16_bf16 v[160:175], v[84:87], v[196:199], v[160:175]
    v_mov_b32 v200, v144
    v_mov_b32 v201, v145
    s_nop 0
    v_permlane32_swap_b32 v200, v144
    v_permlane32_swap_b32 v201, v145
    ds_read_b64_tr_b16 v[192:193], v10 offset:20480
    ds_read_b64_tr_b16 v[194:195], v11 offset:20480
    s_waitcnt vmcnt(7)
    v_mfma_f32_32x32x16_bf16 v[128:143], v[176:179], v[88:91], v[128:143]
    buffer_load_dwordx4 v[120:123], v2, s[40:43], s74 offen offset:2048 sc1
    s_waitcnt lgkmcnt(4)
    ds_read_b64_tr_b16 v[196:197], v12 offset:20480
    ds_read_b64_tr_b16 v[198:199], v13 offset:20480
    v_mfma_f32_32x32x16_bf16 v[160:175], v[88:91], v[180:183], v[160:175]
    v_add_f32 v200, v200, v144
    v_add_f32 v201, v201, v145
    v_mul_f32 v202, s90, v200
    v_mul_f32 v203, s90, v201
    ds_read_b64_tr_b16 v[176:177], v10 offset:21504
    ds_read_b64_tr_b16 v[178:179], v11 offset:21504
    s_waitcnt vmcnt(7)
    v_mfma_f32_32x32x16_bf16 v[128:143], v[184:187], v[92:95], v[128:143]
    buffer_load_dwordx4 v[124:127], v2, s[40:43], s74 offen offset:3072 sc1
    s_waitcnt lgkmcnt(4)
    ds_read_b64_tr_b16 v[180:181], v12 offset:21504
    ds_read_b64_tr_b16 v[182:183], v13 offset:21504
    v_mfma_f32_32x32x16_bf16 v[160:175], v[92:95], v[188:191], v[160:175]
    v_fma_f32 v203, -v202, v202, v203
    v_max_f32 v203, 0, v203
    v_add_f32 v203, s91, v203
    ds_read_b64_tr_b16 v[184:185], v10 offset:22528
    ds_read_b64_tr_b16 v[186:187], v11 offset:22528
    s_waitcnt vmcnt(7)
    v_mfma_f32_32x32x16_bf16 v[128:143], v[192:195], v[96:99], v[128:143]
    s_lshl_b32 s100, s44, 10
    s_add_u32 m0, s100, 86016
    s_add_u32 s100, s100, 65536
    s_lshl_b32 s99, s50, 18
    s_add_u32 s99, s99, s100
    s_add_u32 s99, s99, 138412032
    s_lshr_b32 s100, s99, 8
    s_xor_b32 s100, s100, s69
    s_and_b32 s100, s100, 0x2000
    s_or_b32 s99, s99, s100
    s_waitcnt lgkmcnt(4)
    ds_read_b64_tr_b16 v[188:189], v12 offset:22528
    ds_read_b64_tr_b16 v[190:191], v13 offset:22528
    v_mfma_f32_32x32x16_bf16 v[160:175], v[96:99], v[196:199], v[160:175]
    buffer_load_dwordx4 v2, s[40:43], s99 offen offset:0 sc1 lds
    ds_read_b64_tr_b16 v[192:193], v10 offset:23552
    ds_read_b64_tr_b16 v[194:195], v11 offset:23552
    s_waitcnt vmcnt(7)
    v_mfma_f32_32x32x16_bf16 v[128:143], v[176:179], v[100:103], v[128:143]
    v_rsq_f32 v204, v203
    s_lshl_b32 s72, s44, 8
    s_add_u32 s72, s72, 143872
    s_waitcnt lgkmcnt(4)
    ds_read_b64_tr_b16 v[196:197], v12 offset:23552
    ds_read_b64_tr_b16 v[198:199], v13 offset:23552
    v_mfma_f32_32x32x16_bf16 v[160:175], v[100:103], v[180:183], v[160:175]
    s_add_u32 s99, s99, 4096
    s_add_u32 m0, m0, 4096
    s_nop 0
    buffer_load_dwordx4 v2, s[40:43], s99 offen offset:0 sc1 lds
    ds_read_b64_tr_b16 v[176:177], v10 offset:24576
    ds_read_b64_tr_b16 v[178:179], v11 offset:24576
    s_waitcnt vmcnt(7)
    v_mfma_f32_32x32x16_bf16 v[128:143], v[184:187], v[104:107], v[128:143]
    v_add_u32 v15, s72, v3
    v_mul_f32 v205, v204, v202
    v_mul_f32_e64 v206, s94, v204
    s_waitcnt lgkmcnt(4)
    ds_read_b64_tr_b16 v[180:181], v12 offset:24576
    ds_read_b64_tr_b16 v[182:183], v13 offset:24576
    v_mfma_f32_32x32x16_bf16 v[160:175], v[104:107], v[188:191], v[160:175]
    s_add_u32 s99, s99, 12288
    s_add_u32 m0, m0, 4096
    s_nop 0
    buffer_load_dwordx4 v2, s[40:43], s99 offen offset:0 sc1 lds
    ds_read_b64_tr_b16 v[184:185], v10 offset:25600
    ds_read_b64_tr_b16 v[186:187], v11 offset:25600
    s_waitcnt vmcnt(7)
    v_mfma_f32_32x32x16_bf16 v[128:143], v[192:195], v[108:111], v[128:143]
    v_cndmask_b32 v200, v204, v205, s[82:83]
    ds_write_b32 v15, v200
    s_waitcnt lgkmcnt(5)
    ds_read_b64_tr_b16 v[188:189], v12 offset:25600
    ds_read_b64_tr_b16 v[190:191], v13 offset:25600
    v_mfma_f32_32x32x16_bf16 v[160:175], v[108:111], v[196:199], v[160:175]
    s_add_u32 s99, s99, 4096
    s_add_u32 m0, m0, 4096
    s_nop 0
    buffer_load_dwordx4 v2, s[40:43], s99 offen offset:0 sc1 lds
    ds_read_b64_tr_b16 v[192:193], v10 offset:26624
    ds_read_b64_tr_b16 v[194:195], v11 offset:26624
    s_waitcnt vmcnt(7)
    v_mfma_f32_32x32x16_bf16 v[128:143], v[176:179], v[112:115], v[128:143]
    v_mul_f32 v202, v206, v202
    v_lshrrev_b32 v14, 5, v1
    v_lshlrev_b32 v14, 4, v14
    v_add_u32 v15, s72, v14
    s_waitcnt lgkmcnt(5)
    ds_read_b64_tr_b16 v[196:197], v12 offset:26624
    ds_read_b64_tr_b16 v[198:199], v13 offset:26624
    v_mfma_f32_32x32x16_bf16 v[160:175], v[112:115], v[180:183], v[160:175]
    s_add_u32 s99, s99, 12288
    s_add_u32 m0, m0, 4096
    s_nop 0
    buffer_load_dwordx4 v2, s[40:43], s99 offen offset:0 sc1 lds
    ds_read_b64_tr_b16 v[176:177], v10 offset:27648
    ds_read_b64_tr_b16 v[178:179], v11 offset:27648
    s_waitcnt vmcnt(7)
    v_mfma_f32_32x32x16_bf16 v[128:143], v[184:187], v[116:119], v[128:143]
    v_add_u32 v14, 143360, v14
    ds_read_b128 v[208:211], v14 offset:0
    s_waitcnt lgkmcnt(5)
    ds_read_b64_tr_b16 v[180:181], v12 offset:27648
    ds_read_b64_tr_b16 v[182:183], v13 offset:27648
    v_mfma_f32_32x32x16_bf16 v[160:175], v[116:119], v[188:191], v[160:175]
    s_add_u32 s99, s99, 4096
    s_add_u32 m0, m0, 4096
    s_nop 0
    buffer_load_dwordx4 v2, s[40:43], s99 offen offset:0 sc1 lds
    s_waitcnt vmcnt(7)
    v_mfma_f32_32x32x16_bf16 v[128:143], v[192:195], v[120:123], v[128:143]
    ds_read_b128 v[212:215], v14 offset:32
    ds_read_b128 v[216:219], v14 offset:64
    s_waitcnt lgkmcnt(5)
    v_mfma_f32_32x32x16_bf16 v[160:175], v[120:123], v[196:199], v[160:175]
    s_add_u32 s99, s99, 12288
    s_add_u32 m0, m0, 4096
    s_nop 0
    buffer_load_dwordx4 v2, s[40:43], s99 offen offset:0 sc1 lds
    s_waitcnt vmcnt(7)
    v_mfma_f32_32x32x16_bf16 v[128:143], v[176:179], v[124:127], v[128:143]
    ds_read_b128 v[220:223], v14 offset:96
    ds_read_b128 v[224:227], v15 offset:0
    s_waitcnt lgkmcnt(4)
    v_mfma_f32_32x32x16_bf16 v[160:175], v[124:127], v[180:183], v[160:175]
    ds_read_b128 v[228:231], v15 offset:32
    ds_read_b128 v[232:235], v15 offset:64
    ds_read_b128 v[236:239], v15 offset:96
    ds_read_b128 v[240:243], v15 offset:128
    ds_read_b128 v[244:247], v15 offset:160
    ds_read_b128 v[248:251], v15 offset:192
    ds_read_b128 v[252:255], v15 offset:224
    v_and_b32 v200, 31, v1
    v_lshlrev_b32_e64 v200, 2, v200
    v_add_u32 v200, 143616, v200
    ds_read_b32 v203, v200
    s_mov_b64 s[86:87], 0
    v_and_b32 v200, 31, v1
    v_cmp_eq_u32 vcc, 28, v200
    s_lshr_b32 s78, s50, 1
    v_mov_b32 v207, s88
    s_lshr_b32 s78, s67, s78
    s_and_b32 s78, s78, 1
    s_lshl_b32 s78, s78, 13
    v_cndmask_b32 v207, 0, v207, vcc
    s_lshl_b32 s79, s50, 5
    s_lshr_b32 s73, s49, 1
    s_add_u32 s79, s79, s73
    s_lshl_b32 s79, s79, 14
    s_and_b32 s73, s44, 1
    s_lshl_b32 s73, s73, 12
    s_add_u32 s79, s79, s73
    s_add_u32 s79, s79, s48
    s_add_u32 s79, s79, 4194304
    s_lshr_b32 s73, s79, 8
    s_xor_b32 s73, s73, s78
    s_and_b32 s73, s73, 0x2000
    s_or_b32 s79, s79, s73
    s_lshl_b32 s73, s50, 4
    s_add_u32 s73, s73, s51
    s_lshl_b32 s73, s73, 14
    s_add_u32 s73, s73, s48
    s_lshr_b32 s96, s73, 8
    s_xor_b32 s96, s96, s78
    s_and_b32 s96, s96, 0x2000
    s_or_b32 s73, s73, s96
    s_lshl_b32 s96, s44, 11
    s_add_u32 s73, s73, s96
    v_mov_b32 v200, s88
    v_mov_b32 v201, 0x3f80
    v_mul_f32 v208, v208, v205
    v_mul_f32 v209, v209, v205
    v_mul_f32 v210, v210, v205
    v_mul_f32 v211, v211, v205
    s_waitcnt lgkmcnt(11)
    v_mul_f32 v212, v212, v205
    v_mul_f32 v213, v213, v205
    v_mul_f32 v214, v214, v205
    v_mul_f32 v215, v215, v205
    s_waitcnt lgkmcnt(10)
    v_mul_f32 v216, v216, v205
    v_mul_f32 v217, v217, v205
    v_mul_f32 v218, v218, v205
    v_mul_f32 v219, v219, v205
    s_waitcnt lgkmcnt(9)
    v_mul_f32 v220, v220, v205
    v_mul_f32 v221, v221, v205
    v_mul_f32 v222, v222, v205
    v_mul_f32 v223, v223, v205
    s_waitcnt lgkmcnt(0)
    v_mul_f32 v240, v240, v203
    v_mul_f32 v241, v241, v203
    v_mul_f32 v242, v242, v203
    v_mul_f32 v243, v243, v203
    v_mul_f32 v244, v244, v203
    v_mul_f32 v245, v245, v203
    v_mul_f32 v246, v246, v203
    v_mul_f32 v247, v247, v203
    v_mul_f32 v248, v248, v203
    v_mul_f32 v249, v249, v203
    v_mul_f32 v250, v250, v203
    v_mul_f32 v251, v251, v203
    v_mul_f32 v252, v252, v203
    v_mul_f32 v253, v253, v203
    v_mul_f32 v254, v254, v203
    v_mul_f32 v255, v255, v203
    v_pk_fma_f32 v[128:129], v[128:129], v[204:205], v[208:209] op_sel_hi:[1,0,1] neg_lo:[0,0,1] neg_hi:[0,0,1]
    v_pk_fma_f32 v[130:131], v[130:131], v[204:205], v[210:211] op_sel_hi:[1,0,1] neg_lo:[0,0,1] neg_hi:[0,0,1]
    v_pk_fma_f32 v[132:133], v[132:133], v[204:205], v[212:213] op_sel_hi:[1,0,1] neg_lo:[0,0,1] neg_hi:[0,0,1]
    v_pk_fma_f32 v[134:135], v[134:135], v[204:205], v[214:215] op_sel_hi:[1,0,1] neg_lo:[0,0,1] neg_hi:[0,0,1]
    v_pk_fma_f32 v[136:137], v[136:137], v[204:205], v[216:217] op_sel_hi:[1,0,1] neg_lo:[0,0,1] neg_hi:[0,0,1]
    v_pk_fma_f32 v[138:139], v[138:139], v[204:205], v[218:219] op_sel_hi:[1,0,1] neg_lo:[0,0,1] neg_hi:[0,0,1]
    v_pk_fma_f32 v[140:141], v[140:141], v[204:205], v[220:221] op_sel_hi:[1,0,1] neg_lo:[0,0,1] neg_hi:[0,0,1]
    v_pk_fma_f32 v[142:143], v[142:143], v[204:205], v[222:223] op_sel_hi:[1,0,1] neg_lo:[0,0,1] neg_hi:[0,0,1]
    v_cvt_pk_bf16_f32 v208, v128, v129
    v_cvt_pk_bf16_f32 v209, v130, v131
    v_cvt_pk_bf16_f32 v210, v132, v133
    v_cvt_pk_bf16_f32 v211, v134, v135
    buffer_store_dwordx4 v[208:211], v2, s[40:43], s79 offen offset:0 sc1
    v_cvt_pk_bf16_f32 v212, v136, v137
    v_cvt_pk_bf16_f32 v213, v138, v139
    v_cvt_pk_bf16_f32 v214, v140, v141
    v_cndmask_b32 v214, v214, v200, s[82:83]
    v_cvt_pk_bf16_f32 v215, v142, v143
    v_cndmask_b32 v215, v215, v201, s[82:83]
    buffer_store_dwordx4 v[212:215], v2, s[40:43], s79 offen offset:1024 sc1
    s_waitcnt vmcnt(2)
    s_barrier
    ds_read_b64_tr_b16 v[176:177], v10 offset:28672
    ds_read_b64_tr_b16 v[178:179], v11 offset:28672
    ds_read_b64_tr_b16 v[180:181], v10 offset:29696
    ds_read_b64_tr_b16 v[182:183], v11 offset:29696
    ds_read_b64_tr_b16 v[184:185], v10 offset:30720
    ds_read_b64_tr_b16 v[186:187], v11 offset:30720
    ds_read_b64_tr_b16 v[188:189], v10 offset:31744
    ds_read_b64_tr_b16 v[190:191], v11 offset:31744
    ds_read_b64_tr_b16 v[192:193], v10 offset:32768
    ds_read_b64_tr_b16 v[194:195], v11 offset:32768
    v_pk_fma_f32 v[160:161], v[160:161], v[224:225], v[240:241] neg_lo:[0,0,1] neg_hi:[0,0,1]
    v_pk_fma_f32 v[162:163], v[162:163], v[226:227], v[242:243] neg_lo:[0,0,1] neg_hi:[0,0,1]
    v_pk_fma_f32 v[164:165], v[164:165], v[228:229], v[244:245] neg_lo:[0,0,1] neg_hi:[0,0,1]
    v_pk_fma_f32 v[166:167], v[166:167], v[230:231], v[246:247] neg_lo:[0,0,1] neg_hi:[0,0,1]
    v_pk_fma_f32 v[168:169], v[168:169], v[232:233], v[248:249] neg_lo:[0,0,1] neg_hi:[0,0,1]
    v_pk_fma_f32 v[170:171], v[170:171], v[234:235], v[250:251] neg_lo:[0,0,1] neg_hi:[0,0,1]
    v_pk_fma_f32 v[172:173], v[172:173], v[236:237], v[252:253] neg_lo:[0,0,1] neg_hi:[0,0,1]
    v_pk_fma_f32 v[174:175], v[174:175], v[238:239], v[254:255] neg_lo:[0,0,1] neg_hi:[0,0,1]
    v_cvt_pk_bf16_f32 v160, v160, v161
    v_cndmask_b32 v160, v160, v207, s[84:85]
    v_cvt_pk_bf16_f32 v161, v162, v163
    v_cndmask_b32 v161, v161, v207, s[84:85]
    v_cvt_pk_bf16_f32 v162, v164, v165
    v_cndmask_b32 v162, v162, v207, s[84:85]
    v_cvt_pk_bf16_f32 v163, v166, v167
    v_cndmask_b32 v163, v163, v207, s[84:85]
    buffer_store_dwordx4 v[160:163], v2, s[40:43], s79 offen offset:2048 sc1
    v_cvt_pk_bf16_f32 v164, v168, v169
    v_cndmask_b32 v164, v164, v207, s[84:85]
    v_cvt_pk_bf16_f32 v165, v170, v171
    v_cndmask_b32 v165, v165, v207, s[84:85]
    v_cvt_pk_bf16_f32 v166, v172, v173
    v_cndmask_b32 v166, v166, v207, s[84:85]
    v_cvt_pk_bf16_f32 v167, v174, v175
    v_cndmask_b32 v167, v167, v207, s[84:85]
    buffer_store_dwordx4 v[164:167], v2, s[40:43], s79 offen offset:3072 sc1
    s_waitcnt lgkmcnt(8)
    v_mfma_f32_32x32x16_bf16 v[144:159], v[176:179], v[16:19], 0
    ds_read_b128 v[224:227], v14 offset:128
    s_waitcnt lgkmcnt(5)
    ds_read_b64_tr_b16 v[196:197], v10 offset:33792
    ds_read_b64_tr_b16 v[198:199], v11 offset:33792
    v_mfma_f32_32x32x16_bf16 v[144:159], v[180:183], v[20:23], v[144:159]
    ds_read_b128 v[228:231], v14 offset:160
    ds_read_b64_tr_b16 v[176:177], v10 offset:34816
    ds_read_b64_tr_b16 v[178:179], v11 offset:34816
    v_mfma_f32_32x32x16_bf16 v[144:159], v[184:187], v[24:27], v[144:159]
    ds_read_b128 v[232:235], v14 offset:192
    s_waitcnt lgkmcnt(7)
    ds_read_b64_tr_b16 v[180:181], v10 offset:35840
    ds_read_b64_tr_b16 v[182:183], v11 offset:35840
    v_mfma_f32_32x32x16_bf16 v[144:159], v[188:191], v[28:31], v[144:159]
    ds_read_b128 v[236:239], v14 offset:224
    v_mul_f32 v216, v128, v128
    v_mul_f32 v217, v129, v129
    ds_read_b64_tr_b16 v[184:185], v10 offset:36864
    ds_read_b64_tr_b16 v[186:187], v11 offset:36864
    v_mfma_f32_32x32x16_bf16 v[144:159], v[192:195], v[32:35], v[144:159]
    v_mul_f32 v218, v140, v140
    v_fmac_f32 v216, v130, v130
    v_fmac_f32 v217, v131, v131
    s_waitcnt lgkmcnt(6)
    ds_read_b64_tr_b16 v[188:189], v10 offset:37888
    ds_read_b64_tr_b16 v[190:191], v11 offset:37888
    v_mfma_f32_32x32x16_bf16 v[144:159], v[196:199], v[36:39], v[144:159]
    v_fmac_f32 v216, v132, v132
    v_fmac_f32 v217, v133, v133
    v_fmac_f32 v216, v134, v134
    ds_read_b64_tr_b16 v[192:193], v10 offset:38912
    ds_read_b64_tr_b16 v[194:195], v11 offset:38912
    v_mfma_f32_32x32x16_bf16 v[144:159], v[176:179], v[40:43], v[144:159]
    v_fmac_f32 v217, v135, v135
    v_fmac_f32 v216, v136, v136
    v_fmac_f32 v217, v137, v137
    s_waitcnt lgkmcnt(4)
    ds_read_b64_tr_b16 v[196:197], v10 offset:39936
    ds_read_b64_tr_b16 v[198:199], v11 offset:39936
    v_mfma_f32_32x32x16_bf16 v[144:159], v[180:183], v[44:47], v[144:159]
    v_fmac_f32 v216, v138, v138
    v_fmac_f32 v217, v139, v139
    v_fmac_f32 v218, v141, v141
    ds_read_b64_tr_b16 v[176:177], v10 offset:40960
    ds_read_b64_tr_b16 v[178:179], v11 offset:40960
    v_mfma_f32_32x32x16_bf16 v[144:159], v[184:187], v[48:51], v[144:159]
    v_fmac_f32 v218, v142, v142
    v_fmac_f32 v218, v143, v143
    v_add_f32 v216, v216, v217
    s_waitcnt lgkmcnt(4)
    ds_read_b64_tr_b16 v[180:181], v10 offset:41984
    ds_read_b64_tr_b16 v[182:183], v11 offset:41984
    v_mfma_f32_32x32x16_bf16 v[144:159], v[188:191], v[52:55], v[144:159]
    v_cndmask_b32 v218, v218, 0, s[82:83]
    v_add_f32 v216, v216, v218
    v_mov_b32 v217, v216
    s_nop 1
    v_permlane32_swap_b32 v216, v217
    ds_read_b64_tr_b16 v[184:185], v10 offset:43008
    ds_read_b64_tr_b16 v[186:187], v11 offset:43008
    v_mfma_f32_32x32x16_bf16 v[144:159], v[192:195], v[56:59], v[144:159]
    v_add_f32 v216, v216, v217
    v_cmp_nge_f32 vcc, s95, v216
    s_nop 0
    s_or_b64 s[86:87], s[86:87], vcc
    v_mul_f32 v224, v224, v202
    s_waitcnt lgkmcnt(4)
    ds_read_b64_tr_b16 v[188:189], v10 offset:44032
    ds_read_b64_tr_b16 v[190:191], v11 offset:44032
    v_mfma_f32_32x32x16_bf16 v[144:159], v[196:199], v[60:63], v[144:159]
    v_mul_f32 v225, v225, v202
    v_mul_f32 v226, v226, v202
    v_mul_f32 v227, v227, v202
    v_mul_f32 v228, v228, v202
    ds_read_b64_tr_b16 v[192:193], v10 offset:45056
    ds_read_b64_tr_b16 v[194:195], v11 offset:45056
    v_mfma_f32_32x32x16_bf16 v[144:159], v[176:179], v[64:67], v[144:159]
    v_mul_f32 v229, v229, v202
    v_mul_f32 v230, v230, v202
    v_mul_f32 v231, v231, v202
    v_mul_f32 v232, v232, v202
    s_waitcnt lgkmcnt(4)
    ds_read_b64_tr_b16 v[196:197], v10 offset:46080
    ds_read_b64_tr_b16 v[198:199], v11 offset:46080
    v_mfma_f32_32x32x16_bf16 v[144:159], v[180:183], v[68:71], v[144:159]
    v_mul_f32 v233, v233, v202
    v_mul_f32 v234, v234, v202
    v_mul_f32 v235, v235, v202
    v_mul_f32 v236, v236, v202
    ds_read_b64_tr_b16 v[176:177], v10 offset:47104
    ds_read_b64_tr_b16 v[178:179], v11 offset:47104
    v_mfma_f32_32x32x16_bf16 v[144:159], v[184:187], v[72:75], v[144:159]
    v_mul_f32 v237, v237, v202
    v_mul_f32 v238, v238, v202
    v_mul_f32_e64 v239, v239, v202
    s_waitcnt lgkmcnt(4)
    ds_read_b64_tr_b16 v[180:181], v10 offset:48128
    ds_read_b64_tr_b16 v[182:183], v11 offset:48128
    v_mfma_f32_32x32x16_bf16 v[144:159], v[188:191], v[76:79], v[144:159]
    ds_read_b64_tr_b16 v[184:185], v10 offset:49152
    ds_read_b64_tr_b16 v[186:187], v11 offset:49152
    v_mfma_f32_32x32x16_bf16 v[144:159], v[192:195], v[80:83], v[144:159]
    s_waitcnt lgkmcnt(4)
    ds_read_b64_tr_b16 v[188:189], v10 offset:50176
    ds_read_b64_tr_b16 v[190:191], v11 offset:50176
    v_mfma_f32_32x32x16_bf16 v[144:159], v[196:199], v[84:87], v[144:159]
    ds_read_b64_tr_b16 v[192:193], v10 offset:51200
    ds_read_b64_tr_b16 v[194:195], v11 offset:51200
    v_mfma_f32_32x32x16_bf16 v[144:159], v[176:179], v[88:91], v[144:159]
    s_waitcnt lgkmcnt(4)
    ds_read_b64_tr_b16 v[196:197], v10 offset:52224
    ds_read_b64_tr_b16 v[198:199], v11 offset:52224
    v_mfma_f32_32x32x16_bf16 v[144:159], v[180:183], v[92:95], v[144:159]
    ds_read_b64_tr_b16 v[176:177], v10 offset:53248
    ds_read_b64_tr_b16 v[178:179], v11 offset:53248
    v_mfma_f32_32x32x16_bf16 v[144:159], v[184:187], v[96:99], v[144:159]
    s_waitcnt lgkmcnt(4)
    ds_read_b64_tr_b16 v[180:181], v10 offset:54272
    ds_read_b64_tr_b16 v[182:183], v11 offset:54272
    v_mfma_f32_32x32x16_bf16 v[144:159], v[188:191], v[100:103], v[144:159]
    ds_read_b64_tr_b16 v[184:185], v10 offset:55296
    ds_read_b64_tr_b16 v[186:187], v11 offset:55296
    v_mfma_f32_32x32x16_bf16 v[144:159], v[192:195], v[104:107], v[144:159]
    s_waitcnt lgkmcnt(4)
    ds_read_b64_tr_b16 v[188:189], v10 offset:56320
    ds_read_b64_tr_b16 v[190:191], v11 offset:56320
    v_mfma_f32_32x32x16_bf16 v[144:159], v[196:199], v[108:111], v[144:159]
    v_mfma_f32_32x32x16_bf16 v[144:159], v[176:179], v[112:115], v[144:159]
    s_waitcnt lgkmcnt(2)
    v_mfma_f32_32x32x16_bf16 v[144:159], v[180:183], v[116:119], v[144:159]
    v_mfma_f32_32x32x16_bf16 v[144:159], v[184:187], v[120:123], v[144:159]
    s_waitcnt lgkmcnt(0)
    v_mfma_f32_32x32x16_bf16 v[144:159], v[188:191], v[124:127], v[144:159]
    s_nop 11
    v_pk_fma_f32 v[144:145], v[144:145], v[206:207], v[224:225] op_sel_hi:[1,0,1] neg_lo:[0,0,1] neg_hi:[0,0,1]
    v_pk_fma_f32 v[146:147], v[146:147], v[206:207], v[226:227] op_sel_hi:[1,0,1] neg_lo:[0,0,1] neg_hi:[0,0,1]
    v_pk_fma_f32 v[148:149], v[148:149], v[206:207], v[228:229] op_sel_hi:[1,0,1] neg_lo:[0,0,1] neg_hi:[0,0,1]
    v_pk_fma_f32 v[150:151], v[150:151], v[206:207], v[230:231] op_sel_hi:[1,0,1] neg_lo:[0,0,1] neg_hi:[0,0,1]
    v_pk_fma_f32 v[152:153], v[152:153], v[206:207], v[232:233] op_sel_hi:[1,0,1] neg_lo:[0,0,1] neg_hi:[0,0,1]
    v_pk_fma_f32 v[154:155], v[154:155], v[206:207], v[234:235] op_sel_hi:[1,0,1] neg_lo:[0,0,1] neg_hi:[0,0,1]
    v_pk_fma_f32 v[156:157], v[156:157], v[206:207], v[236:237] op_sel_hi:[1,0,1] neg_lo:[0,0,1] neg_hi:[0,0,1]
    v_pk_fma_f32 v[158:159], v[158:159], v[206:207], v[238:239] op_sel_hi:[1,0,1] neg_lo:[0,0,1] neg_hi:[0,0,1]
    v_cvt_pk_bf16_f32 v240, v144, v145
    v_cvt_pk_bf16_f32 v241, v146, v147
    v_cvt_pk_bf16_f32 v242, v148, v149
    v_cvt_pk_bf16_f32 v243, v150, v151
    buffer_store_dwordx4 v[240:243], v2, s[40:43], s73 offen offset:0 sc1
    v_cvt_pk_bf16_f32 v244, v152, v153
    v_cvt_pk_bf16_f32 v245, v154, v155
    v_cvt_pk_bf16_f32 v246, v156, v157
    v_cndmask_b32 v246, v246, 0, s[82:83]
    v_cvt_pk_bf16_f32 v247, v158, v159
    v_cndmask_b32 v247, v247, 0, s[82:83]
    buffer_store_dwordx4 v[244:247], v2, s[40:43], s73 offen offset:1024 sc1
    v_pk_mul_f32 v[220:221], v[144:145], v[144:145]
    v_pk_mul_f32 v[222:223], v[156:157], v[156:157]
    v_pk_fma_f32 v[220:221], v[146:147], v[146:147], v[220:221]
    v_pk_fma_f32 v[220:221], v[148:149], v[148:149], v[220:221]
    v_pk_fma_f32 v[220:221], v[150:151], v[150:151], v[220:221]
    v_pk_fma_f32 v[220:221], v[152:153], v[152:153], v[220:221]
    v_pk_fma_f32 v[220:221], v[154:155], v[154:155], v[220:221]
    v_pk_fma_f32 v[222:223], v[158:159], v[158:159], v[222:223]
    v_add_f32 v220, v220, v221
    v_add_f32 v222, v222, v223
    v_cndmask_b32 v222, v222, 0, s[82:83]
    v_add_f32 v220, v220, v222
    v_mov_b32 v221, v220
    s_nop 1
    v_permlane32_swap_b32 v220, v221
    v_add_f32_e64 v220, v220, v221
    v_cmp_nge_f32 vcc, s3, v220
    s_nop 0
    s_or_b64 s[86:87], s[86:87], vcc
    s_nop 2
L_qkv_out:
    s_cmp_eq_u64 s[86:87], 0
    s_cbranch_scc1 L_vote_8
    v_mov_b32 v208, 0x10000
    s_mov_b64 exec, 0xffff
    buffer_atomic_add v208, v0, s[40:43], s64 offen sc1
    s_mov_b64 exec, -1
L_vote_8:
    s_add_u32 s57, s47, 1
    s_mul_i32 s72, s57, 16
    s_mov_b32 s81, 0
    s_mov_b32 s57, s72
    s_mov_b32 s80, 1
    s_add_u32 s52, s71, 0
    s_waitcnt vmcnt(0) lgkmcnt(0)
    s_barrier
    s_cmp_lg_u32 s44, 0
    s_cbranch_scc1 L_sig_9
    s_mov_b64 exec, 0xffff
    buffer_atomic_add a238, v0, s[40:43], s64 offen offset:0 sc1
L_sig_9_e:
    s_mov_b64 exec, s[80:81]
    v_accvgpr_write_b32 a232, 0
    buffer_atomic_or a232, v3, s[40:43], s52 offen sc0 sc1
    s_mov_b64 exec, -1
L_sig_9:
    s_cmp_lg_u32 s47, 0
    s_cbranch_scc1 L_res_10
    v_and_b32 v10, 31, v1
    v_mul_u32_u24 v10, 896, v10
    v_lshrrev_b32 v11, 5, v1
    v_lshlrev_b32 v11, 3, v11
    v_add_u32 v10, v10, v11
    s_mul_i32 s74, s60, 28672
    s_lshl_b32 s75, s54, 7
    s_add_u32 s74, s74, s75
    s_lshl_b32 s75, s58, 6
    s_add_u32 s74, s74, s75
    buffer_load_dwordx2 v[240:241], v10, s[4:7], s74 offen offset:0
    buffer_load_dwordx2 v[242:243], v10, s[4:7], s74 offen offset:16
    buffer_load_dwordx2 v[244:245], v10, s[4:7], s74 offen offset:32
    buffer_load_dwordx2 v[246:247], v10, s[4:7], s74 offen offset:48
    s_cmp_eq_u32 s44, 0
    s_cbranch_scc1 L_res_10
    s_sub_u32 s79, s44, 1
    s_mul_i32 s72, s79, 28672
    s_add_u32 s72, s72, 57344
    v_lshrrev_b32 v12, 5, v1
    v_lshlrev_b32 v12, 8, v12
    v_add3_u32 v12, v12, v5, s72
    v_mov_b32 v224, s88
    v_mov_b32 v225, s88
    v_mov_b32 v226, s88
    v_mov_b32 v227, s88
    ds_read_b64_tr_b16 v[176:177], v12 offset:0
    ds_read_b64_tr_b16 v[178:179], v12 offset:512
    ds_read_b64_tr_b16 v[180:181], v12 offset:1024
    ds_read_b64_tr_b16 v[182:183], v12 offset:1536
    ds_read_b64_tr_b16 v[184:185], v12 offset:2048
    ds_read_b64_tr_b16 v[186:187], v12 offset:2560
    ds_read_b64_tr_b16 v[188:189], v12 offset:3072
    ds_read_b64_tr_b16 v[190:191], v12 offset:3584
    ds_read_b64_tr_b16 v[192:193], v12 offset:4096
    ds_read_b64_tr_b16 v[194:195], v12 offset:4608
    s_waitcnt lgkmcnt(8)
    v_mfma_f32_32x32x16_bf16 v[208:223], v[176:179], v[224:227], 0
    ds_read_b64_tr_b16 v[196:197], v12 offset:5120
    ds_read_b64_tr_b16 v[198:199], v12 offset:5632
    s_waitcnt lgkmcnt(8)
    v_mfma_f32_32x32x16_bf16 v[208:223], v[180:183], v[224:227], v[208:223]
    ds_read_b64_tr_b16 v[176:177], v12 offset:6144
    ds_read_b64_tr_b16 v[178:179], v12 offset:6656
    s_waitcnt lgkmcnt(8)
    v_mfma_f32_32x32x16_bf16 v[208:223], v[184:187], v[224:227], v[208:223]
    ds_read_b64_tr_b16 v[180:181], v12 offset:7168
    ds_read_b64_tr_b16 v[182:183], v12 offset:7680
    s_waitcnt lgkmcnt(8)
    v_mfma_f32_32x32x16_bf16 v[208:223], v[188:191], v[224:227], v[208:223]
    ds_read_b64_tr_b16 v[184:185], v12 offset:8192
    ds_read_b64_tr_b16 v[186:187], v12 offset:8704
    s_waitcnt lgkmcnt(8)
    v_mfma_f32_32x32x16_bf16 v[208:223], v[192:195], v[224:227], v[208:223]
    ds_read_b64_tr_b16 v[188:189], v12 offset:9216
    ds_read_b64_tr_b16 v[190:191], v12 offset:9728
    s_waitcnt lgkmcnt(8)
    v_mfma_f32_32x32x16_bf16 v[208:223], v[196:199], v[224:227], v[208:223]
    ds_read_b64_tr_b16 v[192:193], v12 offset:10240
    ds_read_b64_tr_b16 v[194:195], v12 offset:10752
    s_waitcnt lgkmcnt(8)
    v_mfma_f32_32x32x16_bf16 v[208:223], v[176:179], v[224:227], v[208:223]
    ds_read_b64_tr_b16 v[196:197], v12 offset:11264
    ds_read_b64_tr_b16 v[198:199], v12 offset:11776
    s_waitcnt lgkmcnt(8)
    v_mfma_f32_32x32x16_bf16 v[208:223], v[180:183], v[224:227], v[208:223]
    ds_read_b64_tr_b16 v[176:177], v12 offset:12288
    ds_read_b64_tr_b16 v[178:179], v12 offset:12800
    s_waitcnt lgkmcnt(8)
    v_mfma_f32_32x32x16_bf16 v[208:223], v[184:187], v[224:227], v[208:223]
    ds_read_b64_tr_b16 v[180:181], v12 offset:13312
    ds_read_b64_tr_b16 v[182:183], v12 offset:13824
    s_waitcnt lgkmcnt(8)
    v_mfma_f32_32x32x16_bf16 v[208:223], v[188:191], v[224:227], v[208:223]
    ds_read_b64_tr_b16 v[184:185], v12 offset:14336
    ds_read_b64_tr_b16 v[186:187], v12 offset:14848
    s_waitcnt lgkmcnt(8)
    v_mfma_f32_32x32x16_bf16 v[208:223], v[192:195], v[224:227], v[208:223]
    ds_read_b64_tr_b16 v[188:189], v12 offset:15360
    ds_read_b64_tr_b16 v[190:191], v12 offset:15872
    s_waitcnt lgkmcnt(8)
    v_mfma_f32_32x32x16_bf16 v[208:223], v[196:199], v[224:227], v[208:223]
    ds_read_b64_tr_b16 v[192:193], v12 offset:16384
    ds_read_b64_tr_b16 v[194:195], v12 offset:16896
    s_waitcnt lgkmcnt(8)
    v_mfma_f32_32x32x16_bf16 v[208:223], v[176:179], v[224:227], v[208:223]
    ds_read_b64_tr_b16 v[196:197], v12 offset:17408
    ds_read_b64_tr_b16 v[198:199], v12 offset:17920
    s_waitcnt lgkmcnt(8)
    v_mfma_f32_32x32x16_bf16 v[208:223], v[180:183], v[224:227], v[208:223]
    ds_read_b64_tr_b16 v[176:177], v12 offset:18432
    ds_read_b64_tr_b16 v[178:179], v12 offset:18944
    s_waitcnt lgkmcnt(8)
    v_mfma_f32_32x32x16_bf16 v[208:223], v[184:187], v[224:227], v[208:223]
    ds_read_b64_tr_b16 v[180:181], v12 offset:19456
    ds_read_b64_tr_b16 v[182:183], v12 offset:19968
    s_waitcnt lgkmcnt(8)
    v_mfma_f32_32x32x16_bf16 v[208:223], v[188:191], v[224:227], v[208:223]
    ds_read_b64_tr_b16 v[184:185], v12 offset:20480
    ds_read_b64_tr_b16 v[186:187], v12 offset:20992
    s_waitcnt lgkmcnt(8)
    v_mfma_f32_32x32x16_bf16 v[208:223], v[192:195], v[224:227], v[208:223]
    ds_read_b64_tr_b16 v[188:189], v12 offset:21504
    ds_read_b64_tr_b16 v[190:191], v12 offset:22016
    s_waitcnt lgkmcnt(8)
    v_mfma_f32_32x32x16_bf16 v[208:223], v[196:199], v[224:227], v[208:223]
    ds_read_b64_tr_b16 v[192:193], v12 offset:22528
    ds_read_b64_tr_b16 v[194:195], v12 offset:23040
    s_waitcnt lgkmcnt(8)
    v_mfma_f32_32x32x16_bf16 v[208:223], v[176:179], v[224:227], v[208:223]
    ds_read_b64_tr_b16 v[196:197], v12 offset:23552
    ds_read_b64_tr_b16 v[198:199], v12 offset:24064
    s_waitcnt lgkmcnt(8)
    v_mfma_f32_32x32x16_bf16 v[208:223], v[180:183], v[224:227], v[208:223]
    ds_read_b64_tr_b16 v[176:177], v12 offset:24576
    ds_read_b64_tr_b16 v[178:179], v12 offset:25088
    s_waitcnt lgkmcnt(8)
    v_mfma_f32_32x32x16_bf16 v[208:223], v[184:187], v[224:227], v[208:223]
    ds_read_b64_tr_b16 v[180:181], v12 offset:25600
    ds_read_b64_tr_b16 v[182:183], v12 offset:26112
    s_waitcnt lgkmcnt(8)
    v_mfma_f32_32x32x16_bf16 v[208:223], v[188:191], v[224:227], v[208:223]
    ds_read_b64_tr_b16 v[184:185], v12 offset:26624
    ds_read_b64_tr_b16 v[186:187], v12 offset:27136
    s_waitcnt lgkmcnt(8)
    v_mfma_f32_32x32x16_bf16 v[208:223], v[192:195], v[224:227], v[208:223]
    ds_read_b64_tr_b16 v[188:189], v12 offset:27648
    ds_read_b64_tr_b16 v[190:191], v12 offset:28160
    s_waitcnt lgkmcnt(8)
    v_mfma_f32_32x32x16_bf16 v[208:223], v[196:199], v[224:227], v[208:223]
    s_waitcnt lgkmcnt(6)
    v_mfma_f32_32x32x16_bf16 v[208:223], v[176:179], v[224:227], v[208:223]
    s_waitcnt lgkmcnt(4)
    v_mfma_f32_32x32x16_bf16 v[208:223], v[180:183], v[224:227], v[208:223]
    s_waitcnt lgkmcnt(2)
    v_mfma_f32_32x32x16_bf16 v[208:223], v[184:187], v[224:227], v[208:223]
    s_waitcnt lgkmcnt(0)
    v_mfma_f32_32x32x16_bf16 v[208:223], v[188:191], v[224:227], v[208:223]
    s_lshl_b32 s72, s79, 7
    v_lshrrev_b32 v10, 5, v1
    v_lshlrev_b32 v10, 4, v10
    v_add_u32 v10, s72, v10
    v_add_u32 v11, 143360, v10
    s_add_u32 s72, s61, 0
    s_mov_b32 exec_lo, 1
    s_mov_b32 exec_hi, 1
    s_nop 3
    ds_write_b128 v11, v[208:211] offset:0
    ds_write_b128 v11, v[212:215] offset:32
    ds_write_b128 v11, v[216:219] offset:64
    ds_write_b128 v11, v[220:223] offset:96
    buffer_store_dwordx4 v[208:211], v10, s[40:43], s72 offen offset:0 sc1
    buffer_store_dwordx4 v[212:215], v10, s[40:43], s72 offen offset:32 sc1
    buffer_store_dwordx4 v[216:219], v10, s[40:43], s72 offen offset:64 sc1
    buffer_store_dwordx4 v[220:223], v10, s[40:43], s72 offen offset:96 sc1
    s_mov_b64 exec, -1
    s_nop 0
L_res_10:
    v_pk_mov_b32 v[96:97], 0, 0
    v_pk_mov_b32 v[98:99], 0, 0
    v_pk_mov_b32 v[100:101], 0, 0
    v_pk_mov_b32 v[102:103], 0, 0
    v_pk_mov_b32 v[104:105], 0, 0
    v_pk_mov_b32 v[106:107], 0, 0
    v_pk_mov_b32 v[108:109], 0, 0
    v_pk_mov_b32 v[110:111], 0, 0
    v_pk_mov_b32 v[112:113], 0, 0
    v_pk_mov_b32 v[114:115], 0, 0
    v_pk_mov_b32 v[116:117], 0, 0
    v_pk_mov_b32 v[118:119], 0, 0
    v_pk_mov_b32 v[120:121], 0, 0
    v_pk_mov_b32 v[122:123], 0, 0
    v_pk_mov_b32 v[124:125], 0, 0
    v_pk_mov_b32 v[126:127], 0, 0
    v_pk_mov_b32 v[128:129], 0, 0
    v_pk_mov_b32 v[130:131], 0, 0
    v_pk_mov_b32 v[132:133], 0, 0
    v_pk_mov_b32 v[134:135], 0, 0
    v_pk_mov_b32 v[136:137], 0, 0
    v_pk_mov_b32 v[138:139], 0, 0
    v_pk_mov_b32 v[140:141], 0, 0
    v_pk_mov_b32 v[142:143], 0, 0
    v_pk_mov_b32 v[144:145], 0, 0
    v_pk_mov_b32 v[146:147], 0, 0
    v_pk_mov_b32 v[148:149], 0, 0
    v_pk_mov_b32 v[150:151], 0, 0
    v_pk_mov_b32 v[152:153], 0, 0
    v_pk_mov_b32 v[154:155], 0, 0
    v_pk_mov_b32 v[156:157], 0, 0
    v_pk_mov_b32 v[158:159], 0, 0
    s_cmp_lg_u32 s44, 0
    s_cbranch_scc1 L_kick_11
    s_mov_b64 exec, s[80:81]
    v_accvgpr_write_b32 a233, 0
    buffer_atomic_or a233, v3, s[40:43], s52 offen sc0 sc1
    s_mov_b64 exec, -1
L_kick_11:
    s_lshl_b32 s79, s51, 2
    s_add_u32 s79, s79, s44
    s_lshl_b32 s79, s79, 17
    s_add_u32 s79, s79, s48
    s_add_u32 s79, s79, 4194304
    s_lshr_b32 s72, s79, 8
    s_xor_b32 s72, s72, s69
    s_and_b32 s72, s72, 0x2000
    s_or_b32 s79, s79, s72
    s_mov_b32 s78, s79
    s_lshl_b32 s74, s51, 4
    s_add_u32 s74, s74, s50
    s_lshl_b32 s74, s74, 14
    s_add_u32 s74, s74, s48
    s_lshr_b32 s72, s74, 8
    s_xor_b32 s72, s72, s69
    s_and_b32 s72, s72, 0x2000
    s_or_b32 s74, s74, s72
    s_add_u32 s98, s44, 0
    s_and_b32 s98, s98, 3
    s_lshl_b32 s98, s98, 11
    s_add_u32 s98, s98, s74
    s_add_u32 s99, s44, 1
    s_and_b32 s99, s99, 3
    s_lshl_b32 s99, s99, 11
    s_add_u32 s99, s99, s74
    s_add_u32 s100, s44, 2
    s_and_b32 s100, s100, 3
    s_lshl_b32 s100, s100, 11
    s_add_u32 s100, s100, s74
    s_add_u32 s101, s44, 3
    s_and_b32 s101, s101, 3
    s_lshl_b32 s101, s101, 11
    s_add_u32 s101, s101, s74
    v_mov_b32 v12, 0
    s_nop 1
    s_cmp_lg_u32 s44, 0
    s_cbranch_scc1 L_poll_12_done
    s_mov_b64 exec, s[80:81]
    v_accvgpr_write_b32 a234, 0
    buffer_atomic_or a234, v3, s[40:43], s52 offen sc0 sc1
    s_mov_b32 s73, 0
L_poll_12_loop:
    s_waitcnt vmcnt(2)
    v_accvgpr_read_b32 v11, a232
    v_and_b32 v10, 0xffff, v11
    v_cmp_gt_u32 vcc, s57, v10
    s_cbranch_vccz L_poll_12_out
    v_accvgpr_write_b32 a232, 0
    buffer_atomic_or a232, v3, s[40:43], s52 offen sc0 sc1
    s_waitcnt vmcnt(2)
    v_accvgpr_read_b32 v11, a233
    v_and_b32 v10, 0xffff, v11
    v_cmp_gt_u32 vcc, s57, v10
    s_cbranch_vccz L_poll_12_out
    v_accvgpr_write_b32 a233, 0
    buffer_atomic_or a233, v3, s[40:43], s52 offen sc0 sc1
    s_waitcnt vmcnt(2)
    v_accvgpr_read_b32 v11, a234
    v_and_b32 v10, 0xffff, v11
    v_cmp_gt_u32 vcc, s57, v10
    s_cbranch_vccz L_poll_12_out
    v_accvgpr_write_b32 a234, 0
    buffer_atomic_or a234, v3, s[40:43], s52 offen sc0 sc1
    s_add_u32 s73, s73, 1
    s_cmp_lt_u32 s73, 0x20000
    s_cbranch_scc1 L_poll_12_loop
L_poll_12_out:
    v_mov_b32 v10, 0
    ds_write_b32 v10, v11
    s_mov_b64 exec, -1
    s_waitcnt vmcnt(2) lgkmcnt(0)
    s_branch L_poll_12_b
L_poll_12_done:
    s_waitcnt vmcnt(0) lgkmcnt(0)
L_poll_12_b:
    s_barrier
    buffer_load_dwordx4 a[0:3], v2, s[40:43], s79 offen offset:0 sc1
    buffer_load_dwordx4 a[4:7], v2, s[40:43], s79 offen offset:1024 sc1
    buffer_load_dwordx4 v[16:19], v2, s[40:43], s98 offen offset:0 sc1
    buffer_load_dwordx4 v[20:23], v2, s[40:43], s98 offen offset:1024 sc1
    ds_read_b32 v160, v12
    buffer_load_dwordx4 v[24:27], v2, s[40:43], s99 offen offset:0 sc1
    buffer_load_dwordx4 v[28:31], v2, s[40:43], s99 offen offset:1024 sc1
    buffer_load_dwordx4 a[8:11], v2, s[40:43], s79 offen offset:2048 sc1
    buffer_load_dwordx4 a[12:15], v2, s[40:43], s79 offen offset:3072 sc1
    buffer_load_dwordx4 v[32:35], v2, s[40:43], s100 offen offset:0 sc1
    buffer_load_dwordx4 v[36:39], v2, s[40:43], s100 offen offset:1024 sc1
    buffer_load_dwordx4 v[40:43], v2, s[40:43], s101 offen offset:0 sc1
    buffer_load_dwordx4 v[44:47], v2, s[40:43], s101 offen offset:1024 sc1
    s_waitcnt lgkmcnt(0)
    v_cmp_lt_u32 vcc, 0xffff, v160
    s_nop 4
    s_cbranch_vccz L_fast_13
    s_waitcnt vmcnt(0)
    v_mov_b32 v164, 0xff800000
    v_mov_b32 v165, 0xff800000
    v_mov_b32 v166, 0xff800000
    v_mov_b32 v167, 0xff800000
    s_mov_b32 s77, 0
    s_mov_b32 s76, s78
L_fb_14:
    buffer_load_dwordx4 v[168:171], v2, s[40:43], s76 offen sc1
    buffer_load_dwordx4 v[172:175], v2, s[40:43], s76 offen offset:1024 sc1
    s_waitcnt vmcnt(1)
    v_mfma_f32_32x32x16_bf16 v[176:191], v[168:171], v[16:19], 0
    s_waitcnt vmcnt(0)
    v_mfma_f32_32x32x16_bf16 v[176:191], v[172:175], v[20:23], v[176:191]
    s_nop 11
    s_nop 0
    v_max3_f32 v164, v164, v176, v177
    v_max3_f32 v164, v164, v178, v179
    v_max3_f32 v164, v164, v180, v181
    v_max3_f32 v164, v164, v182, v183
    v_max3_f32 v164, v164, v184, v185
    v_max3_f32 v164, v164, v186, v187
    v_max3_f32 v164, v164, v188, v189
    v_max3_f32 v164, v164, v190, v191
    v_mfma_f32_32x32x16_bf16 v[176:191], v[168:171], v[24:27], 0
    v_mfma_f32_32x32x16_bf16 v[176:191], v[172:175], v[28:31], v[176:191]
    s_nop 11
    s_nop 0
    v_max3_f32 v165, v165, v176, v177
    v_max3_f32 v165, v165, v178, v179
    v_max3_f32 v165, v165, v180, v181
    v_max3_f32 v165, v165, v182, v183
    v_max3_f32 v165, v165, v184, v185
    v_max3_f32 v165, v165, v186, v187
    v_max3_f32 v165, v165, v188, v189
    v_max3_f32 v165, v165, v190, v191
    v_mfma_f32_32x32x16_bf16 v[176:191], v[168:171], v[32:35], 0
    v_mfma_f32_32x32x16_bf16 v[176:191], v[172:175], v[36:39], v[176:191]
    s_nop 11
    s_nop 0
    v_max3_f32 v166, v166, v176, v177
    v_max3_f32 v166, v166, v178, v179
    v_max3_f32 v166, v166, v180, v181
    v_max3_f32 v166, v166, v182, v183
    v_max3_f32 v166, v166, v184, v185
    v_max3_f32 v166, v166, v186, v187
    v_max3_f32 v166, v166, v188, v189
    v_max3_f32 v166, v166, v190, v191
    v_mfma_f32_32x32x16_bf16 v[176:191], v[168:171], v[40:43], 0
    v_mfma_f32_32x32x16_bf16 v[176:191], v[172:175], v[44:47], v[176:191]
    s_nop 11
    s_nop 0
    v_max3_f32 v167, v167, v176, v177
    v_max3_f32 v167, v167, v178, v179
    v_max3_f32 v167, v167, v180, v181
    v_max3_f32 v167, v167, v182, v183
    v_max3_f32 v167, v167, v184, v185
    v_max3_f32 v167, v167, v186, v187
    v_max3_f32 v167, v167, v188, v189
    v_max3_f32 v167, v167, v190, v191
    s_and_b32 s75, s77, 1
    s_lshl_b32 s75, s75, 13
    s_add_u32 s76, s76, s75
    s_add_u32 s76, s76, 4096
    s_add_u32 s77, s77, 1
    s_cmp_lt_u32 s77, 16
    s_cbranch_scc1 L_fb_14
    v_mov_b32 v10, v164
    s_nop 1
    v_permlane32_swap_b32 v10, v164
    v_max_f32 v164, v164, v10
    s_add_u32 s74, s44, 0
    s_and_b32 s74, s74, 3
    s_lshl_b32 s74, s74, 10
    s_add_u32 s74, s74, 114688
    v_add_u32 v168, s74, v3
    s_lshl_b32 s75, s44, 8
    v_add_u32 v11, s75, v168
    ds_write_b32 v11, v164
    v_mov_b32 v10, v165
    s_nop 1
    v_permlane32_swap_b32 v10, v165
    v_max_f32 v165, v165, v10
    s_add_u32 s74, s44, 1
    s_and_b32 s74, s74, 3
    s_lshl_b32 s74, s74, 10
    s_add_u32 s74, s74, 114688
    v_add_u32 v169, s74, v3
    s_lshl_b32 s75, s44, 8
    v_add_u32 v11, s75, v169
    ds_write_b32 v11, v165
    v_mov_b32 v10, v166
    s_nop 1
    v_permlane32_swap_b32 v10, v166
    v_max_f32 v166, v166, v10
    s_add_u32 s74, s44, 2
    s_and_b32 s74, s74, 3
    s_lshl_b32 s74, s74, 10
    s_add_u32 s74, s74, 114688
    v_add_u32 v170, s74, v3
    s_lshl_b32 s75, s44, 8
    v_add_u32 v11, s75, v170
    ds_write_b32 v11, v166
    v_mov_b32 v10, v167
    s_nop 1
    v_permlane32_swap_b32 v10, v167
    v_max_f32 v167, v167, v10
    s_add_u32 s74, s44, 3
    s_and_b32 s74, s74, 3
    s_lshl_b32 s74, s74, 10
    s_add_u32 s74, s74, 114688
    v_add_u32 v171, s74, v3
    s_lshl_b32 s75, s44, 8
    v_add_u32 v11, s75, v171
    ds_write_b32 v11, v167
    s_waitcnt lgkmcnt(0)
    s_barrier
    ds_read_b32 v176, v168 offset:0
    ds_read_b32 v177, v168 offset:256
    ds_read_b32 v178, v168 offset:512
    ds_read_b32 v179, v168 offset:768
    ds_read_b32 v180, v169 offset:0
    ds_read_b32 v181, v169 offset:256
    ds_read_b32 v182, v169 offset:512
    ds_read_b32 v183, v169 offset:768
    ds_read_b32 v184, v170 offset:0
    ds_read_b32 v185, v170 offset:256
    ds_read_b32 v186, v170 offset:512
    ds_read_b32 v187, v170 offset:768
    ds_read_b32 v188, v171 offset:0
    ds_read_b32 v189, v171 offset:256
    ds_read_b32 v190, v171 offset:512
    ds_read_b32 v191, v171 offset:768
    s_waitcnt lgkmcnt(13)
    v_max3_f32 v176, v176, v177, v178
    s_waitcnt lgkmcnt(12)
    v_max_f32 v176, v176, v179
    v_sub_f32 v176, 0, v176
    v_and_b32 v177, 0xffff0000, v176
    v_sub_f32 v176, v176, v177
    v_and_b32 v178, 0xffff0000, v176
    v_sub_f32 v176, v176, v178
    v_lshrrev_b32 v176, 16, v176
    v_lshrrev_b32_e64 v177, 16, v177
    v_or_b32 v177, v177, v178
    v_cndmask_b32 v22, v22, v177, s[82:83]
    v_cndmask_b32 v23, v23, v176, s[82:83]
    s_waitcnt lgkmcnt(9)
    v_max3_f32 v180, v180, v181, v182
    s_waitcnt lgkmcnt(8)
    v_max_f32 v180, v180, v183
    v_sub_f32 v180, 0, v180
    v_and_b32 v181, 0xffff0000, v180
    v_sub_f32 v180, v180, v181
    v_and_b32 v182, 0xffff0000, v180
    v_sub_f32 v180, v180, v182
    v_lshrrev_b32 v180, 16, v180
    v_lshrrev_b32_e64 v181, 16, v181
    v_or_b32 v181, v181, v182
    v_cndmask_b32 v30, v30, v181, s[82:83]
    v_cndmask_b32 v31, v31, v180, s[82:83]
    s_waitcnt lgkmcnt(5)
    v_max3_f32 v184, v184, v185, v186
    s_waitcnt lgkmcnt(4)
    v_max_f32 v184, v184, v187
    v_sub_f32 v184, 0, v184
    v_and_b32 v185, 0xffff0000, v184
    v_sub_f32 v184, v184, v185
    v_and_b32 v186, 0xffff0000, v184
    v_sub_f32 v184, v184, v186
    v_lshrrev_b32 v184, 16, v184
    v_lshrrev_b32_e64 v185, 16, v185
    v_or_b32 v185, v185, v186
    v_cndmask_b32 v38, v38, v185, s[82:83]
    v_cndmask_b32 v39, v39, v184, s[82:83]
    s_waitcnt lgkmcnt(1)
    v_max3_f32 v188, v188, v189, v190
    s_waitcnt lgkmcnt(0)
    v_max_f32 v188, v188, v191
    v_sub_f32 v188, 0, v188
    v_and_b32 v189, 0xffff0000, v188
    v_sub_f32 v188, v188, v189
    v_and_b32 v190, 0xffff0000, v188
    v_sub_f32 v188, v188, v190
    v_lshrrev_b32 v188, 16, v188
    v_lshrrev_b32_e64 v189, 16, v189
    v_or_b32 v189, v189, v190
    v_cndmask_b32 v46, v46, v189, s[82:83]
    v_cndmask_b32 v47, v47, v188, s[82:83]
    s_nop 1
    s_barrier
L_fast_13:
    s_waitcnt vmcnt(9)
    v_mfma_f32_32x32x16_bf16 v[176:191], a[0:3], v[16:19], 0
    s_waitcnt vmcnt(8)
    v_mfma_f32_32x32x16_bf16 v[176:191], a[4:7], v[20:23], v[176:191]
    s_waitcnt vmcnt(7)
    v_mfma_f32_32x32x16_bf16 v[192:207], a[0:3], v[24:27], 0
    s_nop 9
    v_exp_f32 v176, v176
    v_exp_f32 v177, v177
    v_exp_f32 v178, v178
    v_exp_f32 v179, v179
    v_cvt_pk_bf16_f32 v80, v176, v177
    v_cvt_pk_bf16_f32 v81, v178, v179
    s_waitcnt vmcnt(6)
    v_mfma_f32_32x32x16_bf16 v[192:207], a[4:7], v[28:31], v[192:207]
    s_add_u32 s79, s79, 4096
    v_exp_f32 v180, v180
    v_exp_f32 v181, v181
    v_exp_f32 v182, v182
    v_exp_f32_e64 v183, v183
    v_cvt_pk_bf16_f32 v82, v180, v181
    v_cvt_pk_bf16_f32 v83, v182, v183
    buffer_load_dwordx4 a[16:19], v2, s[40:43], s79 offen offset:0 sc1
    buffer_load_dwordx4 a[20:23], v2, s[40:43], s79 offen offset:1024 sc1
    buffer_load_dwordx4 a[24:27], v2, s[40:43], s79 offen offset:2048 sc1
    buffer_load_dwordx4 a[28:31], v2, s[40:43], s79 offen offset:3072 sc1
    v_exp_f32 v184, v184
    v_exp_f32 v185, v185
    v_exp_f32 v186, v186
    v_exp_f32 v187, v187
    v_cvt_pk_bf16_f32 v84, v184, v185
    v_cvt_pk_bf16_f32 v85, v186, v187
    s_waitcnt vmcnt(9)
    v_mfma_f32_32x32x16_bf16 v[96:111], a[8:11], v[80:83], v[96:111]
    v_exp_f32 v188, v188
    v_exp_f32 v189, v189
    v_exp_f32 v190, v190
    v_exp_f32_e64 v191, v191
    v_cvt_pk_bf16_f32 v86, v188, v189
    v_cvt_pk_bf16_f32 v87, v190, v191
    s_waitcnt vmcnt(7)
    v_mfma_f32_32x32x16_bf16 v[208:223], a[0:3], v[32:35], 0
    v_exp_f32 v192, v192
    v_exp_f32 v193, v193
    v_exp_f32 v194, v194
    v_exp_f32_e64 v195, v195
    v_cvt_pk_bf16_f32 v80, v192, v193
    v_cvt_pk_bf16_f32 v81, v194, v195
    s_waitcnt vmcnt(6)
    v_mfma_f32_32x32x16_bf16 v[208:223], a[4:7], v[36:39], v[208:223]
    s_add_u32 s79, s79, 12288
    v_exp_f32 v196, v196
    v_exp_f32 v197, v197
    v_exp_f32 v198, v198
    v_exp_f32_e64 v199, v199
    v_cvt_pk_bf16_f32 v82, v196, v197
    v_cvt_pk_bf16_f32 v83, v198, v199
    v_mfma_f32_32x32x16_bf16 v[96:111], a[12:15], v[84:87], v[96:111]
    buffer_load_dwordx4 a[32:35], v2, s[40:43], s79 offen offset:0 sc1
    buffer_load_dwordx4 a[36:39], v2, s[40:43], s79 offen offset:1024 sc1
    buffer_load_dwordx4 a[40:43], v2, s[40:43], s79 offen offset:2048 sc1
    buffer_load_dwordx4 a[44:47], v2, s[40:43], s79 offen offset:3072 sc1
    v_exp_f32 v200, v200
    v_exp_f32 v201, v201
    v_exp_f32 v202, v202
    v_exp_f32 v203, v203
    v_cvt_pk_bf16_f32 v84, v200, v201
    v_cvt_pk_bf16_f32 v85, v202, v203
    v_mfma_f32_32x32x16_bf16 v[112:127], a[8:11], v[80:83], v[112:127]
    v_exp_f32 v204, v204
    v_exp_f32 v205, v205
    v_exp_f32 v206, v206
    v_exp_f32 v207, v207
    v_cvt_pk_bf16_f32 v86, v204, v205
    v_cvt_pk_bf16_f32 v87, v206, v207
    s_waitcnt vmcnt(9)
    v_mfma_f32_32x32x16_bf16 v[176:191], a[0:3], v[40:43], 0
    v_exp_f32 v208, v208
    v_exp_f32 v209, v209
    v_exp_f32 v210, v210
    v_exp_f32_e64 v211, v211
    v_cvt_pk_bf16_f32 v80, v208, v209
    v_cvt_pk_bf16_f32 v81, v210, v211
    s_waitcnt vmcnt(8)
    v_mfma_f32_32x32x16_bf16 v[176:191], a[4:7], v[44:47], v[176:191]
    s_add_u32 s79, s79, 4096
    v_exp_f32 v212, v212
    v_exp_f32 v213, v213
    v_exp_f32 v214, v214
    v_exp_f32_e64 v215, v215
    v_cvt_pk_bf16_f32 v82, v212, v213
    v_cvt_pk_bf16_f32 v83, v214, v215
    v_mfma_f32_32x32x16_bf16 v[112:127], a[12:15], v[84:87], v[112:127]
    buffer_load_dwordx4 a[48:51], v2, s[40:43], s79 offen offset:0 sc1
    buffer_load_dwordx4 a[52:55], v2, s[40:43], s79 offen offset:1024 sc1
    buffer_load_dwordx4 a[56:59], v2, s[40:43], s79 offen offset:2048 sc1
    buffer_load_dwordx4 a[60:63], v2, s[40:43], s79 offen offset:3072 sc1
    v_exp_f32 v216, v216
    v_exp_f32 v217, v217
    v_exp_f32 v218, v218
    v_exp_f32 v219, v219
    v_cvt_pk_bf16_f32 v84, v216, v217
    v_cvt_pk_bf16_f32 v85, v218, v219
    v_mfma_f32_32x32x16_bf16 v[128:143], a[8:11], v[80:83], v[128:143]
    v_exp_f32 v220, v220
    v_exp_f32 v221, v221
    v_exp_f32 v222, v222
    v_exp_f32 v223, v223
    v_cvt_pk_bf16_f32 v86, v220, v221
    v_cvt_pk_bf16_f32 v87, v222, v223
    s_waitcnt vmcnt(11)
    v_mfma_f32_32x32x16_bf16 v[192:207], a[16:19], v[16:19], 0
    v_exp_f32 v176, v176
    v_exp_f32 v177, v177
    v_exp_f32 v178, v178
    v_exp_f32_e64 v179, v179
    v_cvt_pk_bf16_f32 v80, v176, v177
    v_cvt_pk_bf16_f32 v81, v178, v179
    s_waitcnt vmcnt(10)
    v_mfma_f32_32x32x16_bf16 v[192:207], a[20:23], v[20:23], v[192:207]
    s_add_u32 s79, s79, 12288
    v_exp_f32 v180, v180
    v_exp_f32 v181, v181
    v_exp_f32 v182, v182
    v_exp_f32_e64 v183, v183
    v_cvt_pk_bf16_f32 v82, v180, v181
    v_cvt_pk_bf16_f32 v83, v182, v183
    v_mfma_f32_32x32x16_bf16 v[128:143], a[12:15], v[84:87], v[128:143]
    buffer_load_dwordx4 a[64:67], v2, s[40:43], s79 offen offset:0 sc1
    buffer_load_dwordx4 a[68:71], v2, s[40:43], s79 offen offset:1024 sc1
    buffer_load_dwordx4 a[72:75], v2, s[40:43], s79 offen offset:2048 sc1
    buffer_load_dwordx4 a[76:79], v2, s[40:43], s79 offen offset:3072 sc1
    v_exp_f32 v184, v184
    v_exp_f32 v185, v185
    v_exp_f32 v186, v186
    v_exp_f32 v187, v187
    v_cvt_pk_bf16_f32 v84, v184, v185
    v_cvt_pk_bf16_f32 v85, v186, v187
    v_mfma_f32_32x32x16_bf16 v[144:159], a[8:11], v[80:83], v[144:159]
    v_exp_f32 v188, v188
    v_exp_f32 v189, v189
    v_exp_f32 v190, v190
    v_exp_f32 v191, v191
    v_cvt_pk_bf16_f32 v86, v188, v189
    v_cvt_pk_bf16_f32 v87, v190, v191
    v_mfma_f32_32x32x16_bf16 v[208:223], a[16:19], v[24:27], 0
    v_exp_f32 v192, v192
    v_exp_f32 v193, v193
    v_exp_f32 v194, v194
    v_exp_f32 v195, v195
    v_cvt_pk_bf16_f32 v80, v192, v193
    v_cvt_pk_bf16_f32 v81, v194, v195
    v_mfma_f32_32x32x16_bf16 v[208:223], a[20:23], v[28:31], v[208:223]
    s_add_u32 s79, s79, 4096
    v_exp_f32 v196, v196
    v_exp_f32 v197, v197
    v_exp_f32 v198, v198
    v_exp_f32 v199, v199
    v_cvt_pk_bf16_f32 v82, v196, v197
    v_cvt_pk_bf16_f32 v83, v198, v199
    v_mfma_f32_32x32x16_bf16 v[144:159], a[12:15], v[84:87], v[144:159]
    buffer_load_dwordx4 a[80:83], v2, s[40:43], s79 offen offset:0 sc1
    buffer_load_dwordx4 a[84:87], v2, s[40:43], s79 offen offset:1024 sc1
    buffer_load_dwordx4 a[88:91], v2, s[40:43], s79 offen offset:2048 sc1
    buffer_load_dwordx4 a[92:95], v2, s[40:43], s79 offen offset:3072 sc1
    v_exp_f32 v200, v200
    v_exp_f32 v201, v201
    v_exp_f32 v202, v202
    v_exp_f32 v203, v203
    v_cvt_pk_bf16_f32 v84, v200, v201
    v_cvt_pk_bf16_f32 v85, v202, v203
    s_waitcnt vmcnt(17)
    v_mfma_f32_32x32x16_bf16 v[96:111], a[24:27], v[80:83], v[96:111]
    v_exp_f32 v204, v204
    v_exp_f32 v205, v205
    v_exp_f32 v206, v206
    v_exp_f32_e64 v207, v207
    v_cvt_pk_bf16_f32 v86, v204, v205
    v_cvt_pk_bf16_f32 v87, v206, v207
    v_mfma_f32_32x32x16_bf16 v[176:191], a[16:19], v[32:35], 0
    v_exp_f32 v208, v208
    v_exp_f32 v209, v209
    v_exp_f32 v210, v210
    v_exp_f32 v211, v211
    v_cvt_pk_bf16_f32 v80, v208, v209
    v_cvt_pk_bf16_f32 v81, v210, v211
    v_mfma_f32_32x32x16_bf16 v[176:191], a[20:23], v[36:39], v[176:191]
    s_add_u32 s79, s79, 12288
    v_exp_f32 v212, v212
    v_exp_f32 v213, v213
    v_exp_f32 v214, v214
    v_exp_f32 v215, v215
    v_cvt_pk_bf16_f32 v82, v212, v213
    v_cvt_pk_bf16_f32 v83, v214, v215
    s_waitcnt vmcnt(16)
    v_mfma_f32_32x32x16_bf16 v[96:111], a[28:31], v[84:87], v[96:111]
    buffer_load_dwordx4 a[96:99], v2, s[40:43], s79 offen offset:0 sc1
    buffer_load_dwordx4 a[100:103], v2, s[40:43], s79 offen offset:1024 sc1
    buffer_load_dwordx4 a[104:107], v2, s[40:43], s79 offen offset:2048 sc1
    buffer_load_dwordx4 a[108:111], v2, s[40:43], s79 offen offset:3072 sc1
    v_exp_f32 v216, v216
    v_exp_f32 v217, v217
    v_exp_f32 v218, v218
    v_exp_f32_e64 v219, v219
    v_cvt_pk_bf16_f32 v84, v216, v217
    v_cvt_pk_bf16_f32 v85, v218, v219
    v_mfma_f32_32x32x16_bf16 v[112:127], a[24:27], v[80:83], v[112:127]
    v_exp_f32 v220, v220
    v_exp_f32 v221, v221
    v_exp_f32 v222, v222
    v_exp_f32 v223, v223
    v_cvt_pk_bf16_f32 v86, v220, v221
    v_cvt_pk_bf16_f32 v87, v222, v223
    v_mfma_f32_32x32x16_bf16 v[192:207], a[16:19], v[40:43], 0
    v_exp_f32 v176, v176
    v_exp_f32 v177, v177
    v_exp_f32 v178, v178
    v_exp_f32 v179, v179
    v_cvt_pk_bf16_f32 v80, v176, v177
    v_cvt_pk_bf16_f32 v81, v178, v179
    v_mfma_f32_32x32x16_bf16 v[192:207], a[20:23], v[44:47], v[192:207]
    s_add_u32 s79, s79, 4096
    v_exp_f32 v180, v180
    v_exp_f32 v181, v181
    v_exp_f32 v182, v182
    v_exp_f32 v183, v183
    v_cvt_pk_bf16_f32 v82, v180, v181
    v_cvt_pk_bf16_f32 v83, v182, v183
    v_mfma_f32_32x32x16_bf16 v[112:127], a[28:31], v[84:87], v[112:127]
    buffer_load_dwordx4 a[0:3], v2, s[40:43], s79 offen offset:0 sc1
    buffer_load_dwordx4 a[4:7], v2, s[40:43], s79 offen offset:1024 sc1
    buffer_load_dwordx4 a[8:11], v2, s[40:43], s79 offen offset:2048 sc1
    buffer_load_dwordx4 a[12:15], v2, s[40:43], s79 offen offset:3072 sc1
    v_exp_f32 v184, v184
    v_exp_f32 v185, v185
    v_exp_f32 v186, v186
    v_exp_f32 v187, v187
    v_cvt_pk_bf16_f32 v84, v184, v185
    v_cvt_pk_bf16_f32 v85, v186, v187
    v_mfma_f32_32x32x16_bf16 v[128:143], a[24:27], v[80:83], v[128:143]
    v_exp_f32 v188, v188
    v_exp_f32 v189, v189
    v_exp_f32 v190, v190
    v_exp_f32 v191, v191
    v_cvt_pk_bf16_f32 v86, v188, v189
    v_cvt_pk_bf16_f32 v87, v190, v191
    s_waitcnt vmcnt(23)
    v_mfma_f32_32x32x16_bf16 v[208:223], a[32:35], v[16:19], 0
    v_exp_f32 v192, v192
    v_exp_f32 v193, v193
    v_exp_f32 v194, v194
    v_exp_f32_e64 v195, v195
    v_cvt_pk_bf16_f32 v80, v192, v193
    v_cvt_pk_bf16_f32 v81, v194, v195
    s_waitcnt vmcnt(22)
    v_mfma_f32_32x32x16_bf16 v[208:223], a[36:39], v[20:23], v[208:223]
    v_exp_f32 v196, v196
    v_exp_f32 v197, v197
    v_exp_f32 v198, v198
    v_exp_f32_e64 v199, v199
    v_cvt_pk_bf16_f32 v82, v196, v197
    v_cvt_pk_bf16_f32 v83, v198, v199
    v_mfma_f32_32x32x16_bf16 v[128:143], a[28:31], v[84:87], v[128:143]
    v_exp_f32 v200, v200
    v_exp_f32 v201, v201
    v_exp_f32 v202, v202
    v_exp_f32 v203, v203
    v_cvt_pk_bf16_f32 v84, v200, v201
    v_cvt_pk_bf16_f32 v85, v202, v203
    v_mfma_f32_32x32x16_bf16 v[144:159], a[24:27], v[80:83], v[144:159]
    v_exp_f32 v204, v204
    v_exp_f32 v205, v205
    v_exp_f32 v206, v206
    v_exp_f32 v207, v207
    v_cvt_pk_bf16_f32 v86, v204, v205
    v_cvt_pk_bf16_f32 v87, v206, v207
    v_mfma_f32_32x32x16_bf16 v[176:191], a[32:35], v[24:27], 0
    v_exp_f32 v208, v208
    v_exp_f32 v209, v209
    v_exp_f32 v210, v210
    v_exp_f32 v211, v211
    v_cvt_pk_bf16_f32 v80, v208, v209
    v_cvt_pk_bf16_f32 v81, v210, v211
    v_mfma_f32_32x32x16_bf16 v[176:191], a[36:39], v[28:31], v[176:191]
    s_add_u32 s79, s79, 12288
    v_exp_f32 v212, v212
    v_exp_f32 v213, v213
    v_exp_f32 v214, v214
    v_exp_f32 v215, v215
    v_cvt_pk_bf16_f32 v82, v212, v213
    v_cvt_pk_bf16_f32 v83, v214, v215
    v_mfma_f32_32x32x16_bf16 v[144:159], a[28:31], v[84:87], v[144:159]
    buffer_load_dwordx4 a[16:19], v2, s[40:43], s79 offen offset:0 sc1
    buffer_load_dwordx4 a[20:23], v2, s[40:43], s79 offen offset:1024 sc1
    buffer_load_dwordx4 a[24:27], v2, s[40:43], s79 offen offset:2048 sc1
    buffer_load_dwordx4 a[28:31], v2, s[40:43], s79 offen offset:3072 sc1
    v_exp_f32 v216, v216
    v_exp_f32 v217, v217
    v_exp_f32 v218, v218
    v_exp_f32 v219, v219
    v_cvt_pk_bf16_f32 v84, v216, v217
    v_cvt_pk_bf16_f32 v85, v218, v219
    s_waitcnt vmcnt(25)
    v_mfma_f32_32x32x16_bf16 v[96:111], a[40:43], v[80:83], v[96:111]
    v_exp_f32 v220, v220
    v_exp_f32 v221, v221
    v_exp_f32 v222, v222
    v_exp_f32_e64 v223, v223
    v_cvt_pk_bf16_f32 v86, v220, v221
    v_cvt_pk_bf16_f32 v87, v222, v223
    v_mfma_f32_32x32x16_bf16 v[192:207], a[32:35], v[32:35], 0
    v_exp_f32 v176, v176
    v_exp_f32 v177, v177
    v_exp_f32 v178, v178
    v_exp_f32 v179, v179
    v_cvt_pk_bf16_f32 v80, v176, v177
    v_cvt_pk_bf16_f32 v81, v178, v179
    v_mfma_f32_32x32x16_bf16 v[192:207], a[36:39], v[36:39], v[192:207]
    v_exp_f32 v180, v180
    v_exp_f32 v181, v181
    v_exp_f32 v182, v182
    v_exp_f32 v183, v183
    v_cvt_pk_bf16_f32 v82, v180, v181
    v_cvt_pk_bf16_f32 v83, v182, v183
    s_waitcnt vmcnt(24)
    v_mfma_f32_32x32x16_bf16 v[96:111], a[44:47], v[84:87], v[96:111]
    v_exp_f32 v184, v184
    v_exp_f32 v185, v185
    v_exp_f32 v186, v186
    v_exp_f32_e64 v187, v187
    v_cvt_pk_bf16_f32 v84, v184, v185
    v_cvt_pk_bf16_f32 v85, v186, v187
    v_mfma_f32_32x32x16_bf16 v[112:127], a[40:43], v[80:83], v[112:127]
    v_exp_f32 v188, v188
    v_exp_f32 v189, v189
    v_exp_f32 v190, v190
    v_exp_f32 v191, v191
    v_cvt_pk_bf16_f32 v86, v188, v189
    v_cvt_pk_bf16_f32 v87, v190, v191
    v_mfma_f32_32x32x16_bf16 v[208:223], a[32:35], v[40:43], 0
    v_exp_f32 v192, v192
    v_exp_f32 v193, v193
    v_exp_f32 v194, v194
    v_exp_f32 v195, v195
    v_cvt_pk_bf16_f32 v80, v192, v193
    v_cvt_pk_bf16_f32 v81, v194, v195
    v_mfma_f32_32x32x16_bf16 v[208:223], a[36:39], v[44:47], v[208:223]
    v_exp_f32 v196, v196
    v_exp_f32 v197, v197
    v_exp_f32 v198, v198
    v_exp_f32 v199, v199
    v_cvt_pk_bf16_f32 v82, v196, v197
    v_cvt_pk_bf16_f32 v83, v198, v199
    v_mfma_f32_32x32x16_bf16 v[112:127], a[44:47], v[84:87], v[112:127]
    v_exp_f32 v200, v200
    v_exp_f32 v201, v201
    v_exp_f32 v202, v202
    v_exp_f32 v203, v203
    v_cvt_pk_bf16_f32 v84, v200, v201
    v_cvt_pk_bf16_f32 v85, v202, v203
    v_mfma_f32_32x32x16_bf16 v[128:143], a[40:43], v[80:83], v[128:143]
    s_waitcnt vmcnt(20)
    v_exp_f32 v204, v204
    v_exp_f32 v205, v205
    v_exp_f32 v206, v206
    v_exp_f32_e64 v207, v207
    v_cvt_pk_bf16_f32 v86, v204, v205
    v_cvt_pk_bf16_f32 v87, v206, v207
    v_mfma_f32_32x32x16_bf16 v[176:191], a[48:51], v[16:19], 0
    s_mul_i32 s98, s44, 100352
    v_exp_f32 v208, v208
    v_exp_f32 v209, v209
    v_exp_f32 v210, v210
    v_exp_f32 v211, v211
    v_cvt_pk_bf16_f32 v80, v208, v209
    v_cvt_pk_bf16_f32 v81, v210, v211
    v_mfma_f32_32x32x16_bf16 v[176:191], a[52:55], v[20:23], v[176:191]
    s_lshl_b32 s75, s54, 7
    v_exp_f32 v212, v212
    v_exp_f32 v213, v213
    v_exp_f32 v214, v214
    v_exp_f32_e64 v215, v215
    v_cvt_pk_bf16_f32 v82, v212, v213
    v_cvt_pk_bf16_f32 v83, v214, v215
    v_mfma_f32_32x32x16_bf16 v[128:143], a[44:47], v[84:87], v[128:143]
    s_add_u32 s98, s98, s75
    v_exp_f32 v216, v216
    v_exp_f32 v217, v217
    v_exp_f32 v218, v218
    v_exp_f32_e64 v219, v219
    v_cvt_pk_bf16_f32 v84, v216, v217
    v_cvt_pk_bf16_f32 v85, v218, v219
    v_mfma_f32_32x32x16_bf16 v[144:159], a[40:43], v[80:83], v[144:159]
    s_mul_i32 s75, s44, 14336
    v_exp_f32 v220, v220
    v_exp_f32 v221, v221
    v_exp_f32 v222, v222
    v_exp_f32 v223, v223
    v_cvt_pk_bf16_f32 v86, v220, v221
    v_cvt_pk_bf16_f32 v87, v222, v223
    v_mfma_f32_32x32x16_bf16 v[192:207], a[48:51], v[24:27], 0
    s_add_u32 m0, s75, 0
    v_exp_f32 v176, v176
    v_exp_f32 v177, v177
    v_exp_f32 v178, v178
    v_exp_f32_e64 v179, v179
    v_cvt_pk_bf16_f32 v80, v176, v177
    v_cvt_pk_bf16_f32 v81, v178, v179
    v_mfma_f32_32x32x16_bf16 v[192:207], a[52:55], v[28:31], v[192:207]
    s_add_u32 s79, s79, 4096
    v_exp_f32 v180, v180
    v_exp_f32 v181, v181
    v_exp_f32 v182, v182
    v_exp_f32 v183, v183
    v_cvt_pk_bf16_f32 v82, v180, v181
    v_cvt_pk_bf16_f32 v83, v182, v183
    v_mfma_f32_32x32x16_bf16 v[144:159], a[44:47], v[84:87], v[144:159]
    buffer_load_dwordx4 a[32:35], v2, s[40:43], s79 offen offset:0 sc1
    buffer_load_dwordx4 a[36:39], v2, s[40:43], s79 offen offset:1024 sc1
    buffer_load_dwordx4 a[40:43], v2, s[40:43], s79 offen offset:2048 sc1
    buffer_load_dwordx4 a[44:47], v2, s[40:43], s79 offen offset:3072 sc1
    v_exp_f32 v184, v184
    v_exp_f32 v185, v185
    v_exp_f32 v186, v186
    v_exp_f32 v187, v187
    v_cvt_pk_bf16_f32 v84, v184, v185
    v_cvt_pk_bf16_f32 v85, v186, v187
    v_mfma_f32_32x32x16_bf16 v[96:111], a[56:59], v[80:83], v[96:111]
    s_add_u32 s99, s98, 6144
    v_exp_f32 v188, v188
    v_exp_f32 v189, v189
    v_exp_f32 v190, v190
    v_exp_f32 v191, v191
    v_cvt_pk_bf16_f32 v86, v188, v189
    v_cvt_pk_bf16_f32 v87, v190, v191
    v_mfma_f32_32x32x16_bf16 v[208:223], a[48:51], v[32:35], 0
    s_add_u32 s100, s98, 12288
    v_exp_f32 v192, v192
    v_exp_f32 v193, v193
    v_exp_f32 v194, v194
    v_exp_f32 v195, v195
    v_cvt_pk_bf16_f32 v80, v192, v193
    v_cvt_pk_bf16_f32 v81, v194, v195
    v_mfma_f32_32x32x16_bf16 v[208:223], a[52:55], v[36:39], v[208:223]
    s_add_u32 s101, s98, 18432
    v_exp_f32 v196, v196
    v_exp_f32 v197, v197
    v_exp_f32 v198, v198
    v_exp_f32 v199, v199
    v_cvt_pk_bf16_f32 v82, v196, v197
    v_cvt_pk_bf16_f32 v83, v198, v199
    v_mfma_f32_32x32x16_bf16 v[96:111], a[60:63], v[84:87], v[96:111]
    buffer_load_dwordx4 v6, s[12:15], s98 offen offset:0 lds
    buffer_load_dwordx4 v6, s[12:15], s99 offen offset:1024 lds
    buffer_load_dwordx4 v6, s[12:15], s100 offen offset:2048 lds
    buffer_load_dwordx4 v6, s[12:15], s101 offen offset:3072 lds
    v_exp_f32 v200, v200
    v_exp_f32 v201, v201
    v_exp_f32 v202, v202
    v_exp_f32 v203, v203
    v_cvt_pk_bf16_f32 v84, v200, v201
    v_cvt_pk_bf16_f32 v85, v202, v203
    v_mfma_f32_32x32x16_bf16 v[112:127], a[56:59], v[80:83], v[112:127]
    v_exp_f32 v204, v204
    v_exp_f32 v205, v205
    v_exp_f32 v206, v206
    v_exp_f32 v207, v207
    v_cvt_pk_bf16_f32 v86, v204, v205
    v_cvt_pk_bf16_f32 v87, v206, v207
    v_mfma_f32_32x32x16_bf16 v[176:191], a[48:51], v[40:43], 0
    v_exp_f32 v208, v208
    v_exp_f32 v209, v209
    v_exp_f32 v210, v210
    v_exp_f32 v211, v211
    v_cvt_pk_bf16_f32 v80, v208, v209
    v_cvt_pk_bf16_f32 v81, v210, v211
    v_mfma_f32_32x32x16_bf16 v[176:191], a[52:55], v[44:47], v[176:191]
    v_exp_f32 v212, v212
    v_exp_f32 v213, v213
    v_exp_f32 v214, v214
    v_exp_f32 v215, v215
    v_cvt_pk_bf16_f32 v82, v212, v213
    v_cvt_pk_bf16_f32 v83, v214, v215
    v_mfma_f32_32x32x16_bf16 v[112:127], a[60:63], v[84:87], v[112:127]
    s_add_u32 s98, s98, 28672
    v_exp_f32 v216, v216
    v_exp_f32 v217, v217
    v_exp_f32 v218, v218
    v_exp_f32 v219, v219
    v_cvt_pk_bf16_f32 v84, v216, v217
    v_cvt_pk_bf16_f32 v85, v218, v219
    v_mfma_f32_32x32x16_bf16 v[128:143], a[56:59], v[80:83], v[128:143]
    s_waitcnt vmcnt(24)
    v_exp_f32 v220, v220
    v_exp_f32 v221, v221
    v_exp_f32 v222, v222
    v_exp_f32_e64 v223, v223
    v_cvt_pk_bf16_f32 v86, v220, v221
    v_cvt_pk_bf16_f32 v87, v222, v223
    v_mfma_f32_32x32x16_bf16 v[192:207], a[64:67], v[16:19], 0
    s_add_u32 s99, s99, 28672
    v_exp_f32 v176, v176
    v_exp_f32 v177, v177
    v_exp_f32 v178, v178
    v_exp_f32 v179, v179
    v_cvt_pk_bf16_f32 v80, v176, v177
    v_cvt_pk_bf16_f32 v81, v178, v179
    v_mfma_f32_32x32x16_bf16 v[192:207], a[68:71], v[20:23], v[192:207]
    s_add_u32 s100, s100, 28672
    v_exp_f32 v180, v180
    v_exp_f32 v181, v181
    v_exp_f32 v182, v182
    v_exp_f32 v183, v183
    v_cvt_pk_bf16_f32 v82, v180, v181
    v_cvt_pk_bf16_f32 v83, v182, v183
    v_mfma_f32_32x32x16_bf16 v[128:143], a[60:63], v[84:87], v[128:143]
    s_add_u32 s101, s101, 28672
    v_exp_f32 v184, v184
    v_exp_f32 v185, v185
    v_exp_f32 v186, v186
    v_exp_f32 v187, v187
    v_cvt_pk_bf16_f32 v84, v184, v185
    v_cvt_pk_bf16_f32 v85, v186, v187
    v_mfma_f32_32x32x16_bf16 v[144:159], a[56:59], v[80:83], v[144:159]
    s_add_u32 m0, m0, 4096
    v_exp_f32 v188, v188
    v_exp_f32 v189, v189
    v_exp_f32 v190, v190
    v_exp_f32 v191, v191
    v_cvt_pk_bf16_f32 v86, v188, v189
    v_cvt_pk_bf16_f32 v87, v190, v191
    v_mfma_f32_32x32x16_bf16 v[208:223], a[64:67], v[24:27], 0
    buffer_load_dwordx4 v6, s[12:15], s98 offen offset:0 lds
    buffer_load_dwordx4 v6, s[12:15], s99 offen offset:1024 lds
    buffer_load_dwordx4 v6, s[12:15], s100 offen offset:2048 lds
    buffer_load_dwordx4 v6, s[12:15], s101 offen offset:3072 lds
    v_exp_f32 v192, v192
    v_exp_f32 v193, v193
    v_exp_f32 v194, v194
    v_exp_f32 v195, v195
    v_cvt_pk_bf16_f32 v80, v192, v193
    v_cvt_pk_bf16_f32 v81, v194, v195
    v_mfma_f32_32x32x16_bf16 v[208:223], a[68:71], v[28:31], v[208:223]
    s_add_u32 s79, s79, 12288
    v_exp_f32 v196, v196
    v_exp_f32 v197, v197
    v_exp_f32 v198, v198
    v_exp_f32 v199, v199
    v_cvt_pk_bf16_f32 v82, v196, v197
    v_cvt_pk_bf16_f32 v83, v198, v199
    v_mfma_f32_32x32x16_bf16 v[144:159], a[60:63], v[84:87], v[144:159]
    buffer_load_dwordx4 a[48:51], v2, s[40:43], s79 offen offset:0 sc1
    buffer_load_dwordx4 a[52:55], v2, s[40:43], s79 offen offset:1024 sc1
    buffer_load_dwordx4 a[56:59], v2, s[40:43], s79 offen offset:2048 sc1
    buffer_load_dwordx4 a[60:63], v2, s[40:43], s79 offen offset:3072 sc1
    v_exp_f32 v200, v200
    v_exp_f32 v201, v201
    v_exp_f32 v202, v202
    v_exp_f32 v203, v203
    v_cvt_pk_bf16_f32 v84, v200, v201
    v_cvt_pk_bf16_f32 v85, v202, v203
    v_mfma_f32_32x32x16_bf16 v[96:111], a[72:75], v[80:83], v[96:111]
    v_exp_f32 v204, v204
    v_exp_f32 v205, v205
    v_exp_f32 v206, v206
    v_exp_f32 v207, v207
    v_cvt_pk_bf16_f32 v86, v204, v205
    v_cvt_pk_bf16_f32 v87, v206, v207
    v_mfma_f32_32x32x16_bf16 v[176:191], a[64:67], v[32:35], 0
    v_exp_f32 v208, v208
    v_exp_f32 v209, v209
    v_exp_f32 v210, v210
    v_exp_f32 v211, v211
    v_cvt_pk_bf16_f32 v80, v208, v209
    v_cvt_pk_bf16_f32 v81, v210, v211
    v_mfma_f32_32x32x16_bf16 v[176:191], a[68:71], v[36:39], v[176:191]
    v_exp_f32 v212, v212
    v_exp_f32 v213, v213
    v_exp_f32 v214, v214
    v_exp_f32 v215, v215
    v_cvt_pk_bf16_f32 v82, v212, v213
    v_cvt_pk_bf16_f32 v83, v214, v215
    v_mfma_f32_32x32x16_bf16 v[96:111], a[76:79], v[84:87], v[96:111]
    v_exp_f32 v216, v216
    v_exp_f32 v217, v217
    v_exp_f32 v218, v218
    v_exp_f32 v219, v219
    v_cvt_pk_bf16_f32 v84, v216, v217
    v_cvt_pk_bf16_f32 v85, v218, v219
    v_mfma_f32_32x32x16_bf16 v[112:127], a[72:75], v[80:83], v[112:127]
    v_exp_f32 v220, v220
    v_exp_f32 v221, v221
    v_exp_f32 v222, v222
    v_exp_f32 v223, v223
    v_cvt_pk_bf16_f32 v86, v220, v221
    v_cvt_pk_bf16_f32 v87, v222, v223
    v_mfma_f32_32x32x16_bf16 v[192:207], a[64:67], v[40:43], 0
    s_add_u32 s98, s98, 28672
    v_exp_f32 v176, v176
    v_exp_f32 v177, v177
    v_exp_f32 v178, v178
    v_exp_f32 v179, v179
    v_cvt_pk_bf16_f32 v80, v176, v177
    v_cvt_pk_bf16_f32 v81, v178, v179
    v_mfma_f32_32x32x16_bf16 v[192:207], a[68:71], v[44:47], v[192:207]
    s_add_u32 s99, s99, 28672
    v_exp_f32 v180, v180
    v_exp_f32 v181, v181
    v_exp_f32 v182, v182
    v_exp_f32 v183, v183
    v_cvt_pk_bf16_f32 v82, v180, v181
    v_cvt_pk_bf16_f32 v83, v182, v183
    v_mfma_f32_32x32x16_bf16 v[112:127], a[76:79], v[84:87], v[112:127]
    s_add_u32 s100, s100, 28672
    v_exp_f32 v184, v184
    v_exp_f32 v185, v185
    v_exp_f32 v186, v186
    v_exp_f32 v187, v187
    v_cvt_pk_bf16_f32 v84, v184, v185
    v_cvt_pk_bf16_f32 v85, v186, v187
    v_mfma_f32_32x32x16_bf16 v[128:143], a[72:75], v[80:83], v[128:143]
    s_waitcnt vmcnt(28)
    v_exp_f32 v188, v188
    v_exp_f32 v189, v189
    v_exp_f32 v190, v190
    v_exp_f32_e64 v191, v191
    v_cvt_pk_bf16_f32 v86, v188, v189
    v_cvt_pk_bf16_f32 v87, v190, v191
    v_mfma_f32_32x32x16_bf16 v[208:223], a[80:83], v[16:19], 0
    s_add_u32 s101, s101, 28672
    v_exp_f32 v192, v192
    v_exp_f32 v193, v193
    v_exp_f32 v194, v194
    v_exp_f32 v195, v195
    v_cvt_pk_bf16_f32 v80, v192, v193
    v_cvt_pk_bf16_f32 v81, v194, v195
    v_mfma_f32_32x32x16_bf16 v[208:223], a[84:87], v[20:23], v[208:223]
    s_add_u32 m0, m0, 4096
    v_exp_f32 v196, v196
    v_exp_f32 v197, v197
    v_exp_f32 v198, v198
    v_exp_f32 v199, v199
    v_cvt_pk_bf16_f32 v82, v196, v197
    v_cvt_pk_bf16_f32 v83, v198, v199
    v_mfma_f32_32x32x16_bf16 v[128:143], a[76:79], v[84:87], v[128:143]
    buffer_load_dwordx4 v6, s[12:15], s98 offen offset:0 lds
    buffer_load_dwordx4 v6, s[12:15], s99 offen offset:1024 lds
    buffer_load_dwordx4 v6, s[12:15], s100 offen offset:2048 lds
    buffer_load_dwordx4 v6, s[12:15], s101 offen offset:3072 lds
    v_exp_f32 v200, v200
    v_exp_f32 v201, v201
    v_exp_f32 v202, v202
    v_exp_f32 v203, v203
    v_cvt_pk_bf16_f32 v84, v200, v201
    v_cvt_pk_bf16_f32 v85, v202, v203
    v_mfma_f32_32x32x16_bf16 v[144:159], a[72:75], v[80:83], v[144:159]
    v_exp_f32 v204, v204
    v_exp_f32 v205, v205
    v_exp_f32 v206, v206
    v_exp_f32 v207, v207
    v_cvt_pk_bf16_f32 v86, v204, v205
    v_cvt_pk_bf16_f32 v87, v206, v207
    v_mfma_f32_32x32x16_bf16 v[176:191], a[80:83], v[24:27], 0
    v_exp_f32 v208, v208
    v_exp_f32 v209, v209
    v_exp_f32 v210, v210
    v_exp_f32 v211, v211
    v_cvt_pk_bf16_f32 v80, v208, v209
    v_cvt_pk_bf16_f32 v81, v210, v211
    v_mfma_f32_32x32x16_bf16 v[176:191], a[84:87], v[28:31], v[176:191]
    s_add_u32 s79, s79, 4096
    v_exp_f32 v212, v212
    v_exp_f32 v213, v213
    v_exp_f32 v214, v214
    v_exp_f32 v215, v215
    v_cvt_pk_bf16_f32 v82, v212, v213
    v_cvt_pk_bf16_f32 v83, v214, v215
    v_mfma_f32_32x32x16_bf16 v[144:159], a[76:79], v[84:87], v[144:159]
    buffer_load_dwordx4 a[64:67], v2, s[40:43], s79 offen offset:0 sc1
    buffer_load_dwordx4 a[68:71], v2, s[40:43], s79 offen offset:1024 sc1
    buffer_load_dwordx4 a[72:75], v2, s[40:43], s79 offen offset:2048 sc1
    buffer_load_dwordx4 a[76:79], v2, s[40:43], s79 offen offset:3072 sc1
    v_exp_f32 v216, v216
    v_exp_f32 v217, v217
    v_exp_f32 v218, v218
    v_exp_f32 v219, v219
    v_cvt_pk_bf16_f32 v84, v216, v217
    v_cvt_pk_bf16_f32 v85, v218, v219
    v_mfma_f32_32x32x16_bf16 v[96:111], a[88:91], v[80:83], v[96:111]
    v_exp_f32 v220, v220
    v_exp_f32 v221, v221
    v_exp_f32 v222, v222
    v_exp_f32 v223, v223
    v_cvt_pk_bf16_f32 v86, v220, v221
    v_cvt_pk_bf16_f32 v87, v222, v223
    v_mfma_f32_32x32x16_bf16 v[192:207], a[80:83], v[32:35], 0
    v_exp_f32 v176, v176
    v_exp_f32 v177, v177
    v_exp_f32 v178, v178
    v_exp_f32 v179, v179
    v_cvt_pk_bf16_f32 v80, v176, v177
    v_cvt_pk_bf16_f32 v81, v178, v179
    v_mfma_f32_32x32x16_bf16 v[192:207], a[84:87], v[36:39], v[192:207]
    v_exp_f32 v180, v180
    v_exp_f32 v181, v181
    v_exp_f32 v182, v182
    v_exp_f32 v183, v183
    v_cvt_pk_bf16_f32 v82, v180, v181
    v_cvt_pk_bf16_f32 v83, v182, v183
    v_mfma_f32_32x32x16_bf16 v[96:111], a[92:95], v[84:87], v[96:111]
    s_add_u32 s98, s98, 28672
    v_exp_f32 v184, v184
    v_exp_f32 v185, v185
    v_exp_f32 v186, v186
    v_exp_f32 v187, v187
    v_cvt_pk_bf16_f32 v84, v184, v185
    v_cvt_pk_bf16_f32 v85, v186, v187
    v_mfma_f32_32x32x16_bf16 v[112:127], a[88:91], v[80:83], v[112:127]
    s_add_u32 s99, s99, 28672
    v_exp_f32 v188, v188
    v_exp_f32 v189, v189
    v_exp_f32 v190, v190
    v_exp_f32 v191, v191
    v_cvt_pk_bf16_f32 v86, v188, v189
    v_cvt_pk_bf16_f32 v87, v190, v191
    v_mfma_f32_32x32x16_bf16 v[208:223], a[80:83], v[40:43], 0
    s_add_u32 m0, m0, 4096
    v_exp_f32 v192, v192
    v_exp_f32 v193, v193
    v_exp_f32 v194, v194
    v_exp_f32 v195, v195
    v_cvt_pk_bf16_f32 v80, v192, v193
    v_cvt_pk_bf16_f32 v81, v194, v195
    v_mfma_f32_32x32x16_bf16 v[208:223], a[84:87], v[44:47], v[208:223]
    buffer_load_dwordx4 v6, s[12:15], s98 offen offset:0 lds
    buffer_load_dwordx4 v6, s[12:15], s99 offen offset:1024 lds
    v_exp_f32 v196, v196
    v_exp_f32 v197, v197
    v_exp_f32 v198, v198
    v_exp_f32 v199, v199
    v_cvt_pk_bf16_f32 v82, v196, v197
    v_cvt_pk_bf16_f32 v83, v198, v199
    v_mfma_f32_32x32x16_bf16 v[112:127], a[92:95], v[84:87], v[112:127]
    v_exp_f32 v200, v200
    v_exp_f32 v201, v201
    v_exp_f32 v202, v202
    v_exp_f32 v203, v203
    v_cvt_pk_bf16_f32 v84, v200, v201
    v_cvt_pk_bf16_f32 v85, v202, v203
    v_mfma_f32_32x32x16_bf16 v[128:143], a[88:91], v[80:83], v[128:143]
    s_waitcnt vmcnt(34)
    v_exp_f32 v204, v204
    v_exp_f32 v205, v205
    v_exp_f32 v206, v206
    v_exp_f32_e64 v207, v207
    v_cvt_pk_bf16_f32 v86, v204, v205
    v_cvt_pk_bf16_f32 v87, v206, v207
    v_mfma_f32_32x32x16_bf16 v[176:191], a[96:99], v[16:19], 0
    v_exp_f32 v208, v208
    v_exp_f32 v209, v209
    v_exp_f32 v210, v210
    v_exp_f32 v211, v211
    v_cvt_pk_bf16_f32 v80, v208, v209
    v_cvt_pk_bf16_f32 v81, v210, v211
    v_mfma_f32_32x32x16_bf16 v[176:191], a[100:103], v[20:23], v[176:191]
    v_exp_f32 v212, v212
    v_exp_f32 v213, v213
    v_exp_f32 v214, v214
    v_exp_f32 v215, v215
    v_cvt_pk_bf16_f32 v82, v212, v213
    v_cvt_pk_bf16_f32 v83, v214, v215
    v_mfma_f32_32x32x16_bf16 v[128:143], a[92:95], v[84:87], v[128:143]
    v_exp_f32 v216, v216
    v_exp_f32 v217, v217
    v_exp_f32 v218, v218
    v_exp_f32 v219, v219
    v_cvt_pk_bf16_f32 v84, v216, v217
    v_cvt_pk_bf16_f32 v85, v218, v219
    v_mfma_f32_32x32x16_bf16 v[144:159], a[88:91], v[80:83], v[144:159]
    v_exp_f32 v220, v220
    v_exp_f32 v221, v221
    v_exp_f32 v222, v222
    v_exp_f32 v223, v223
    v_cvt_pk_bf16_f32 v86, v220, v221
    v_cvt_pk_bf16_f32 v87, v222, v223
    v_mfma_f32_32x32x16_bf16 v[192:207], a[96:99], v[24:27], 0
    v_exp_f32 v176, v176
    v_exp_f32 v177, v177
    v_exp_f32 v178, v178
    v_exp_f32 v179, v179
    v_cvt_pk_bf16_f32 v80, v176, v177
    v_cvt_pk_bf16_f32 v81, v178, v179
    v_mfma_f32_32x32x16_bf16 v[192:207], a[100:103], v[28:31], v[192:207]
    s_add_u32 s79, s79, 12288
    v_exp_f32 v180, v180
    v_exp_f32 v181, v181
    v_exp_f32 v182, v182
    v_exp_f32 v183, v183
    v_cvt_pk_bf16_f32 v82, v180, v181
    v_cvt_pk_bf16_f32 v83, v182, v183
    v_mfma_f32_32x32x16_bf16 v[144:159], a[92:95], v[84:87], v[144:159]
    buffer_load_dwordx4 a[80:83], v2, s[40:43], s79 offen offset:0 sc1
    buffer_load_dwordx4 a[84:87], v2, s[40:43], s79 offen offset:1024 sc1
    buffer_load_dwordx4 a[88:91], v2, s[40:43], s79 offen offset:2048 sc1
    buffer_load_dwordx4 a[92:95], v2, s[40:43], s79 offen offset:3072 sc1
    v_exp_f32 v184, v184
    v_exp_f32 v185, v185
    v_exp_f32 v186, v186
    v_exp_f32 v187, v187
    v_cvt_pk_bf16_f32 v84, v184, v185
    v_cvt_pk_bf16_f32 v85, v186, v187
    v_mfma_f32_32x32x16_bf16 v[96:111], a[104:107], v[80:83], v[96:111]
    v_exp_f32 v188, v188
    v_exp_f32 v189, v189
    v_exp_f32 v190, v190
    v_exp_f32 v191, v191
    v_cvt_pk_bf16_f32 v86, v188, v189
    v_cvt_pk_bf16_f32 v87, v190, v191
    v_mfma_f32_32x32x16_bf16 v[208:223], a[96:99], v[32:35], 0
    s_mul_i32 s98, s44, 100352
    v_exp_f32 v192, v192
    v_exp_f32 v193, v193
    v_exp_f32 v194, v194
    v_exp_f32 v195, v195
    v_cvt_pk_bf16_f32 v80, v192, v193
    v_cvt_pk_bf16_f32 v81, v194, v195
    v_mfma_f32_32x32x16_bf16 v[208:223], a[100:103], v[36:39], v[208:223]
    s_lshl_b32 s75, s54, 7
    v_exp_f32 v196, v196
    v_exp_f32 v197, v197
    v_exp_f32 v198, v198
    v_exp_f32_e64 v199, v199
    v_cvt_pk_bf16_f32 v82, v196, v197
    v_cvt_pk_bf16_f32 v83, v198, v199
    v_mfma_f32_32x32x16_bf16 v[96:111], a[108:111], v[84:87], v[96:111]
    s_add_u32 s98, s98, s75
    v_exp_f32 v200, v200
    v_exp_f32 v201, v201
    v_exp_f32 v202, v202
    v_exp_f32_e64 v203, v203
    v_cvt_pk_bf16_f32 v84, v200, v201
    v_cvt_pk_bf16_f32 v85, v202, v203
    v_mfma_f32_32x32x16_bf16 v[112:127], a[104:107], v[80:83], v[112:127]
    s_mul_i32 s75, s44, 14336
    v_exp_f32 v204, v204
    v_exp_f32 v205, v205
    v_exp_f32 v206, v206
    v_exp_f32 v207, v207
    v_cvt_pk_bf16_f32 v86, v204, v205
    v_cvt_pk_bf16_f32 v87, v206, v207
    v_mfma_f32_32x32x16_bf16 v[176:191], a[96:99], v[40:43], 0
    s_add_u32 m0, s75, 57344
    v_exp_f32 v208, v208
    v_exp_f32 v209, v209
    v_exp_f32 v210, v210
    v_exp_f32 v211, v211
    v_cvt_pk_bf16_f32 v80, v208, v209
    v_cvt_pk_bf16_f32 v81, v210, v211
    v_mfma_f32_32x32x16_bf16 v[176:191], a[100:103], v[44:47], v[176:191]
    s_add_u32 s99, s98, 6144
    v_exp_f32 v212, v212
    v_exp_f32 v213, v213
    v_exp_f32 v214, v214
    v_exp_f32 v215, v215
    v_cvt_pk_bf16_f32 v82, v212, v213
    v_cvt_pk_bf16_f32 v83, v214, v215
    v_mfma_f32_32x32x16_bf16 v[112:127], a[108:111], v[84:87], v[112:127]
    s_add_u32 s100, s98, 12288
    v_exp_f32 v216, v216
    v_exp_f32 v217, v217
    v_exp_f32 v218, v218
    v_exp_f32 v219, v219
    v_cvt_pk_bf16_f32 v84, v216, v217
    v_cvt_pk_bf16_f32 v85, v218, v219
    v_mfma_f32_32x32x16_bf16 v[128:143], a[104:107], v[80:83], v[128:143]
    s_waitcnt vmcnt(34)
    v_exp_f32 v220, v220
    v_exp_f32 v221, v221
    v_exp_f32 v222, v222
    v_exp_f32_e64 v223, v223
    v_cvt_pk_bf16_f32 v86, v220, v221
    v_cvt_pk_bf16_f32 v87, v222, v223
    v_mfma_f32_32x32x16_bf16 v[192:207], a[0:3], v[16:19], 0
    s_add_u32 s101, s98, 18432
    v_exp_f32 v176, v176
    v_exp_f32 v177, v177
    v_exp_f32 v178, v178
    v_exp_f32 v179, v179
    v_cvt_pk_bf16_f32 v80, v176, v177
    v_cvt_pk_bf16_f32 v81, v178, v179
    v_mfma_f32_32x32x16_bf16 v[192:207], a[4:7], v[20:23], v[192:207]
    buffer_load_dwordx4 v6, s[16:19], s98 offen offset:0 lds
    buffer_load_dwordx4 v6, s[16:19], s99 offen offset:1024 lds
    buffer_load_dwordx4 v6, s[16:19], s100 offen offset:2048 lds
    buffer_load_dwordx4 v6, s[16:19], s101 offen offset:3072 lds
    v_exp_f32 v180, v180
    v_exp_f32 v181, v181
    v_exp_f32 v182, v182
    v_exp_f32 v183, v183
    v_cvt_pk_bf16_f32 v82, v180, v181
    v_cvt_pk_bf16_f32 v83, v182, v183
    v_mfma_f32_32x32x16_bf16 v[128:143], a[108:111], v[84:87], v[128:143]
    v_exp_f32 v184, v184
    v_exp_f32 v185, v185
    v_exp_f32 v186, v186
    v_exp_f32 v187, v187
    v_cvt_pk_bf16_f32 v84, v184, v185
    v_cvt_pk_bf16_f32 v85, v186, v187
    v_mfma_f32_32x32x16_bf16 v[144:159], a[104:107], v[80:83], v[144:159]
    v_exp_f32 v188, v188
    v_exp_f32 v189, v189
    v_exp_f32 v190, v190
    v_exp_f32 v191, v191
    v_cvt_pk_bf16_f32 v86, v188, v189
    v_cvt_pk_bf16_f32 v87, v190, v191
    v_mfma_f32_32x32x16_bf16 v[208:223], a[0:3], v[24:27], 0
    v_exp_f32 v192, v192
    v_exp_f32 v193, v193
    v_exp_f32 v194, v194
    v_exp_f32 v195, v195
    v_cvt_pk_bf16_f32 v80, v192, v193
    v_cvt_pk_bf16_f32 v81, v194, v195
    v_mfma_f32_32x32x16_bf16 v[208:223], a[4:7], v[28:31], v[208:223]
    s_add_u32 s79, s79, 4096
    v_exp_f32 v196, v196
    v_exp_f32 v197, v197
    v_exp_f32 v198, v198
    v_exp_f32 v199, v199
    v_cvt_pk_bf16_f32 v82, v196, v197
    v_cvt_pk_bf16_f32 v83, v198, v199
    v_mfma_f32_32x32x16_bf16 v[144:159], a[108:111], v[84:87], v[144:159]
    buffer_load_dwordx4 a[96:99], v2, s[40:43], s79 offen offset:0 sc1
    buffer_load_dwordx4 a[100:103], v2, s[40:43], s79 offen offset:1024 sc1
    buffer_load_dwordx4 a[104:107], v2, s[40:43], s79 offen offset:2048 sc1
    buffer_load_dwordx4 a[108:111], v2, s[40:43], s79 offen offset:3072 sc1
    v_exp_f32 v200, v200
    v_exp_f32 v201, v201
    v_exp_f32 v202, v202
    v_exp_f32 v203, v203
    v_cvt_pk_bf16_f32 v84, v200, v201
    v_cvt_pk_bf16_f32 v85, v202, v203
    v_mfma_f32_32x32x16_bf16 v[96:111], a[8:11], v[80:83], v[96:111]
    s_add_u32 s98, s98, 28672
    v_exp_f32 v204, v204
    v_exp_f32 v205, v205
    v_exp_f32 v206, v206
    v_exp_f32 v207, v207
    v_cvt_pk_bf16_f32 v86, v204, v205
    v_cvt_pk_bf16_f32 v87, v206, v207
    v_mfma_f32_32x32x16_bf16 v[176:191], a[0:3], v[32:35], 0
    s_add_u32 s99, s99, 28672
    v_exp_f32 v208, v208
    v_exp_f32 v209, v209
    v_exp_f32 v210, v210
    v_exp_f32 v211, v211
    v_cvt_pk_bf16_f32 v80, v208, v209
    v_cvt_pk_bf16_f32 v81, v210, v211
    v_mfma_f32_32x32x16_bf16 v[176:191], a[4:7], v[36:39], v[176:191]
    s_add_u32 s100, s100, 28672
    v_exp_f32 v212, v212
    v_exp_f32 v213, v213
    v_exp_f32 v214, v214
    v_exp_f32 v215, v215
    v_cvt_pk_bf16_f32 v82, v212, v213
    v_cvt_pk_bf16_f32 v83, v214, v215
    v_mfma_f32_32x32x16_bf16 v[96:111], a[12:15], v[84:87], v[96:111]
    s_add_u32 s101, s101, 28672
    v_exp_f32 v216, v216
    v_exp_f32 v217, v217
    v_exp_f32 v218, v218
    v_exp_f32 v219, v219
    v_cvt_pk_bf16_f32 v84, v216, v217
    v_cvt_pk_bf16_f32 v85, v218, v219
    v_mfma_f32_32x32x16_bf16 v[112:127], a[8:11], v[80:83], v[112:127]
    s_add_u32 m0, m0, 4096
    v_exp_f32 v220, v220
    v_exp_f32 v221, v221
    v_exp_f32 v222, v222
    v_exp_f32 v223, v223
    v_cvt_pk_bf16_f32 v86, v220, v221
    v_cvt_pk_bf16_f32 v87, v222, v223
    v_mfma_f32_32x32x16_bf16 v[192:207], a[0:3], v[40:43], 0
    buffer_load_dwordx4 v6, s[16:19], s98 offen offset:0 lds
    buffer_load_dwordx4 v6, s[16:19], s99 offen offset:1024 lds
    buffer_load_dwordx4 v6, s[16:19], s100 offen offset:2048 lds
    buffer_load_dwordx4 v6, s[16:19], s101 offen offset:3072 lds
    v_exp_f32 v176, v176
    v_exp_f32 v177, v177
    v_exp_f32 v178, v178
    v_exp_f32 v179, v179
    v_cvt_pk_bf16_f32 v80, v176, v177
    v_cvt_pk_bf16_f32 v81, v178, v179
    v_mfma_f32_32x32x16_bf16 v[192:207], a[4:7], v[44:47], v[192:207]
    v_exp_f32 v180, v180
    v_exp_f32 v181, v181
    v_exp_f32 v182, v182
    v_exp_f32 v183, v183
    v_cvt_pk_bf16_f32 v82, v180, v181
    v_cvt_pk_bf16_f32 v83, v182, v183
    v_mfma_f32_32x32x16_bf16 v[112:127], a[12:15], v[84:87], v[112:127]
    v_exp_f32 v184, v184
    v_exp_f32 v185, v185
    v_exp_f32 v186, v186
    v_exp_f32 v187, v187
    v_cvt_pk_bf16_f32 v84, v184, v185
    v_cvt_pk_bf16_f32 v85, v186, v187
    v_mfma_f32_32x32x16_bf16 v[128:143], a[8:11], v[80:83], v[128:143]
    s_waitcnt vmcnt(42)
    v_exp_f32 v188, v188
    v_exp_f32 v189, v189
    v_exp_f32 v190, v190
    v_exp_f32_e64 v191, v191
    v_cvt_pk_bf16_f32 v86, v188, v189
    v_cvt_pk_bf16_f32 v87, v190, v191
    v_mfma_f32_32x32x16_bf16 v[208:223], a[16:19], v[16:19], 0
    v_exp_f32 v192, v192
    v_exp_f32 v193, v193
    v_exp_f32 v194, v194
    v_exp_f32 v195, v195
    v_cvt_pk_bf16_f32 v80, v192, v193
    v_cvt_pk_bf16_f32 v81, v194, v195
    v_mfma_f32_32x32x16_bf16 v[208:223], a[20:23], v[20:23], v[208:223]
    v_exp_f32 v196, v196
    v_exp_f32 v197, v197
    v_exp_f32 v198, v198
    v_exp_f32 v199, v199
    v_cvt_pk_bf16_f32 v82, v196, v197
    v_cvt_pk_bf16_f32 v83, v198, v199
    v_mfma_f32_32x32x16_bf16 v[128:143], a[12:15], v[84:87], v[128:143]
    v_exp_f32 v200, v200
    v_exp_f32 v201, v201
    v_exp_f32 v202, v202
    v_exp_f32 v203, v203
    v_cvt_pk_bf16_f32 v84, v200, v201
    v_cvt_pk_bf16_f32 v85, v202, v203
    v_mfma_f32_32x32x16_bf16 v[144:159], a[8:11], v[80:83], v[144:159]
    v_exp_f32 v204, v204
    v_exp_f32 v205, v205
    v_exp_f32 v206, v206
    v_exp_f32 v207, v207
    v_cvt_pk_bf16_f32 v86, v204, v205
    v_cvt_pk_bf16_f32 v87, v206, v207
    v_mfma_f32_32x32x16_bf16 v[176:191], a[16:19], v[24:27], 0
    s_add_u32 s98, s98, 28672
    v_exp_f32 v208, v208
    v_exp_f32 v209, v209
    v_exp_f32 v210, v210
    v_exp_f32 v211, v211
    v_cvt_pk_bf16_f32 v80, v208, v209
    v_cvt_pk_bf16_f32 v81, v210, v211
    v_mfma_f32_32x32x16_bf16 v[176:191], a[20:23], v[28:31], v[176:191]
    s_add_u32 s79, s79, 12288
    v_exp_f32 v212, v212
    v_exp_f32 v213, v213
    v_exp_f32 v214, v214
    v_exp_f32 v215, v215
    v_cvt_pk_bf16_f32 v82, v212, v213
    v_cvt_pk_bf16_f32 v83, v214, v215
    v_mfma_f32_32x32x16_bf16 v[144:159], a[12:15], v[84:87], v[144:159]
    buffer_load_dwordx4 a[0:3], v2, s[40:43], s79 offen offset:0 sc1
    buffer_load_dwordx4 a[4:7], v2, s[40:43], s79 offen offset:1024 sc1
    buffer_load_dwordx4 a[8:11], v2, s[40:43], s79 offen offset:2048 sc1
    buffer_load_dwordx4 a[12:15], v2, s[40:43], s79 offen offset:3072 sc1
    v_exp_f32 v216, v216
    v_exp_f32 v217, v217
    v_exp_f32 v218, v218
    v_exp_f32 v219, v219
    v_cvt_pk_bf16_f32 v84, v216, v217
    v_cvt_pk_bf16_f32 v85, v218, v219
    v_mfma_f32_32x32x16_bf16 v[96:111], a[24:27], v[80:83], v[96:111]
    s_add_u32 s99, s99, 28672
    v_exp_f32 v220, v220
    v_exp_f32 v221, v221
    v_exp_f32 v222, v222
    v_exp_f32 v223, v223
    v_cvt_pk_bf16_f32 v86, v220, v221
    v_cvt_pk_bf16_f32 v87, v222, v223
    v_mfma_f32_32x32x16_bf16 v[192:207], a[16:19], v[32:35], 0
    s_add_u32 s100, s100, 28672
    v_exp_f32 v176, v176
    v_exp_f32 v177, v177
    v_exp_f32 v178, v178
    v_exp_f32 v179, v179
    v_cvt_pk_bf16_f32 v80, v176, v177
    v_cvt_pk_bf16_f32 v81, v178, v179
    v_mfma_f32_32x32x16_bf16 v[192:207], a[20:23], v[36:39], v[192:207]
    s_add_u32 s101, s101, 28672
    v_exp_f32 v180, v180
    v_exp_f32 v181, v181
    v_exp_f32 v182, v182
    v_exp_f32 v183, v183
    v_cvt_pk_bf16_f32 v82, v180, v181
    v_cvt_pk_bf16_f32 v83, v182, v183
    v_mfma_f32_32x32x16_bf16 v[96:111], a[28:31], v[84:87], v[96:111]
    s_add_u32 m0, m0, 4096
    v_exp_f32 v184, v184
    v_exp_f32 v185, v185
    v_exp_f32 v186, v186
    v_exp_f32 v187, v187
    v_cvt_pk_bf16_f32 v84, v184, v185
    v_cvt_pk_bf16_f32 v85, v186, v187
    v_mfma_f32_32x32x16_bf16 v[112:127], a[24:27], v[80:83], v[112:127]
    buffer_load_dwordx4 v6, s[16:19], s98 offen offset:0 lds
    buffer_load_dwordx4 v6, s[16:19], s99 offen offset:1024 lds
    buffer_load_dwordx4 v6, s[16:19], s100 offen offset:2048 lds
    buffer_load_dwordx4 v6, s[16:19], s101 offen offset:3072 lds
    v_exp_f32 v188, v188
    v_exp_f32 v189, v189
    v_exp_f32 v190, v190
    v_exp_f32 v191, v191
    v_cvt_pk_bf16_f32 v86, v188, v189
    v_cvt_pk_bf16_f32 v87, v190, v191
    v_mfma_f32_32x32x16_bf16 v[208:223], a[16:19], v[40:43], 0
    v_exp_f32 v192, v192
    v_exp_f32 v193, v193
    v_exp_f32 v194, v194
    v_exp_f32 v195, v195
    v_cvt_pk_bf16_f32 v80, v192, v193
    v_cvt_pk_bf16_f32 v81, v194, v195
    v_mfma_f32_32x32x16_bf16 v[208:223], a[20:23], v[44:47], v[208:223]
    v_exp_f32 v196, v196
    v_exp_f32 v197, v197
    v_exp_f32 v198, v198
    v_exp_f32 v199, v199
    v_cvt_pk_bf16_f32 v82, v196, v197
    v_cvt_pk_bf16_f32 v83, v198, v199
    v_mfma_f32_32x32x16_bf16 v[112:127], a[28:31], v[84:87], v[112:127]
    v_exp_f32 v200, v200
    v_exp_f32 v201, v201
    v_exp_f32 v202, v202
    v_exp_f32 v203, v203
    v_cvt_pk_bf16_f32 v84, v200, v201
    v_cvt_pk_bf16_f32 v85, v202, v203
    v_mfma_f32_32x32x16_bf16 v[128:143], a[24:27], v[80:83], v[128:143]
    s_waitcnt vmcnt(46)
    v_exp_f32 v204, v204
    v_exp_f32 v205, v205
    v_exp_f32 v206, v206
    v_exp_f32_e64 v207, v207
    v_cvt_pk_bf16_f32 v86, v204, v205
    v_cvt_pk_bf16_f32 v87, v206, v207
    v_mfma_f32_32x32x16_bf16 v[176:191], a[32:35], v[16:19], 0
    v_exp_f32 v208, v208
    v_exp_f32 v209, v209
    v_exp_f32 v210, v210
    v_exp_f32 v211, v211
    v_cvt_pk_bf16_f32 v80, v208, v209
    v_cvt_pk_bf16_f32 v81, v210, v211
    v_mfma_f32_32x32x16_bf16 v[176:191], a[36:39], v[20:23], v[176:191]
    v_exp_f32 v212, v212
    v_exp_f32 v213, v213
    v_exp_f32 v214, v214
    v_exp_f32 v215, v215
    v_cvt_pk_bf16_f32 v82, v212, v213
    v_cvt_pk_bf16_f32 v83, v214, v215
    v_mfma_f32_32x32x16_bf16 v[128:143], a[28:31], v[84:87], v[128:143]
    s_add_u32 s98, s98, 28672
    v_exp_f32 v216, v216
    v_exp_f32 v217, v217
    v_exp_f32 v218, v218
    v_exp_f32 v219, v219
    v_cvt_pk_bf16_f32 v84, v216, v217
    v_cvt_pk_bf16_f32 v85, v218, v219
    v_mfma_f32_32x32x16_bf16 v[144:159], a[24:27], v[80:83], v[144:159]
    s_add_u32 s99, s99, 28672
    v_exp_f32 v220, v220
    v_exp_f32 v221, v221
    v_exp_f32 v222, v222
    v_exp_f32 v223, v223
    v_cvt_pk_bf16_f32 v86, v220, v221
    v_cvt_pk_bf16_f32 v87, v222, v223
    v_mfma_f32_32x32x16_bf16 v[192:207], a[32:35], v[24:27], 0
    s_add_u32 m0, m0, 4096
    v_exp_f32 v176, v176
    v_exp_f32 v177, v177
    v_exp_f32 v178, v178
    v_exp_f32 v179, v179
    v_cvt_pk_bf16_f32 v80, v176, v177
    v_cvt_pk_bf16_f32 v81, v178, v179
    v_mfma_f32_32x32x16_bf16 v[192:207], a[36:39], v[28:31], v[192:207]
    s_add_u32 s79, s79, 4096
    v_exp_f32 v180, v180
    v_exp_f32 v181, v181
    v_exp_f32 v182, v182
    v_exp_f32 v183, v183
    v_cvt_pk_bf16_f32 v82, v180, v181
    v_cvt_pk_bf16_f32 v83, v182, v183
    v_mfma_f32_32x32x16_bf16 v[144:159], a[28:31], v[84:87], v[144:159]
    buffer_load_dwordx4 a[16:19], v2, s[40:43], s79 offen offset:0 sc1
    buffer_load_dwordx4 a[20:23], v2, s[40:43], s79 offen offset:1024 sc1
    buffer_load_dwordx4 a[24:27], v2, s[40:43], s79 offen offset:2048 sc1
    buffer_load_dwordx4 a[28:31], v2, s[40:43], s79 offen offset:3072 sc1
    v_exp_f32 v184, v184
    v_exp_f32 v185, v185
    v_exp_f32 v186, v186
    v_exp_f32 v187, v187
    v_cvt_pk_bf16_f32 v84, v184, v185
    v_cvt_pk_bf16_f32 v85, v186, v187
    v_mfma_f32_32x32x16_bf16 v[96:111], a[40:43], v[80:83], v[96:111]
    buffer_load_dwordx4 v6, s[16:19], s98 offen offset:0 lds
    buffer_load_dwordx4 v6, s[16:19], s99 offen offset:1024 lds
    v_exp_f32 v188, v188
    v_exp_f32 v189, v189
    v_exp_f32 v190, v190
    v_exp_f32 v191, v191
    v_cvt_pk_bf16_f32 v86, v188, v189
    v_cvt_pk_bf16_f32 v87, v190, v191
    v_mfma_f32_32x32x16_bf16 v[208:223], a[32:35], v[32:35], 0
    v_exp_f32 v192, v192
    v_exp_f32 v193, v193
    v_exp_f32 v194, v194
    v_exp_f32 v195, v195
    v_cvt_pk_bf16_f32 v80, v192, v193
    v_cvt_pk_bf16_f32 v81, v194, v195
    v_mfma_f32_32x32x16_bf16 v[208:223], a[36:39], v[36:39], v[208:223]
    v_exp_f32 v196, v196
    v_exp_f32 v197, v197
    v_exp_f32 v198, v198
    v_exp_f32 v199, v199
    v_cvt_pk_bf16_f32 v82, v196, v197
    v_cvt_pk_bf16_f32 v83, v198, v199
    v_mfma_f32_32x32x16_bf16 v[96:111], a[44:47], v[84:87], v[96:111]
    v_exp_f32 v200, v200
    v_exp_f32 v201, v201
    v_exp_f32 v202, v202
    v_exp_f32 v203, v203
    v_cvt_pk_bf16_f32 v84, v200, v201
    v_cvt_pk_bf16_f32 v85, v202, v203
    v_mfma_f32_32x32x16_bf16 v[112:127], a[40:43], v[80:83], v[112:127]
    v_exp_f32 v204, v204
    v_exp_f32 v205, v205
    v_exp_f32 v206, v206
    v_exp_f32 v207, v207
    v_cvt_pk_bf16_f32 v86, v204, v205
    v_cvt_pk_bf16_f32 v87, v206, v207
    v_mfma_f32_32x32x16_bf16 v[176:191], a[32:35], v[40:43], 0
    v_exp_f32 v208, v208
    v_exp_f32 v209, v209
    v_exp_f32 v210, v210
    v_exp_f32 v211, v211
    v_cvt_pk_bf16_f32 v80, v208, v209
    v_cvt_pk_bf16_f32 v81, v210, v211
    v_mfma_f32_32x32x16_bf16 v[176:191], a[36:39], v[44:47], v[176:191]
    v_exp_f32 v212, v212
    v_exp_f32 v213, v213
    v_exp_f32 v214, v214
    v_exp_f32 v215, v215
    v_cvt_pk_bf16_f32 v82, v212, v213
    v_cvt_pk_bf16_f32 v83, v214, v215
    v_mfma_f32_32x32x16_bf16 v[112:127], a[44:47], v[84:87], v[112:127]
    v_exp_f32 v216, v216
    v_exp_f32 v217, v217
    v_exp_f32 v218, v218
    v_exp_f32 v219, v219
    v_cvt_pk_bf16_f32 v84, v216, v217
    v_cvt_pk_bf16_f32 v85, v218, v219
    v_mfma_f32_32x32x16_bf16 v[128:143], a[40:43], v[80:83], v[128:143]
    s_waitcnt vmcnt(40)
    v_exp_f32 v220, v220
    v_exp_f32 v221, v221
    v_exp_f32 v222, v222
    v_exp_f32_e64 v223, v223
    v_cvt_pk_bf16_f32 v86, v220, v221
    v_cvt_pk_bf16_f32 v87, v222, v223
    v_mfma_f32_32x32x16_bf16 v[192:207], a[48:51], v[16:19], 0
    s_lshl_b32 s75, s2, 2
    v_exp_f32 v176, v176
    v_exp_f32 v177, v177
    v_exp_f32 v178, v178
    v_exp_f32_e64 v179, v179
    v_cvt_pk_bf16_f32 v80, v176, v177
    v_cvt_pk_bf16_f32 v81, v178, v179
    v_mfma_f32_32x32x16_bf16 v[192:207], a[52:55], v[20:23], v[192:207]
    s_add_u32 s75, s75, s44
    v_exp_f32 v180, v180
    v_exp_f32 v181, v181
    v_exp_f32 v182, v182
    v_exp_f32_e64 v183, v183
    v_cvt_pk_bf16_f32 v82, v180, v181
    v_cvt_pk_bf16_f32 v83, v182, v183
    v_mfma_f32_32x32x16_bf16 v[128:143], a[44:47], v[84:87], v[128:143]
    s_mul_i32 s75, s75, 1568
    v_exp_f32 v184, v184
    v_exp_f32 v185, v185
    v_exp_f32 v186, v186
    v_exp_f32 v187, v187
    v_cvt_pk_bf16_f32 v84, v184, v185
    v_cvt_pk_bf16_f32 v85, v186, v187
    v_mfma_f32_32x32x16_bf16 v[144:159], a[40:43], v[80:83], v[144:159]
    s_cmp_lg_u32 s47, 0
    s_cbranch_scc1 L_l0_15
    buffer_load_dwordx4 v[64:67], v2, s[28:31], s75 offen offset:0
    buffer_load_dwordx4 v[64:67], v2, s[28:31], s75 offen offset:1024
L_l0_15:
    v_exp_f32 v188, v188
    v_exp_f32 v189, v189
    v_exp_f32 v190, v190
    v_exp_f32 v191, v191
    v_cvt_pk_bf16_f32 v86, v188, v189
    v_cvt_pk_bf16_f32 v87, v190, v191
    v_mfma_f32_32x32x16_bf16 v[208:223], a[48:51], v[24:27], 0
    v_exp_f32 v192, v192
    v_exp_f32 v193, v193
    v_exp_f32 v194, v194
    v_exp_f32 v195, v195
    v_cvt_pk_bf16_f32 v80, v192, v193
    v_cvt_pk_bf16_f32 v81, v194, v195
    v_mfma_f32_32x32x16_bf16 v[208:223], a[52:55], v[28:31], v[208:223]
    v_exp_f32 v196, v196
    v_exp_f32 v197, v197
    v_exp_f32 v198, v198
    v_exp_f32 v199, v199
    v_cvt_pk_bf16_f32 v82, v196, v197
    v_cvt_pk_bf16_f32 v83, v198, v199
    v_mfma_f32_32x32x16_bf16 v[144:159], a[44:47], v[84:87], v[144:159]
    v_exp_f32 v200, v200
    v_exp_f32 v201, v201
    v_exp_f32 v202, v202
    v_exp_f32 v203, v203
    v_cvt_pk_bf16_f32 v84, v200, v201
    v_cvt_pk_bf16_f32 v85, v202, v203
    v_mfma_f32_32x32x16_bf16 v[96:111], a[56:59], v[80:83], v[96:111]
    v_exp_f32 v204, v204
    v_exp_f32 v205, v205
    v_exp_f32 v206, v206
    v_exp_f32 v207, v207
    v_cvt_pk_bf16_f32 v86, v204, v205
    v_cvt_pk_bf16_f32 v87, v206, v207
    v_mfma_f32_32x32x16_bf16 v[176:191], a[48:51], v[32:35], 0
    v_exp_f32 v208, v208
    v_exp_f32 v209, v209
    v_exp_f32 v210, v210
    v_exp_f32 v211, v211
    v_cvt_pk_bf16_f32 v80, v208, v209
    v_cvt_pk_bf16_f32 v81, v210, v211
    v_mfma_f32_32x32x16_bf16 v[176:191], a[52:55], v[36:39], v[176:191]
    v_exp_f32 v212, v212
    v_exp_f32 v213, v213
    v_exp_f32 v214, v214
    v_exp_f32 v215, v215
    v_cvt_pk_bf16_f32 v82, v212, v213
    v_cvt_pk_bf16_f32 v83, v214, v215
    v_mfma_f32_32x32x16_bf16 v[96:111], a[60:63], v[84:87], v[96:111]
    v_exp_f32 v216, v216
    v_exp_f32 v217, v217
    v_exp_f32 v218, v218
    v_exp_f32 v219, v219
    v_cvt_pk_bf16_f32 v84, v216, v217
    v_cvt_pk_bf16_f32 v85, v218, v219
    v_mfma_f32_32x32x16_bf16 v[112:127], a[56:59], v[80:83], v[112:127]
    v_exp_f32 v220, v220
    v_exp_f32 v221, v221
    v_exp_f32 v222, v222
    v_exp_f32 v223, v223
    v_cvt_pk_bf16_f32 v86, v220, v221
    v_cvt_pk_bf16_f32 v87, v222, v223
    v_mfma_f32_32x32x16_bf16 v[192:207], a[48:51], v[40:43], 0
    v_exp_f32 v176, v176
    v_exp_f32 v177, v177
    v_exp_f32 v178, v178
    v_exp_f32 v179, v179
    v_cvt_pk_bf16_f32 v80, v176, v177
    v_cvt_pk_bf16_f32 v81, v178, v179
    v_mfma_f32_32x32x16_bf16 v[192:207], a[52:55], v[44:47], v[192:207]
    v_exp_f32 v180, v180
    v_exp_f32 v181, v181
    v_exp_f32 v182, v182
    v_exp_f32 v183, v183
    v_cvt_pk_bf16_f32 v82, v180, v181
    v_cvt_pk_bf16_f32 v83, v182, v183
    v_mfma_f32_32x32x16_bf16 v[112:127], a[60:63], v[84:87], v[112:127]
    s_lshl_b32 s75, s46, 2
    v_exp_f32 v184, v184
    v_exp_f32 v185, v185
    v_exp_f32 v186, v186
    v_exp_f32_e64 v187, v187
    v_cvt_pk_bf16_f32 v84, v184, v185
    v_cvt_pk_bf16_f32 v85, v186, v187
    v_mfma_f32_32x32x16_bf16 v[128:143], a[56:59], v[80:83], v[128:143]
    s_waitcnt vmcnt(32)
    v_exp_f32 v188, v188
    v_exp_f32 v189, v189
    v_exp_f32 v190, v190
    v_exp_f32_e64 v191, v191
    v_cvt_pk_bf16_f32 v86, v188, v189
    v_cvt_pk_bf16_f32 v87, v190, v191
    v_mfma_f32_32x32x16_bf16 v[208:223], a[64:67], v[16:19], 0
    s_add_u32 s75, s75, s44
    v_exp_f32 v192, v192
    v_exp_f32 v193, v193
    v_exp_f32 v194, v194
    v_exp_f32_e64 v195, v195
    v_cvt_pk_bf16_f32 v80, v192, v193
    v_cvt_pk_bf16_f32 v81, v194, v195
    v_mfma_f32_32x32x16_bf16 v[208:223], a[68:71], v[20:23], v[208:223]
    s_mul_i32 s75, s75, 3136
    v_exp_f32 v196, v196
    v_exp_f32 v197, v197
    v_exp_f32 v198, v198
    v_exp_f32 v199, v199
    v_cvt_pk_bf16_f32 v82, v196, v197
    v_cvt_pk_bf16_f32 v83, v198, v199
    v_mfma_f32_32x32x16_bf16 v[128:143], a[60:63], v[84:87], v[128:143]
    buffer_load_dwordx4 v[64:67], v2, s[20:23], s75 offen offset:0
    buffer_load_dwordx4 v[64:67], v2, s[20:23], s75 offen offset:1024
    buffer_load_dwordx4 v[64:67], v2, s[20:23], s75 offen offset:2048
    buffer_load_dwordx4 v[64:67], v2, s[20:23], s75 offen offset:3072
    v_exp_f32 v200, v200
    v_exp_f32 v201, v201
    v_exp_f32 v202, v202
    v_exp_f32 v203, v203
    v_cvt_pk_bf16_f32 v84, v200, v201
    v_cvt_pk_bf16_f32 v85, v202, v203
    v_mfma_f32_32x32x16_bf16 v[144:159], a[56:59], v[80:83], v[144:159]
    v_exp_f32 v204, v204
    v_exp_f32 v205, v205
    v_exp_f32 v206, v206
    v_exp_f32 v207, v207
    v_cvt_pk_bf16_f32 v86, v204, v205
    v_cvt_pk_bf16_f32 v87, v206, v207
    v_mfma_f32_32x32x16_bf16 v[176:191], a[64:67], v[24:27], 0
    v_exp_f32 v208, v208
    v_exp_f32 v209, v209
    v_exp_f32 v210, v210
    v_exp_f32 v211, v211
    v_cvt_pk_bf16_f32 v80, v208, v209
    v_cvt_pk_bf16_f32 v81, v210, v211
    v_mfma_f32_32x32x16_bf16 v[176:191], a[68:71], v[28:31], v[176:191]
    v_exp_f32 v212, v212
    v_exp_f32 v213, v213
    v_exp_f32 v214, v214
    v_exp_f32 v215, v215
    v_cvt_pk_bf16_f32 v82, v212, v213
    v_cvt_pk_bf16_f32 v83, v214, v215
    v_mfma_f32_32x32x16_bf16 v[144:159], a[60:63], v[84:87], v[144:159]
    v_exp_f32 v216, v216
    v_exp_f32 v217, v217
    v_exp_f32 v218, v218
    v_exp_f32 v219, v219
    v_cvt_pk_bf16_f32 v84, v216, v217
    v_cvt_pk_bf16_f32 v85, v218, v219
    v_mfma_f32_32x32x16_bf16 v[96:111], a[72:75], v[80:83], v[96:111]
    v_exp_f32 v220, v220
    v_exp_f32 v221, v221
    v_exp_f32 v222, v222
    v_exp_f32 v223, v223
    v_cvt_pk_bf16_f32 v86, v220, v221
    v_cvt_pk_bf16_f32 v87, v222, v223
    v_mfma_f32_32x32x16_bf16 v[192:207], a[64:67], v[32:35], 0
    v_exp_f32 v176, v176
    v_exp_f32 v177, v177
    v_exp_f32 v178, v178
    v_exp_f32 v179, v179
    v_cvt_pk_bf16_f32 v80, v176, v177
    v_cvt_pk_bf16_f32 v81, v178, v179
    v_mfma_f32_32x32x16_bf16 v[192:207], a[68:71], v[36:39], v[192:207]
    v_exp_f32 v180, v180
    v_exp_f32 v181, v181
    v_exp_f32 v182, v182
    v_exp_f32 v183, v183
    v_cvt_pk_bf16_f32 v82, v180, v181
    v_cvt_pk_bf16_f32 v83, v182, v183
    v_mfma_f32_32x32x16_bf16 v[96:111], a[76:79], v[84:87], v[96:111]
    v_exp_f32 v184, v184
    v_exp_f32 v185, v185
    v_exp_f32 v186, v186
    v_exp_f32 v187, v187
    v_cvt_pk_bf16_f32 v84, v184, v185
    v_cvt_pk_bf16_f32 v85, v186, v187
    v_mfma_f32_32x32x16_bf16 v[112:127], a[72:75], v[80:83], v[112:127]
    v_exp_f32 v188, v188
    v_exp_f32 v189, v189
    v_exp_f32 v190, v190
    v_exp_f32 v191, v191
    v_cvt_pk_bf16_f32 v86, v188, v189
    v_cvt_pk_bf16_f32 v87, v190, v191
    v_mfma_f32_32x32x16_bf16 v[208:223], a[64:67], v[40:43], 0
    s_lshl_b32 s75, s46, 2
    v_exp_f32 v192, v192
    v_exp_f32 v193, v193
    v_exp_f32 v194, v194
    v_exp_f32_e64 v195, v195
    v_cvt_pk_bf16_f32 v80, v192, v193
    v_cvt_pk_bf16_f32 v81, v194, v195
    v_mfma_f32_32x32x16_bf16 v[208:223], a[68:71], v[44:47], v[208:223]
    s_add_u32 s75, s75, s44
    v_exp_f32 v196, v196
    v_exp_f32 v197, v197
    v_exp_f32 v198, v198
    v_exp_f32_e64 v199, v199
    v_cvt_pk_bf16_f32 v82, v196, v197
    v_cvt_pk_bf16_f32 v83, v198, v199
    v_mfma_f32_32x32x16_bf16 v[112:127], a[76:79], v[84:87], v[112:127]
    s_mul_i32 s75, s75, 12544
    v_exp_f32 v200, v200
    v_exp_f32 v201, v201
    v_exp_f32 v202, v202
    v_exp_f32 v203, v203
    v_cvt_pk_bf16_f32 v84, v200, v201
    v_cvt_pk_bf16_f32 v85, v202, v203
    v_mfma_f32_32x32x16_bf16 v[128:143], a[72:75], v[80:83], v[128:143]
    s_waitcnt vmcnt(30)
    v_exp_f32 v204, v204
    v_exp_f32 v205, v205
    v_exp_f32 v206, v206
    v_exp_f32_e64 v207, v207
    v_cvt_pk_bf16_f32 v86, v204, v205
    v_cvt_pk_bf16_f32 v87, v206, v207
    v_mfma_f32_32x32x16_bf16 v[176:191], a[80:83], v[16:19], 0
    buffer_load_dwordx4 v[64:67], v2, s[24:27], s75 offen offset:0
    buffer_load_dwordx4 v[64:67], v2, s[24:27], s75 offen offset:1024
    buffer_load_dwordx4 v[64:67], v2, s[24:27], s75 offen offset:2048
    buffer_load_dwordx4 v[64:67], v2, s[24:27], s75 offen offset:3072
    v_exp_f32 v208, v208
    v_exp_f32 v209, v209
    v_exp_f32 v210, v210
    v_exp_f32 v211, v211
    v_cvt_pk_bf16_f32 v80, v208, v209
    v_cvt_pk_bf16_f32 v81, v210, v211
    v_mfma_f32_32x32x16_bf16 v[176:191], a[84:87], v[20:23], v[176:191]
    v_exp_f32 v212, v212
    v_exp_f32 v213, v213
    v_exp_f32 v214, v214
    v_exp_f32 v215, v215
    v_cvt_pk_bf16_f32 v82, v212, v213
    v_cvt_pk_bf16_f32 v83, v214, v215
    v_mfma_f32_32x32x16_bf16 v[128:143], a[76:79], v[84:87], v[128:143]
    v_exp_f32 v216, v216
    v_exp_f32 v217, v217
    v_exp_f32 v218, v218
    v_exp_f32 v219, v219
    v_cvt_pk_bf16_f32 v84, v216, v217
    v_cvt_pk_bf16_f32 v85, v218, v219
    v_mfma_f32_32x32x16_bf16 v[144:159], a[72:75], v[80:83], v[144:159]
    v_exp_f32 v220, v220
    v_exp_f32 v221, v221
    v_exp_f32 v222, v222
    v_exp_f32 v223, v223
    v_cvt_pk_bf16_f32 v86, v220, v221
    v_cvt_pk_bf16_f32 v87, v222, v223
    v_mfma_f32_32x32x16_bf16 v[192:207], a[80:83], v[24:27], 0
    v_exp_f32 v176, v176
    v_exp_f32 v177, v177
    v_exp_f32 v178, v178
    v_exp_f32 v179, v179
    v_cvt_pk_bf16_f32 v80, v176, v177
    v_cvt_pk_bf16_f32 v81, v178, v179
    v_mfma_f32_32x32x16_bf16 v[192:207], a[84:87], v[28:31], v[192:207]
    v_exp_f32 v180, v180
    v_exp_f32 v181, v181
    v_exp_f32 v182, v182
    v_exp_f32 v183, v183
    v_cvt_pk_bf16_f32 v82, v180, v181
    v_cvt_pk_bf16_f32 v83, v182, v183
    v_mfma_f32_32x32x16_bf16 v[144:159], a[76:79], v[84:87], v[144:159]
    v_exp_f32 v184, v184
    v_exp_f32 v185, v185
    v_exp_f32 v186, v186
    v_exp_f32 v187, v187
    v_cvt_pk_bf16_f32 v84, v184, v185
    v_cvt_pk_bf16_f32 v85, v186, v187
    v_mfma_f32_32x32x16_bf16 v[96:111], a[88:91], v[80:83], v[96:111]
    v_exp_f32 v188, v188
    v_exp_f32 v189, v189
    v_exp_f32 v190, v190
    v_exp_f32 v191, v191
    v_cvt_pk_bf16_f32 v86, v188, v189
    v_cvt_pk_bf16_f32 v87, v190, v191
    v_mfma_f32_32x32x16_bf16 v[208:223], a[80:83], v[32:35], 0
    v_exp_f32 v192, v192
    v_exp_f32 v193, v193
    v_exp_f32 v194, v194
    v_exp_f32 v195, v195
    v_cvt_pk_bf16_f32 v80, v192, v193
    v_cvt_pk_bf16_f32 v81, v194, v195
    v_mfma_f32_32x32x16_bf16 v[208:223], a[84:87], v[36:39], v[208:223]
    v_exp_f32 v196, v196
    v_exp_f32 v197, v197
    v_exp_f32 v198, v198
    v_exp_f32 v199, v199
    v_cvt_pk_bf16_f32 v82, v196, v197
    v_cvt_pk_bf16_f32 v83, v198, v199
    v_mfma_f32_32x32x16_bf16 v[96:111], a[92:95], v[84:87], v[96:111]
    s_add_u32 s75, s75, 4096
    v_exp_f32 v200, v200
    v_exp_f32 v201, v201
    v_exp_f32 v202, v202
    v_exp_f32 v203, v203
    v_cvt_pk_bf16_f32 v84, v200, v201
    v_cvt_pk_bf16_f32 v85, v202, v203
    v_mfma_f32_32x32x16_bf16 v[112:127], a[88:91], v[80:83], v[112:127]
    buffer_load_dwordx4 v[64:67], v2, s[24:27], s75 offen offset:0
    buffer_load_dwordx4 v[64:67], v2, s[24:27], s75 offen offset:1024
    buffer_load_dwordx4 v[64:67], v2, s[24:27], s75 offen offset:2048
    buffer_load_dwordx4 v[64:67], v2, s[24:27], s75 offen offset:3072
    v_exp_f32 v204, v204
    v_exp_f32 v205, v205
    v_exp_f32 v206, v206
    v_exp_f32 v207, v207
    v_cvt_pk_bf16_f32 v86, v204, v205
    v_cvt_pk_bf16_f32 v87, v206, v207
    v_mfma_f32_32x32x16_bf16 v[176:191], a[80:83], v[40:43], 0
    v_exp_f32 v208, v208
    v_exp_f32 v209, v209
    v_exp_f32 v210, v210
    v_exp_f32 v211, v211
    v_cvt_pk_bf16_f32 v80, v208, v209
    v_cvt_pk_bf16_f32 v81, v210, v211
    v_mfma_f32_32x32x16_bf16 v[176:191], a[84:87], v[44:47], v[176:191]
    v_exp_f32 v212, v212
    v_exp_f32 v213, v213
    v_exp_f32 v214, v214
    v_exp_f32 v215, v215
    v_cvt_pk_bf16_f32 v82, v212, v213
    v_cvt_pk_bf16_f32 v83, v214, v215
    v_mfma_f32_32x32x16_bf16 v[112:127], a[92:95], v[84:87], v[112:127]
    v_exp_f32 v216, v216
    v_exp_f32 v217, v217
    v_exp_f32 v218, v218
    v_exp_f32 v219, v219
    v_cvt_pk_bf16_f32 v84, v216, v217
    v_cvt_pk_bf16_f32 v85, v218, v219
    v_mfma_f32_32x32x16_bf16 v[128:143], a[88:91], v[80:83], v[128:143]
    s_waitcnt vmcnt(30)
    v_exp_f32 v220, v220
    v_exp_f32 v221, v221
    v_exp_f32 v222, v222
    v_exp_f32_e64 v223, v223
    v_cvt_pk_bf16_f32 v86, v220, v221
    v_cvt_pk_bf16_f32 v87, v222, v223
    v_mfma_f32_32x32x16_bf16 v[192:207], a[96:99], v[16:19], 0
    v_exp_f32 v176, v176
    v_exp_f32 v177, v177
    v_exp_f32 v178, v178
    v_exp_f32 v179, v179
    v_cvt_pk_bf16_f32 v80, v176, v177
    v_cvt_pk_bf16_f32 v81, v178, v179
    v_mfma_f32_32x32x16_bf16 v[192:207], a[100:103], v[20:23], v[192:207]
    v_exp_f32 v180, v180
    v_exp_f32 v181, v181
    v_exp_f32 v182, v182
    v_exp_f32 v183, v183
    v_cvt_pk_bf16_f32 v82, v180, v181
    v_cvt_pk_bf16_f32 v83, v182, v183
    v_mfma_f32_32x32x16_bf16 v[128:143], a[92:95], v[84:87], v[128:143]
    v_exp_f32 v184, v184
    v_exp_f32 v185, v185
    v_exp_f32 v186, v186
    v_exp_f32 v187, v187
    v_cvt_pk_bf16_f32 v84, v184, v185
    v_cvt_pk_bf16_f32 v85, v186, v187
    v_mfma_f32_32x32x16_bf16 v[144:159], a[88:91], v[80:83], v[144:159]
    v_exp_f32 v188, v188
    v_exp_f32 v189, v189
    v_exp_f32 v190, v190
    v_exp_f32 v191, v191
    v_cvt_pk_bf16_f32 v86, v188, v189
    v_cvt_pk_bf16_f32 v87, v190, v191
    v_mfma_f32_32x32x16_bf16 v[208:223], a[96:99], v[24:27], 0
    v_exp_f32 v192, v192
    v_exp_f32 v193, v193
    v_exp_f32 v194, v194
    v_exp_f32 v195, v195
    v_cvt_pk_bf16_f32 v80, v192, v193
    v_cvt_pk_bf16_f32 v81, v194, v195
    v_mfma_f32_32x32x16_bf16 v[208:223], a[100:103], v[28:31], v[208:223]
    v_exp_f32 v196, v196
    v_exp_f32 v197, v197
    v_exp_f32 v198, v198
    v_exp_f32 v199, v199
    v_cvt_pk_bf16_f32 v82, v196, v197
    v_cvt_pk_bf16_f32 v83, v198, v199
    v_mfma_f32_32x32x16_bf16 v[144:159], a[92:95], v[84:87], v[144:159]
    v_exp_f32 v200, v200
    v_exp_f32 v201, v201
    v_exp_f32 v202, v202
    v_exp_f32 v203, v203
    v_cvt_pk_bf16_f32 v84, v200, v201
    v_cvt_pk_bf16_f32 v85, v202, v203
    v_mfma_f32_32x32x16_bf16 v[96:111], a[104:107], v[80:83], v[96:111]
    v_exp_f32 v204, v204
    v_exp_f32 v205, v205
    v_exp_f32 v206, v206
    v_exp_f32 v207, v207
    v_cvt_pk_bf16_f32 v86, v204, v205
    v_cvt_pk_bf16_f32 v87, v206, v207
    v_mfma_f32_32x32x16_bf16 v[176:191], a[96:99], v[32:35], 0
    s_add_u32 s75, s75, 4096
    v_exp_f32 v208, v208
    v_exp_f32 v209, v209
    v_exp_f32 v210, v210
    v_exp_f32 v211, v211
    v_cvt_pk_bf16_f32 v80, v208, v209
    v_cvt_pk_bf16_f32 v81, v210, v211
    v_mfma_f32_32x32x16_bf16 v[176:191], a[100:103], v[36:39], v[176:191]
    buffer_load_dwordx4 v[64:67], v2, s[24:27], s75 offen offset:0
    buffer_load_dwordx4 v[64:67], v2, s[24:27], s75 offen offset:1024
    buffer_load_dwordx4 v[64:67], v2, s[24:27], s75 offen offset:2048
    buffer_load_dwordx4 v[64:67], v2, s[24:27], s75 offen offset:3072
    v_exp_f32 v212, v212
    v_exp_f32 v213, v213
    v_exp_f32 v214, v214
    v_exp_f32 v215, v215
    v_cvt_pk_bf16_f32 v82, v212, v213
    v_cvt_pk_bf16_f32 v83, v214, v215
    v_mfma_f32_32x32x16_bf16 v[96:111], a[108:111], v[84:87], v[96:111]
    v_exp_f32 v216, v216
    v_exp_f32 v217, v217
    v_exp_f32 v218, v218
    v_exp_f32 v219, v219
    v_cvt_pk_bf16_f32 v84, v216, v217
    v_cvt_pk_bf16_f32 v85, v218, v219
    v_mfma_f32_32x32x16_bf16 v[112:127], a[104:107], v[80:83], v[112:127]
    v_exp_f32 v220, v220
    v_exp_f32 v221, v221
    v_exp_f32 v222, v222
    v_exp_f32 v223, v223
    v_cvt_pk_bf16_f32 v86, v220, v221
    v_cvt_pk_bf16_f32 v87, v222, v223
    v_mfma_f32_32x32x16_bf16 v[192:207], a[96:99], v[40:43], 0
    v_exp_f32 v176, v176
    v_exp_f32 v177, v177
    v_exp_f32 v178, v178
    v_exp_f32 v179, v179
    v_cvt_pk_bf16_f32 v80, v176, v177
    v_cvt_pk_bf16_f32 v81, v178, v179
    v_mfma_f32_32x32x16_bf16 v[192:207], a[100:103], v[44:47], v[192:207]
    v_exp_f32 v180, v180
    v_exp_f32 v181, v181
    v_exp_f32 v182, v182
    v_exp_f32 v183, v183
    v_cvt_pk_bf16_f32 v82, v180, v181
    v_cvt_pk_bf16_f32 v83, v182, v183
    v_mfma_f32_32x32x16_bf16 v[112:127], a[108:111], v[84:87], v[112:127]
    v_exp_f32 v184, v184
    v_exp_f32 v185, v185
    v_exp_f32 v186, v186
    v_exp_f32 v187, v187
    v_cvt_pk_bf16_f32 v84, v184, v185
    v_cvt_pk_bf16_f32 v85, v186, v187
    v_mfma_f32_32x32x16_bf16 v[128:143], a[104:107], v[80:83], v[128:143]
    s_waitcnt vmcnt(26)
    v_exp_f32 v188, v188
    v_exp_f32 v189, v189
    v_exp_f32 v190, v190
    v_exp_f32_e64 v191, v191
    v_cvt_pk_bf16_f32 v86, v188, v189
    v_cvt_pk_bf16_f32 v87, v190, v191
    v_mfma_f32_32x32x16_bf16 v[208:223], a[0:3], v[16:19], 0
    v_exp_f32 v192, v192
    v_exp_f32 v193, v193
    v_exp_f32 v194, v194
    v_exp_f32 v195, v195
    v_cvt_pk_bf16_f32 v80, v192, v193
    v_cvt_pk_bf16_f32 v81, v194, v195
    v_mfma_f32_32x32x16_bf16 v[208:223], a[4:7], v[20:23], v[208:223]
    v_exp_f32 v196, v196
    v_exp_f32 v197, v197
    v_exp_f32 v198, v198
    v_exp_f32 v199, v199
    v_cvt_pk_bf16_f32 v82, v196, v197
    v_cvt_pk_bf16_f32 v83, v198, v199
    v_mfma_f32_32x32x16_bf16 v[128:143], a[108:111], v[84:87], v[128:143]
    v_exp_f32 v200, v200
    v_exp_f32 v201, v201
    v_exp_f32 v202, v202
    v_exp_f32 v203, v203
    v_cvt_pk_bf16_f32 v84, v200, v201
    v_cvt_pk_bf16_f32 v85, v202, v203
    v_mfma_f32_32x32x16_bf16 v[144:159], a[104:107], v[80:83], v[144:159]
    v_exp_f32 v204, v204
    v_exp_f32 v205, v205
    v_exp_f32 v206, v206
    v_exp_f32 v207, v207
    v_cvt_pk_bf16_f32 v86, v204, v205
    v_cvt_pk_bf16_f32 v87, v206, v207
    v_mfma_f32_32x32x16_bf16 v[176:191], a[0:3], v[24:27], 0
    v_exp_f32 v208, v208
    v_exp_f32 v209, v209
    v_exp_f32 v210, v210
    v_exp_f32 v211, v211
    v_cvt_pk_bf16_f32 v80, v208, v209
    v_cvt_pk_bf16_f32 v81, v210, v211
    v_mfma_f32_32x32x16_bf16 v[176:191], a[4:7], v[28:31], v[176:191]
    v_exp_f32 v212, v212
    v_exp_f32 v213, v213
    v_exp_f32 v214, v214
    v_exp_f32 v215, v215
    v_cvt_pk_bf16_f32 v82, v212, v213
    v_cvt_pk_bf16_f32 v83, v214, v215
    v_mfma_f32_32x32x16_bf16 v[144:159], a[108:111], v[84:87], v[144:159]
    s_add_u32 s75, s75, 4096
    v_exp_f32 v216, v216
    v_exp_f32 v217, v217
    v_exp_f32 v218, v218
    v_exp_f32 v219, v219
    v_cvt_pk_bf16_f32 v84, v216, v217
    v_cvt_pk_bf16_f32 v85, v218, v219
    v_mfma_f32_32x32x16_bf16 v[96:111], a[8:11], v[80:83], v[96:111]
    buffer_load_dwordx4 v[64:67], v2, s[24:27], s75 offen offset:0
    v_exp_f32 v220, v220
    v_exp_f32 v221, v221
    v_exp_f32 v222, v222
    v_exp_f32 v223, v223
    v_cvt_pk_bf16_f32 v86, v220, v221
    v_cvt_pk_bf16_f32 v87, v222, v223
    v_mfma_f32_32x32x16_bf16 v[192:207], a[0:3], v[32:35], 0
    v_exp_f32 v176, v176
    v_exp_f32 v177, v177
    v_exp_f32 v178, v178
    v_exp_f32 v179, v179
    v_cvt_pk_bf16_f32 v80, v176, v177
    v_cvt_pk_bf16_f32 v81, v178, v179
    v_mfma_f32_32x32x16_bf16 v[192:207], a[4:7], v[36:39], v[192:207]
    v_exp_f32 v180, v180
    v_exp_f32 v181, v181
    v_exp_f32 v182, v182
    v_exp_f32 v183, v183
    v_cvt_pk_bf16_f32 v82, v180, v181
    v_cvt_pk_bf16_f32 v83, v182, v183
    v_mfma_f32_32x32x16_bf16 v[96:111], a[12:15], v[84:87], v[96:111]
    v_exp_f32 v184, v184
    v_exp_f32 v185, v185
    v_exp_f32 v186, v186
    v_exp_f32 v187, v187
    v_cvt_pk_bf16_f32 v84, v184, v185
    v_cvt_pk_bf16_f32 v85, v186, v187
    v_mfma_f32_32x32x16_bf16 v[112:127], a[8:11], v[80:83], v[112:127]
    v_exp_f32 v188, v188
    v_exp_f32 v189, v189
    v_exp_f32 v190, v190
    v_exp_f32 v191, v191
    v_cvt_pk_bf16_f32 v86, v188, v189
    v_cvt_pk_bf16_f32 v87, v190, v191
    v_mfma_f32_32x32x16_bf16 v[208:223], a[0:3], v[40:43], 0
    v_exp_f32 v192, v192
    v_exp_f32 v193, v193
    v_exp_f32 v194, v194
    v_exp_f32 v195, v195
    v_cvt_pk_bf16_f32 v80, v192, v193
    v_cvt_pk_bf16_f32 v81, v194, v195
    v_mfma_f32_32x32x16_bf16 v[208:223], a[4:7], v[44:47], v[208:223]
    v_exp_f32 v196, v196
    v_exp_f32 v197, v197
    v_exp_f32 v198, v198
    v_exp_f32 v199, v199
    v_cvt_pk_bf16_f32 v82, v196, v197
    v_cvt_pk_bf16_f32 v83, v198, v199
    v_mfma_f32_32x32x16_bf16 v[112:127], a[12:15], v[84:87], v[112:127]
    v_exp_f32 v200, v200
    v_exp_f32 v201, v201
    v_exp_f32 v202, v202
    v_exp_f32 v203, v203
    v_cvt_pk_bf16_f32 v84, v200, v201
    v_cvt_pk_bf16_f32 v85, v202, v203
    v_mfma_f32_32x32x16_bf16 v[128:143], a[8:11], v[80:83], v[128:143]
    s_waitcnt vmcnt(19)
    v_exp_f32 v204, v204
    v_exp_f32 v205, v205
    v_exp_f32 v206, v206
    v_exp_f32_e64 v207, v207
    v_cvt_pk_bf16_f32 v86, v204, v205
    v_cvt_pk_bf16_f32 v87, v206, v207
    v_mfma_f32_32x32x16_bf16 v[176:191], a[16:19], v[24:27], 0
    v_exp_f32 v208, v208
    v_exp_f32 v209, v209
    v_exp_f32 v210, v210
    v_exp_f32 v211, v211
    v_cvt_pk_bf16_f32 v80, v208, v209
    v_cvt_pk_bf16_f32 v81, v210, v211
    v_mfma_f32_32x32x16_bf16 v[176:191], a[20:23], v[28:31], v[176:191]
    v_exp_f32 v212, v212
    v_exp_f32 v213, v213
    v_exp_f32 v214, v214
    v_exp_f32 v215, v215
    v_cvt_pk_bf16_f32 v82, v212, v213
    v_cvt_pk_bf16_f32 v83, v214, v215
    v_mfma_f32_32x32x16_bf16 v[128:143], a[12:15], v[84:87], v[128:143]
    v_exp_f32 v216, v216
    v_exp_f32 v217, v217
    v_exp_f32 v218, v218
    v_exp_f32 v219, v219
    v_cvt_pk_bf16_f32 v84, v216, v217
    v_cvt_pk_bf16_f32 v85, v218, v219
    v_mfma_f32_32x32x16_bf16 v[144:159], a[8:11], v[80:83], v[144:159]
    v_exp_f32 v220, v220
    v_exp_f32 v221, v221
    v_exp_f32 v222, v222
    v_exp_f32 v223, v223
    v_cvt_pk_bf16_f32 v86, v220, v221
    v_cvt_pk_bf16_f32 v87, v222, v223
    v_mfma_f32_32x32x16_bf16 v[192:207], a[16:19], v[32:35], 0
    v_exp_f32 v176, v176
    v_exp_f32 v177, v177
    v_exp_f32 v178, v178
    v_exp_f32 v179, v179
    v_cvt_pk_bf16_f32 v80, v176, v177
    v_cvt_pk_bf16_f32 v81, v178, v179
    v_mfma_f32_32x32x16_bf16 v[192:207], a[20:23], v[36:39], v[192:207]
    v_exp_f32 v180, v180
    v_exp_f32 v181, v181
    v_exp_f32 v182, v182
    v_exp_f32 v183, v183
    v_cvt_pk_bf16_f32 v82, v180, v181
    v_cvt_pk_bf16_f32 v83, v182, v183
    v_mfma_f32_32x32x16_bf16 v[144:159], a[12:15], v[84:87], v[144:159]
    v_exp_f32 v184, v184
    v_exp_f32 v185, v185
    v_exp_f32 v186, v186
    v_exp_f32 v187, v187
    v_cvt_pk_bf16_f32 v84, v184, v185
    v_cvt_pk_bf16_f32 v85, v186, v187
    v_mfma_f32_32x32x16_bf16 v[112:127], a[24:27], v[80:83], v[112:127]
    v_exp_f32 v188, v188
    v_exp_f32 v189, v189
    v_exp_f32 v190, v190
    v_exp_f32 v191, v191
    v_cvt_pk_bf16_f32 v86, v188, v189
    v_cvt_pk_bf16_f32 v87, v190, v191
    v_mfma_f32_32x32x16_bf16 v[208:223], a[16:19], v[40:43], 0
    v_exp_f32 v192, v192
    v_exp_f32 v193, v193
    v_exp_f32 v194, v194
    v_exp_f32 v195, v195
    v_cvt_pk_bf16_f32 v80, v192, v193
    v_cvt_pk_bf16_f32 v81, v194, v195
    v_mfma_f32_32x32x16_bf16 v[208:223], a[20:23], v[44:47], v[208:223]
    v_exp_f32 v196, v196
    v_exp_f32 v197, v197
    v_exp_f32 v198, v198
    v_exp_f32 v199, v199
    v_cvt_pk_bf16_f32 v82, v196, v197
    v_cvt_pk_bf16_f32 v83, v198, v199
    v_mfma_f32_32x32x16_bf16 v[112:127], a[28:31], v[84:87], v[112:127]
    s_add_u32 s74, s44, 1
    s_and_b32 s74, s74, 3
    s_mul_i32 s74, s74, 12288
    s_add_u32 s74, s74, 114688
    v_add_u32 v10, s74, v2
    v_exp_f32 v200, v200
    v_exp_f32 v201, v201
    v_exp_f32 v202, v202
    v_exp_f32_e64 v203, v203
    v_cvt_pk_bf16_f32 v84, v200, v201
    v_cvt_pk_bf16_f32 v85, v202, v203
    v_mfma_f32_32x32x16_bf16 v[128:143], a[24:27], v[80:83], v[128:143]
    v_exp_f32 v204, v204
    v_exp_f32 v205, v205
    v_exp_f32 v206, v206
    v_exp_f32 v207, v207
    v_cvt_pk_bf16_f32 v86, v204, v205
    v_cvt_pk_bf16_f32 v87, v206, v207
    v_mfma_f32_32x32x16_bf16 v[176:191], a[16:19], v[16:19], 0
    ds_write_b128 v10, v[112:115] offset:0
    ds_write_b128 v10, v[116:119] offset:1024
    v_exp_f32 v208, v208
    v_exp_f32 v209, v209
    v_exp_f32 v210, v210
    v_exp_f32 v211, v211
    v_cvt_pk_bf16_f32 v80, v208, v209
    v_cvt_pk_bf16_f32 v81, v210, v211
    v_mfma_f32_32x32x16_bf16 v[176:191], a[20:23], v[20:23], v[176:191]
    ds_write_b128 v10, v[120:123] offset:2048
    ds_write_b128 v10, v[124:127] offset:3072
    v_exp_f32 v212, v212
    v_exp_f32 v213, v213
    v_exp_f32 v214, v214
    v_exp_f32 v215, v215
    v_cvt_pk_bf16_f32 v82, v212, v213
    v_cvt_pk_bf16_f32 v83, v214, v215
    v_mfma_f32_32x32x16_bf16 v[128:143], a[28:31], v[84:87], v[128:143]
    s_add_u32 s74, s44, 2
    s_and_b32 s74, s74, 3
    s_mul_i32 s74, s74, 12288
    s_add_u32 s74, s74, 118784
    v_add_u32 v11, s74, v2
    v_exp_f32 v216, v216
    v_exp_f32 v217, v217
    v_exp_f32 v218, v218
    v_exp_f32_e64 v219, v219
    v_cvt_pk_bf16_f32 v84, v216, v217
    v_cvt_pk_bf16_f32 v85, v218, v219
    v_mfma_f32_32x32x16_bf16 v[144:159], a[24:27], v[80:83], v[144:159]
    v_exp_f32 v220, v220
    v_exp_f32 v221, v221
    v_exp_f32 v222, v222
    v_exp_f32 v223, v223
    v_cvt_pk_bf16_f32 v86, v220, v221
    v_cvt_pk_bf16_f32 v87, v222, v223
    ds_write_b128 v11, v[128:131] offset:0
    ds_write_b128 v11, v[132:135] offset:1024
    v_exp_f32 v176, v176
    v_exp_f32 v177, v177
    v_exp_f32 v178, v178
    v_exp_f32 v179, v179
    v_cvt_pk_bf16_f32 v80, v176, v177
    v_cvt_pk_bf16_f32 v81, v178, v179
    ds_write_b128 v11, v[136:139] offset:2048
    ds_write_b128 v11, v[140:143] offset:3072
    v_exp_f32 v180, v180
    v_exp_f32 v181, v181
    v_exp_f32 v182, v182
    v_exp_f32 v183, v183
    v_cvt_pk_bf16_f32 v82, v180, v181
    v_cvt_pk_bf16_f32 v83, v182, v183
    v_mfma_f32_32x32x16_bf16 v[144:159], a[28:31], v[84:87], v[144:159]
    s_add_u32 s74, s44, 3
    s_and_b32 s74, s74, 3
    s_mul_i32 s74, s74, 12288
    s_add_u32 s74, s74, 122880
    v_add_u32 v12, s74, v2
    v_exp_f32 v184, v184
    v_exp_f32 v185, v185
    v_exp_f32 v186, v186
    v_exp_f32_e64 v187, v187
    v_cvt_pk_bf16_f32 v84, v184, v185
    v_cvt_pk_bf16_f32 v85, v186, v187
    v_mfma_f32_32x32x16_bf16 v[96:111], a[24:27], v[80:83], v[96:111]
    v_exp_f32 v188, v188
    v_exp_f32 v189, v189
    v_exp_f32 v190, v190
    v_exp_f32 v191, v191
    ds_write_b128 v12, v[144:147] offset:0
    ds_write_b128 v12, v[148:151] offset:1024
    v_cvt_pk_bf16_f32 v86, v188, v189
    v_cvt_pk_bf16_f32 v87, v190, v191
    ds_write_b128 v12, v[152:155] offset:2048
    ds_write_b128 v12, v[156:159] offset:3072
    v_mfma_f32_32x32x16_bf16 v[96:111], a[28:31], v[84:87], v[96:111]
    s_mul_i32 s74, s44, 12288
    s_add_u32 s74, s74, 114688
    v_add_u32 v13, s74, v2
    s_waitcnt vmcnt(17)
    s_waitcnt lgkmcnt(0)
    s_barrier
    ds_read_b128 v[160:163], v13 offset:0
    ds_read_b128 v[164:167], v13 offset:1024
    ds_read_b128 v[168:171], v13 offset:2048
    ds_read_b128 v[172:175], v13 offset:3072
    ds_read_b128 v[176:179], v13 offset:4096
    ds_read_b128 v[180:183], v13 offset:5120
    ds_read_b128 v[184:187], v13 offset:6144
    ds_read_b128 v[188:191], v13 offset:7168
    ds_read_b128 v[192:195], v13 offset:8192
    ds_read_b128 v[196:199], v13 offset:9216
    ds_read_b128 v[200:203], v13 offset:10240
    ds_read_b128 v[204:207], v13 offset:11264
    s_lshl_b32 s74, s50, 2
    s_add_u32 s74, s74, s44
    s_lshl_b32 s74, s74, 2
    s_lshr_b32 s75, s51, 2
    s_add_u32 s74, s74, s75
    s_lshl_b32 s74, s74, 14
    s_and_b32 s75, s51, 3
    s_lshl_b32 s75, s75, 11
    s_add_u32 s74, s74, s75
    s_add_u32 s74, s74, s48
    s_add_u32 s74, s74, 12582912
    s_lshr_b32 s75, s50, 1
    s_lshr_b32 s75, s67, s75
    s_and_b32 s75, s75, 1
    s_lshl_b32 s75, s75, 13
    s_lshr_b32 s72, s74, 8
    s_xor_b32 s72, s72, s75
    s_and_b32 s72, s72, 0x2000
    s_or_b32 s74, s74, s72
    s_waitcnt lgkmcnt(11)
    v_pk_add_f32 v[96:97], v[96:97], v[160:161]
    v_pk_add_f32 v[98:99], v[98:99], v[162:163]
    s_waitcnt lgkmcnt(10)
    v_pk_add_f32 v[100:101], v[100:101], v[164:165]
    v_pk_add_f32 v[102:103], v[102:103], v[166:167]
    s_waitcnt lgkmcnt(9)
    v_pk_add_f32 v[104:105], v[104:105], v[168:169]
    v_pk_add_f32 v[106:107], v[106:107], v[170:171]
    s_waitcnt lgkmcnt(8)
    v_pk_add_f32 v[108:109], v[108:109], v[172:173]
    v_pk_add_f32 v[110:111], v[110:111], v[174:175]
    s_waitcnt lgkmcnt(7)
    v_pk_add_f32 v[96:97], v[96:97], v[176:177]
    v_pk_add_f32 v[98:99], v[98:99], v[178:179]
    s_waitcnt lgkmcnt(6)
    v_pk_add_f32 v[100:101], v[100:101], v[180:181]
    v_pk_add_f32 v[102:103], v[102:103], v[182:183]
    s_waitcnt lgkmcnt(5)
    v_pk_add_f32 v[104:105], v[104:105], v[184:185]
    v_pk_add_f32 v[106:107], v[106:107], v[186:187]
    s_waitcnt lgkmcnt(4)
    v_pk_add_f32 v[108:109], v[108:109], v[188:189]
    v_pk_add_f32 v[110:111], v[110:111], v[190:191]
    s_waitcnt lgkmcnt(3)
    v_pk_add_f32 v[96:97], v[96:97], v[192:193]
    v_pk_add_f32 v[98:99], v[98:99], v[194:195]
    s_waitcnt lgkmcnt(2)
    v_pk_add_f32 v[100:101], v[100:101], v[196:197]
    v_pk_add_f32 v[102:103], v[102:103], v[198:199]
    s_waitcnt lgkmcnt(1)
    v_pk_add_f32 v[104:105], v[104:105], v[200:201]
    v_pk_add_f32 v[106:107], v[106:107], v[202:203]
    s_waitcnt lgkmcnt(0)
    v_pk_add_f32 v[108:109], v[108:109], v[204:205]
    v_pk_add_f32 v[110:111], v[110:111], v[206:207]
    v_mov_b32 v10, v108
    v_mov_b32 v12, v108
    s_nop 1
    v_permlane32_swap_b32 v10, v12
    v_rcp_f32_e64 v12, v12
    s_nop 0
    v_pk_mul_f32 v[96:97], v[96:97], v[12:13] op_sel_hi:[1,0]
    v_pk_mul_f32 v[98:99], v[98:99], v[12:13] op_sel_hi:[1,0]
    v_pk_mul_f32 v[100:101], v[100:101], v[12:13] op_sel_hi:[1,0]
    v_pk_mul_f32 v[102:103], v[102:103], v[12:13] op_sel_hi:[1,0]
    v_pk_mul_f32 v[104:105], v[104:105], v[12:13] op_sel_hi:[1,0]
    v_pk_mul_f32 v[106:107], v[106:107], v[12:13] op_sel_hi:[1,0]
    v_pk_mul_f32 v[108:109], v[108:109], v[12:13] op_sel_hi:[1,0]
    v_pk_mul_f32 v[110:111], v[110:111], v[12:13] op_sel_hi:[1,0]
    v_cvt_pk_bf16_f32 v16, v96, v97
    v_cvt_pk_bf16_f32 v17, v98, v99
    v_cvt_pk_bf16_f32 v18, v100, v101
    v_cvt_pk_bf16_f32 v19, v102, v103
    buffer_store_dwordx4 v[16:19], v2, s[40:43], s74 offen offset:0 sc1
    v_cvt_pk_bf16_f32 v20, v104, v105
    v_cvt_pk_bf16_f32 v21, v106, v107
    v_cvt_pk_bf16_f32 v22, v108, v109
    v_cndmask_b32 v22, v22, 0, s[82:83]
    v_cvt_pk_bf16_f32 v23, v110, v111
    v_cndmask_b32 v23, v23, 0, s[82:83]
    buffer_store_dwordx4 v[20:23], v2, s[40:43], s74 offen offset:1024 sc1
    s_add_u32 s57, s47, 1
    s_mul_i32 s72, s57, 16
    s_mov_b32 s81, 0
    s_mov_b32 s57, s72
    s_mov_b32 s80, 1
    s_add_u32 s52, s71, 4
    s_lshl_b32 s74, s58, 8
    s_add_u32 s74, s74, 0
    v_add_u32_e64 v13, s74, v4
    ds_read_b64_tr_b16 a[0:1], v13 offset:0
    ds_read_b64_tr_b16 a[2:3], v13 offset:1024
    ds_read_b64_tr_b16 a[4:5], v13 offset:2048
    ds_read_b64_tr_b16 a[6:7], v13 offset:3072
    ds_read_b64_tr_b16 a[8:9], v13 offset:3584
    ds_read_b64_tr_b16 a[10:11], v13 offset:4608
    ds_read_b64_tr_b16 a[12:13], v13 offset:5632
    ds_read_b64_tr_b16 a[14:15], v13 offset:6656
    ds_read_b64_tr_b16 a[16:17], v13 offset:7168
    ds_read_b64_tr_b16 a[18:19], v13 offset:8192
    ds_read_b64_tr_b16 a[20:21], v13 offset:9216
    ds_read_b64_tr_b16 a[22:23], v13 offset:10240
    ds_read_b64_tr_b16 a[24:25], v13 offset:10752
    ds_read_b64_tr_b16 a[26:27], v13 offset:11776
    ds_read_b64_tr_b16 a[28:29], v13 offset:12800
    ds_read_b64_tr_b16 a[30:31], v13 offset:13824
    ds_read_b64_tr_b16 a[32:33], v13 offset:14336
    ds_read_b64_tr_b16 a[34:35], v13 offset:15360
    ds_read_b64_tr_b16 a[36:37], v13 offset:16384
    ds_read_b64_tr_b16 a[38:39], v13 offset:17408
    ds_read_b64_tr_b16 a[40:41], v13 offset:17920
    ds_read_b64_tr_b16 a[42:43], v13 offset:18944
    ds_read_b64_tr_b16 a[44:45], v13 offset:19968
    ds_read_b64_tr_b16 a[46:47], v13 offset:20992
    ds_read_b64_tr_b16 a[48:49], v13 offset:21504
    ds_read_b64_tr_b16 a[50:51], v13 offset:22528
    ds_read_b64_tr_b16 a[52:53], v13 offset:23552
    ds_read_b64_tr_b16 a[54:55], v13 offset:24576
    ds_read_b64_tr_b16 a[56:57], v13 offset:25088
    ds_read_b64_tr_b16 a[58:59], v13 offset:26112
    ds_read_b64_tr_b16 a[60:61], v13 offset:27136
    ds_read_b64_tr_b16 a[62:63], v13 offset:28160
    ds_read_b64_tr_b16 a[64:65], v13 offset:28672
    ds_read_b64_tr_b16 a[66:67], v13 offset:29696
    ds_read_b64_tr_b16 a[68:69], v13 offset:30720
    ds_read_b64_tr_b16 a[70:71], v13 offset:31744
    ds_read_b64_tr_b16 a[72:73], v13 offset:32256
    ds_read_b64_tr_b16 a[74:75], v13 offset:33280
    ds_read_b64_tr_b16 a[76:77], v13 offset:34304
    ds_read_b64_tr_b16 a[78:79], v13 offset:35328
    ds_read_b64_tr_b16 a[80:81], v13 offset:35840
    ds_read_b64_tr_b16 a[82:83], v13 offset:36864
    ds_read_b64_tr_b16 a[84:85], v13 offset:37888
    s_waitcnt vmcnt(0)
    s_waitcnt lgkmcnt(0)
    s_barrier
    s_cmp_lg_u32 s44, 0
    s_cbranch_scc1 L_sig_16
    s_mov_b64 exec, 0x3fff
    buffer_atomic_add a238, v0, s[40:43], s65 offen offset:0 sc1
L_sig_16_e:
    s_mov_b64 exec, s[80:81]
    v_accvgpr_write_b32 a232, 0
    buffer_atomic_or a232, v3, s[40:43], s52 offen sc0 sc1
    s_mov_b64 exec, -1
L_sig_16:
    ds_read_b64_tr_b16 a[86:87], v13 offset:38912
    ds_read_b64_tr_b16 a[88:89], v13 offset:39424
    ds_read_b64_tr_b16 a[90:91], v13 offset:40448
    ds_read_b64_tr_b16 a[92:93], v13 offset:41472
    ds_read_b64_tr_b16 a[94:95], v13 offset:42496
    ds_read_b64_tr_b16 a[96:97], v13 offset:43008
    ds_read_b64_tr_b16 a[98:99], v13 offset:44032
    ds_read_b64_tr_b16 a[100:101], v13 offset:45056
    ds_read_b64_tr_b16 a[102:103], v13 offset:46080
    ds_read_b64_tr_b16 a[104:105], v13 offset:46592
    ds_read_b64_tr_b16 a[106:107], v13 offset:47616
    ds_read_b64_tr_b16 a[108:109], v13 offset:48640
    ds_read_b64_tr_b16 a[110:111], v13 offset:49664
    ds_read_b64_tr_b16 a[112:113], v13 offset:50176
    ds_read_b64_tr_b16 a[114:115], v13 offset:51200
    ds_read_b64_tr_b16 a[116:117], v13 offset:52224
    ds_read_b64_tr_b16 a[118:119], v13 offset:53248
    ds_read_b64_tr_b16 a[120:121], v13 offset:53760
    ds_read_b64_tr_b16 a[122:123], v13 offset:54784
    ds_read_b64_tr_b16 a[124:125], v13 offset:55808
    ds_read_b64_tr_b16 a[126:127], v13 offset:56832
    s_cmp_ge_u32 s46, 28
    s_cbranch_scc1 L_idle
    s_cmp_lg_u32 s47, 0
    s_cbranch_scc1 L_wocs_17_1
    v_lshlrev_b32 v10, 16, v240
    v_and_b32 v11, 0xffff0000, v240
    v_accvgpr_write_b32 a240, v10
    v_accvgpr_write_b32 a241, v11
    v_lshlrev_b32_e64 v10, 16, v241
    v_and_b32 v11, 0xffff0000, v241
    v_accvgpr_write_b32 a242, v10
    v_accvgpr_write_b32 a243, v11
    v_lshlrev_b32_e64 v10, 16, v242
    v_and_b32 v11, 0xffff0000, v242
    v_accvgpr_write_b32 a244, v10
    v_accvgpr_write_b32 a245, v11
    v_lshlrev_b32_e64 v10, 16, v243
    v_and_b32 v11, 0xffff0000, v243
    v_accvgpr_write_b32 a246, v10
    v_accvgpr_write_b32 a247, v11
    v_lshlrev_b32_e64 v10, 16, v244
    v_and_b32 v11, 0xffff0000, v244
    v_accvgpr_write_b32 a248, v10
    v_accvgpr_write_b32 a249, v11
    v_lshlrev_b32_e64 v10, 16, v245
    v_and_b32 v11, 0xffff0000, v245
    v_accvgpr_write_b32 a250, v10
    v_accvgpr_write_b32 a251, v11
    v_lshlrev_b32_e64 v10, 16, v246
    v_and_b32 v11, 0xffff0000, v246
    v_accvgpr_write_b32 a252, v10
    v_accvgpr_write_b32 a253, v11
    v_lshlrev_b32_e64 v10, 16, v247
    v_and_b32 v11, 0xffff0000, v247
    v_accvgpr_write_b32 a254, v10
    v_accvgpr_write_b32 a255, v11
    s_branch L_wocs_17_2
L_wocs_17_1:
    s_add_u32 s76, s61, 512
    s_mov_b32 m0, 161792
    s_mov_b64 exec, 0xffffffff
    buffer_load_dwordx4 v2, s[40:43], s76 offen sc1 lds
    s_mov_b64 exec, -1
L_wocs_17_2:
    s_cmp_lg_u32 s44, 0
    s_cbranch_scc1 L_kick_18
    s_mov_b64 exec, s[80:81]
    v_accvgpr_write_b32 a233, 0
    buffer_atomic_or a233, v3, s[40:43], s52 offen sc0 sc1
    s_mov_b64 exec, -1
L_kick_18:
    v_accvgpr_read_b32 v128, a240
    v_accvgpr_read_b32 v129, a241
    v_accvgpr_read_b32 v130, a242
    v_accvgpr_read_b32 v131, a243
    v_accvgpr_read_b32 v132, a244
    v_accvgpr_read_b32 v133, a245
    v_accvgpr_read_b32 v134, a246
    v_accvgpr_read_b32 v135, a247
    v_accvgpr_read_b32 v136, a248
    v_accvgpr_read_b32 v137, a249
    v_accvgpr_read_b32 v138, a250
    v_accvgpr_read_b32 v139, a251
    v_accvgpr_read_b32 v140, a252
    v_accvgpr_read_b32 v141, a253
    v_accvgpr_read_b32 v142, a254
    v_accvgpr_read_b32 v143, a255
    s_lshl_b32 s74, s60, 16
    s_add_u32 s74, s74, s48
    s_add_u32 s74, s74, 12582912
    s_lshr_b32 s72, s74, 8
    s_xor_b32 s72, s72, s69
    s_and_b32 s72, s72, 0x2000
    s_or_b32 s74, s74, s72
    s_mov_b32 s78, 0
    s_cmp_eq_u32 s59, 0
    s_cselect_b32 s78, 114688, s78
    v_add_u32 v12, s78, v2
    s_lshl_b32 s76, s58, 10
    s_add_u32 s78, s78, s76
    s_add_u32 s74, s74, s76
    s_cmp_lg_u32 s44, 0
    s_cbranch_scc1 L_poll_19_done
    s_mov_b64 exec, s[80:81]
    v_accvgpr_write_b32 a234, 0
    buffer_atomic_or a234, v3, s[40:43], s52 offen sc0 sc1
    s_mov_b32 s73, 0
L_poll_19_loop:
    s_waitcnt vmcnt(2)
    v_accvgpr_read_b32 v11, a232
    v_cmp_gt_u32 vcc, s57, v11
    s_cbranch_vccz L_poll_19_out
    v_accvgpr_write_b32 a232, 0
    buffer_atomic_or a232, v3, s[40:43], s52 offen sc0 sc1
    s_waitcnt vmcnt(2)
    v_accvgpr_read_b32 v11, a233
    v_cmp_gt_u32 vcc, s57, v11
    s_cbranch_vccz L_poll_19_out
    v_accvgpr_write_b32 a233, 0
    buffer_atomic_or a233, v3, s[40:43], s52 offen sc0 sc1
    s_waitcnt vmcnt(2)
    v_accvgpr_read_b32 v11, a234
    v_cmp_gt_u32 vcc, s57, v11
    s_cbranch_vccz L_poll_19_out
    v_accvgpr_write_b32 a234, 0
    buffer_atomic_or a234, v3, s[40:43], s52 offen sc0 sc1
    s_add_u32 s73, s73, 1
    s_cmp_lt_u32 s73, 0x20000
    s_cbranch_scc1 L_poll_19_loop
L_poll_19_out:
    s_mov_b64 exec, -1
    s_waitcnt vmcnt(2) lgkmcnt(0)
    s_branch L_poll_19_b
L_poll_19_done:
    s_waitcnt vmcnt(0) lgkmcnt(0)
L_poll_19_b:
    s_barrier
    s_mov_b32 m0, s78
    s_nop 0
    buffer_load_dwordx4 v2, s[40:43], s74 offen offset:0 sc1 lds
    buffer_load_dwordx4 v2, s[40:43], s74 offen offset:2048 sc1 lds
    s_add_u32 s74, s74, 4096
    s_add_u32 m0, m0, 4096
    s_nop 0
    buffer_load_dwordx4 v2, s[40:43], s74 offen offset:0 sc1 lds
    buffer_load_dwordx4 v2, s[40:43], s74 offen offset:2048 sc1 lds
    s_add_u32 s74, s74, 12288
    s_add_u32 m0, m0, 4096
    s_nop 0
    buffer_load_dwordx4 v2, s[40:43], s74 offen offset:0 sc1 lds
    buffer_load_dwordx4 v2, s[40:43], s74 offen offset:2048 sc1 lds
    s_add_u32 s74, s74, 4096
    s_add_u32 m0, m0, 4096
    s_nop 0
    buffer_load_dwordx4 v2, s[40:43], s74 offen offset:0 sc1 lds
    buffer_load_dwordx4 v2, s[40:43], s74 offen offset:2048 sc1 lds
    s_add_u32 s74, s74, 12288
    s_add_u32 m0, m0, 4096
    s_nop 0
    buffer_load_dwordx4 v2, s[40:43], s74 offen offset:0 sc1 lds
    buffer_load_dwordx4 v2, s[40:43], s74 offen offset:2048 sc1 lds
    s_add_u32 s74, s74, 4096
    s_add_u32 m0, m0, 4096
    s_nop 0
    buffer_load_dwordx4 v2, s[40:43], s74 offen offset:0 sc1 lds
    buffer_load_dwordx4 v2, s[40:43], s74 offen offset:2048 sc1 lds
    s_waitcnt vmcnt(6)
    s_barrier
    ds_read_b128 v[16:19], v12 offset:0
    ds_read_b128 v[20:23], v12 offset:1024
    ds_read_b128 v[24:27], v12 offset:2048
    ds_read_b128 v[28:31], v12 offset:3072
    s_waitcnt lgkmcnt(3)
    v_mfma_f32_32x32x16_bf16 v[128:143], a[0:3], v[16:19], v[128:143]
    s_add_u32 s74, s74, 12288
    s_add_u32 m0, m0, 4096
    s_nop 0
    buffer_load_dwordx4 v2, s[40:43], s74 offen offset:0 sc1 lds
    ds_read_b128 v[32:35], v12 offset:4096
    s_waitcnt lgkmcnt(3)
    v_mfma_f32_32x32x16_bf16 v[128:143], a[4:7], v[20:23], v[128:143]
    buffer_load_dwordx4 v2, s[40:43], s74 offen offset:2048 sc1 lds
    ds_read_b128 v[36:39], v12 offset:5120
    s_waitcnt lgkmcnt(3)
    v_mfma_f32_32x32x16_bf16 v[128:143], a[8:11], v[24:27], v[128:143]
    s_add_u32 s74, s74, 4096
    s_add_u32 m0, m0, 4096
    s_nop 0
    buffer_load_dwordx4 v2, s[40:43], s74 offen offset:0 sc1 lds
    ds_read_b128 v[40:43], v12 offset:6144
    s_waitcnt lgkmcnt(3)
    v_mfma_f32_32x32x16_bf16 v[128:143], a[12:15], v[28:31], v[128:143]
    buffer_load_dwordx4 v2, s[40:43], s74 offen offset:2048 sc1 lds
    ds_read_b128 v[44:47], v12 offset:7168
    s_waitcnt lgkmcnt(3)
    v_mfma_f32_32x32x16_bf16 v[128:143], a[16:19], v[32:35], v[128:143]
    s_lshl_b32 s74, s60, 16
    s_lshr_b32 s78, s54, 1
    s_lshl_b32 s78, s78, 14
    s_add_u32 s74, s74, s78
    s_and_b32 s78, s54, 1
    s_lshl_b32 s78, s78, 12
    s_add_u32 s74, s74, s78
    s_lshl_b32 s78, s58, 11
    s_add_u32 s74, s74, s78
    s_add_u32 s74, s74, s48
    s_add_u32 s74, s74, 16777216
    s_lshr_b32 s78, s74, 8
    s_xor_b32 s78, s78, s69
    s_and_b32 s78, s78, 0x2000
    s_or_b32 s74, s74, s78
    ds_read_b128 v[48:51], v12 offset:8192
    s_waitcnt lgkmcnt(3)
    v_mfma_f32_32x32x16_bf16 v[128:143], a[20:23], v[36:39], v[128:143]
    ds_read_b128 v[52:55], v12 offset:9216
    s_waitcnt lgkmcnt(3)
    v_mfma_f32_32x32x16_bf16 v[128:143], a[24:27], v[40:43], v[128:143]
    ds_read_b128 v[56:59], v12 offset:10240
    s_waitcnt lgkmcnt(3)
    v_mfma_f32_32x32x16_bf16 v[128:143], a[28:31], v[44:47], v[128:143]
    ds_read_b128 v[60:63], v12 offset:11264
    s_waitcnt lgkmcnt(3)
    v_mfma_f32_32x32x16_bf16 v[128:143], a[32:35], v[48:51], v[128:143]
    s_waitcnt vmcnt(5)
    s_barrier
    ds_read_b128 v[64:67], v12 offset:12288
    s_waitcnt lgkmcnt(3)
    v_mfma_f32_32x32x16_bf16 v[128:143], a[36:39], v[52:55], v[128:143]
    ds_read_b128 v[68:71], v12 offset:13312
    s_waitcnt lgkmcnt(3)
    v_mfma_f32_32x32x16_bf16 v[128:143], a[40:43], v[56:59], v[128:143]
    s_lshl_b32 s75, s54, 7
    s_mul_i32 s99, s44, 7168
    s_add_u32 s75, s75, s99
    s_add_u32 s75, s75, 229376
    s_lshl_b32 s99, s44, 10
    s_add_u32 s99, s99, 32768
    s_mov_b32 m0, s99
    s_add_u32 s99, s99, 4096
    ds_read_b128 v[72:75], v12 offset:14336
    s_waitcnt lgkmcnt(3)
    v_mfma_f32_32x32x16_bf16 v[128:143], a[44:47], v[60:63], v[128:143]
    buffer_load_dwordx4 v6, s[20:23], s75 offen lds
    s_add_u32 s75, s75, 28672
    ds_read_b128 v[76:79], v12 offset:15360
    s_waitcnt lgkmcnt(3)
    v_mfma_f32_32x32x16_bf16 v[128:143], a[48:51], v[64:67], v[128:143]
    s_mov_b32 m0, s99
    s_add_u32 s99, s99, 4096
    ds_read_b128 v[80:83], v12 offset:16384
    s_waitcnt lgkmcnt(3)
    v_mfma_f32_32x32x16_bf16 v[128:143], a[52:55], v[68:71], v[128:143]
    buffer_load_dwordx4 v6, s[20:23], s75 offen lds
    s_add_u32 s75, s75, 28672
    ds_read_b128 v[84:87], v12 offset:17408
    s_waitcnt lgkmcnt(3)
    v_mfma_f32_32x32x16_bf16 v[128:143], a[56:59], v[72:75], v[128:143]
    s_mov_b32 m0, s99
    s_add_u32 s99, s99, 4096
    ds_read_b128 v[88:91], v12 offset:18432
    s_waitcnt lgkmcnt(3)
    v_mfma_f32_32x32x16_bf16 v[128:143], a[60:63], v[76:79], v[128:143]
    buffer_load_dwordx4 v6, s[20:23], s75 offen lds
    s_add_u32 s75, s75, 28672
    ds_read_b128 v[92:95], v12 offset:19456
    s_waitcnt lgkmcnt(3)
    v_mfma_f32_32x32x16_bf16 v[128:143], a[64:67], v[80:83], v[128:143]
    s_mov_b32 m0, s99
    s_add_u32 s99, s99, 4096
    ds_read_b128 v[96:99], v12 offset:20480
    s_waitcnt lgkmcnt(3)
    v_mfma_f32_32x32x16_bf16 v[128:143], a[68:71], v[84:87], v[128:143]
    buffer_load_dwordx4 v6, s[20:23], s75 offen lds
    s_add_u32 s75, s75, 28672
    ds_read_b128 v[100:103], v12 offset:21504
    s_waitcnt lgkmcnt(3)
    v_mfma_f32_32x32x16_bf16 v[128:143], a[72:75], v[88:91], v[128:143]
    s_mov_b32 m0, s99
    s_add_u32 s99, s99, 4096
    s_waitcnt vmcnt(4)
    s_barrier
    ds_read_b128 v[104:107], v12 offset:22528
    s_waitcnt lgkmcnt(3)
    v_mfma_f32_32x32x16_bf16 v[128:143], a[76:79], v[92:95], v[128:143]
    buffer_load_dwordx4 v6, s[20:23], s75 offen lds
    s_add_u32 s75, s75, 28672
    ds_read_b128 v[108:111], v12 offset:23552
    s_waitcnt lgkmcnt(3)
    v_mfma_f32_32x32x16_bf16 v[128:143], a[80:83], v[96:99], v[128:143]
    s_mov_b32 m0, s99
    s_add_u32 s99, s99, 4096
    ds_read_b128 v[112:115], v12 offset:24576
    s_waitcnt lgkmcnt(3)
    v_mfma_f32_32x32x16_bf16 v[128:143], a[84:87], v[100:103], v[128:143]
    buffer_load_dwordx4 v6, s[20:23], s75 offen lds
    s_add_u32 s75, s75, 28672
    ds_read_b128 v[116:119], v12 offset:25600
    s_waitcnt lgkmcnt(3)
    v_mfma_f32_32x32x16_bf16 v[128:143], a[88:91], v[104:107], v[128:143]
    ds_read_b128 v[120:123], v12 offset:26624
    s_waitcnt lgkmcnt(3)
    v_mfma_f32_32x32x16_bf16 v[128:143], a[92:95], v[108:111], v[128:143]
    ds_read_b128 v[124:127], v12 offset:27648
    s_waitcnt lgkmcnt(3)
    v_mfma_f32_32x32x16_bf16 v[128:143], a[96:99], v[112:115], v[128:143]
    ds_read_b128 v[16:19], v12 offset:28672
    s_waitcnt lgkmcnt(3)
    v_mfma_f32_32x32x16_bf16 v[128:143], a[100:103], v[116:119], v[128:143]
    ds_read_b128 v[20:23], v12 offset:29696
    s_waitcnt lgkmcnt(3)
    v_mfma_f32_32x32x16_bf16 v[128:143], a[104:107], v[120:123], v[128:143]
    ds_read_b128 v[24:27], v12 offset:30720
    s_waitcnt lgkmcnt(3)
    v_mfma_f32_32x32x16_bf16 v[128:143], a[108:111], v[124:127], v[128:143]
    ds_read_b128 v[28:31], v12 offset:31744
    s_waitcnt lgkmcnt(3)
    v_mfma_f32_32x32x16_bf16 v[128:143], a[112:115], v[16:19], v[128:143]
    s_waitcnt lgkmcnt(2)
    v_mfma_f32_32x32x16_bf16 v[128:143], a[116:119], v[20:23], v[128:143]
    s_waitcnt lgkmcnt(1)
    v_mfma_f32_32x32x16_bf16 v[128:143], a[120:123], v[24:27], v[128:143]
    s_waitcnt lgkmcnt(0)
    v_mfma_f32_32x32x16_bf16 v[128:143], a[124:127], v[28:31], v[128:143]
    s_barrier
    s_nop 10
    v_cvt_pk_bf16_f32 v16, v128, v129
    v_cvt_pk_bf16_f32 v17, v130, v131
    v_cvt_pk_bf16_f32 v18, v132, v133
    v_cvt_pk_bf16_f32 v19, v134, v135
    buffer_store_dwordx4 v[16:19], v2, s[40:43], s74 offen offset:0 sc1
    v_cvt_pk_bf16_f32 v20, v136, v137
    v_cvt_pk_bf16_f32 v21, v138, v139
    v_cvt_pk_bf16_f32 v22, v140, v141
    v_cvt_pk_bf16_f32 v23, v142, v143
    buffer_store_dwordx4 v[20:23], v2, s[40:43], s74 offen offset:1024 sc1
    v_pk_add_f32 v[24:25], v[128:129], v[130:131]
    v_pk_mul_f32 v[26:27], v[128:129], v[128:129]
    v_pk_fma_f32 v[26:27], v[130:131], v[130:131], v[26:27]
    v_pk_fma_f32 v[26:27], v[132:133], v[132:133], v[26:27]
    v_pk_add_f32 v[24:25], v[24:25], v[132:133]
    v_pk_fma_f32 v[26:27], v[134:135], v[134:135], v[26:27]
    v_pk_add_f32 v[24:25], v[24:25], v[134:135]
    v_pk_fma_f32 v[26:27], v[136:137], v[136:137], v[26:27]
    v_pk_add_f32 v[24:25], v[24:25], v[136:137]
    v_pk_fma_f32 v[26:27], v[138:139], v[138:139], v[26:27]
    v_pk_add_f32 v[24:25], v[24:25], v[138:139]
    v_pk_fma_f32 v[26:27], v[140:141], v[140:141], v[26:27]
    v_pk_add_f32 v[24:25], v[24:25], v[140:141]
    v_pk_fma_f32 v[26:27], v[142:143], v[142:143], v[26:27]
    v_pk_add_f32 v[24:25], v[24:25], v[142:143]
    v_add_f32 v24, v24, v25
    v_add_f32 v25, v26, v27
    s_lshl_b32 s77, s60, 14
    v_mov_b32 v26, v24
    v_mov_b32 v27, v25
    s_lshl_b32 s78, s54, 9
    s_add_u32 s77, s77, s78
    v_permlane32_swap_b32 v24, v26
    v_permlane32_swap_b32 v25, v27
    s_lshl_b32 s78, s58, 8
    s_add_u32 s77, s77, s78
    v_pk_add_f32 v[24:25], v[24:25], v[26:27]
    v_lshlrev_b32 v26, 3, v1
    s_add_u32 s77, s77, s48
    s_add_u32 s77, s77, 50331648
    s_lshr_b32 s78, s77, 8
    s_xor_b32 s78, s78, s69
    s_and_b32 s78, s78, 0x2000
    s_or_b32 s77, s77, s78
    s_mov_b64 exec, 0xffffffff
    buffer_store_dwordx2 v[24:25], v26, s[40:43], s77 offen sc1
    s_mov_b64 exec, -1
    s_add_u32 s57, s47, 1
    s_mul_i32 s72, s57, 7
    s_mov_b32 s81, 0
    s_cmp_eq_u32 s63, 0
    s_cselect_b32 s57, s72, s57
    s_cselect_b32 s80, 1, 0x7f
    s_cselect_b32 s52, 8, 0x100
    s_add_u32 s52, s52, s71
    s_lshl_b32 s74, s58, 8
    s_lshl_b32 s75, s54, 7
    s_mul_i32 s99, s44, 7168
    s_add_u32 s75, s75, s99
    s_add_u32 s75, s75, 0
    s_lshl_b32 s99, s44, 10
    s_add_u32 s99, s99, 0
    s_mov_b32 m0, s99
    s_add_u32 s99, s99, 4096
    buffer_load_dwordx4 v6, s[20:23], s75 offen lds
    s_add_u32 s75, s75, 28672
    s_add_u32 s74, s74, 57344
    v_add_u32 v13, s74, v4
    ds_read_b64_tr_b16 a[0:1], v13 offset:0
    ds_read_b64_tr_b16 a[2:3], v13 offset:1024
    ds_read_b64_tr_b16 a[4:5], v13 offset:2048
    ds_read_b64_tr_b16 a[6:7], v13 offset:3072
    ds_read_b64_tr_b16 a[8:9], v13 offset:4096
    ds_read_b64_tr_b16 a[10:11], v13 offset:5120
    ds_read_b64_tr_b16 a[12:13], v13 offset:6144
    s_mov_b32 m0, s99
    s_add_u32 s99, s99, 4096
    buffer_load_dwordx4 v6, s[20:23], s75 offen lds
    s_add_u32 s75, s75, 28672
    ds_read_b64_tr_b16 a[14:15], v13 offset:7168
    ds_read_b64_tr_b16 a[16:17], v13 offset:8192
    ds_read_b64_tr_b16 a[18:19], v13 offset:9216
    ds_read_b64_tr_b16 a[20:21], v13 offset:10240
    ds_read_b64_tr_b16 a[22:23], v13 offset:11264
    ds_read_b64_tr_b16 a[24:25], v13 offset:12288
    ds_read_b64_tr_b16 a[26:27], v13 offset:13312
    ds_read_b64_tr_b16 a[28:29], v13 offset:14336
    ds_read_b64_tr_b16 a[30:31], v13 offset:15360
    s_mov_b32 m0, s99
    s_add_u32 s99, s99, 4096
    buffer_load_dwordx4 v6, s[20:23], s75 offen lds
    s_add_u32 s75, s75, 28672
    ds_read_b64_tr_b16 a[32:33], v13 offset:16384
    ds_read_b64_tr_b16 a[34:35], v13 offset:17408
    ds_read_b64_tr_b16 a[36:37], v13 offset:18432
    ds_read_b64_tr_b16 a[38:39], v13 offset:19456
    ds_read_b64_tr_b16 a[40:41], v13 offset:20480
    ds_read_b64_tr_b16 a[42:43], v13 offset:21504
    ds_read_b64_tr_b16 a[44:45], v13 offset:22528
    ds_read_b64_tr_b16 a[46:47], v13 offset:23552
    ds_read_b64_tr_b16 a[48:49], v13 offset:24576
    ds_read_b64_tr_b16 a[50:51], v13 offset:25600
    s_mov_b32 m0, s99
    s_add_u32 s99, s99, 4096
    buffer_load_dwordx4 v6, s[20:23], s75 offen lds
    s_add_u32 s75, s75, 28672
    ds_read_b64_tr_b16 a[52:53], v13 offset:26624
    ds_read_b64_tr_b16 a[54:55], v13 offset:27648
    ds_read_b64_tr_b16 a[56:57], v13 offset:28672
    ds_read_b64_tr_b16 a[58:59], v13 offset:29696
    ds_read_b64_tr_b16 a[60:61], v13 offset:30720
    ds_read_b64_tr_b16 a[62:63], v13 offset:31744
    ds_read_b64_tr_b16 a[64:65], v13 offset:32768
    ds_read_b64_tr_b16 a[66:67], v13 offset:33792
    ds_read_b64_tr_b16 a[68:69], v13 offset:34816
    s_mov_b32 m0, s99
    s_add_u32 s99, s99, 4096
    buffer_load_dwordx4 v6, s[20:23], s75 offen lds
    s_add_u32 s75, s75, 28672
    ds_read_b64_tr_b16 a[70:71], v13 offset:35840
    ds_read_b64_tr_b16 a[72:73], v13 offset:36864
    ds_read_b64_tr_b16 a[74:75], v13 offset:37888
    ds_read_b64_tr_b16 a[76:77], v13 offset:38912
    ds_read_b64_tr_b16 a[78:79], v13 offset:39936
    ds_read_b64_tr_b16 a[80:81], v13 offset:40960
    ds_read_b64_tr_b16 a[82:83], v13 offset:41984
    ds_read_b64_tr_b16 a[84:85], v13 offset:43008
    ds_read_b64_tr_b16 a[86:87], v13 offset:44032
    s_mov_b32 m0, s99
    s_add_u32 s99, s99, 4096
    buffer_load_dwordx4 v6, s[20:23], s75 offen lds
    s_add_u32 s75, s75, 28672
    ds_read_b64_tr_b16 a[88:89], v13 offset:45056
    ds_read_b64_tr_b16 a[90:91], v13 offset:46080
    ds_read_b64_tr_b16 a[92:93], v13 offset:47104
    ds_read_b64_tr_b16 a[94:95], v13 offset:48128
    ds_read_b64_tr_b16 a[96:97], v13 offset:49152
    s_waitcnt vmcnt(6)
    s_waitcnt lgkmcnt(0)
    s_barrier
    s_cmp_lg_u32 s44, 0
    s_cbranch_scc1 L_sig_20
    s_mov_b64 exec, 0x7f
    s_cmp_eq_u32 s63, 0
    s_cbranch_scc1 L_sig_20_s
    s_add_u32 s72, s47, 1
    v_mov_b32_e64 v10, s72
    s_lshl_b32 s72, s54, 2
    s_add_u32 s72, s72, s66
    buffer_store_dword v10, v0, s[40:43], s72 offen offset:248
    s_branch L_sig_20_e
L_sig_20_s:
    buffer_atomic_add a238, v0, s[40:43], s66 offen offset:0 sc1
L_sig_20_e:
    s_mov_b64 exec, s[80:81]
    buffer_load_dword a232, v3, s[40:43], s52 offen sc1
    s_mov_b64 exec, -1
L_sig_20:
    ds_read_b64_tr_b16 a[98:99], v13 offset:50176
    ds_read_b64_tr_b16 a[100:101], v13 offset:51200
    ds_read_b64_tr_b16 a[102:103], v13 offset:52224
    ds_read_b64_tr_b16 a[104:105], v13 offset:53248
    ds_read_b64_tr_b16 a[106:107], v13 offset:54272
    s_mov_b32 m0, s99
    s_add_u32 s99, s99, 4096
    buffer_load_dwordx4 v6, s[20:23], s75 offen lds
    s_add_u32 s75, s75, 28672
    ds_read_b64_tr_b16 a[108:109], v13 offset:55296
    ds_read_b64_tr_b16 a[110:111], v13 offset:56320
    v_accvgpr_write_b32 a240, v128
    v_accvgpr_write_b32 a241, v129
    v_accvgpr_write_b32 a242, v130
    v_accvgpr_write_b32 a243, v131
    v_accvgpr_write_b32 a244, v132
    v_accvgpr_write_b32 a245, v133
    v_accvgpr_write_b32 a246, v134
    s_mov_b32 m0, s99
    s_add_u32 s99, s99, 4096
    buffer_load_dwordx4 v6, s[20:23], s75 offen lds
    s_add_u32 s75, s75, 28672
    s_nop 0
    v_accvgpr_write_b32 a247, v135
    v_accvgpr_write_b32 a248, v136
    v_accvgpr_write_b32 a249, v137
    v_accvgpr_write_b32 a250, v138
    v_accvgpr_write_b32 a251, v139
    v_accvgpr_write_b32 a252, v140
    v_accvgpr_write_b32 a253, v141
    v_accvgpr_write_b32 a254, v142
    v_accvgpr_write_b32 a255, v143
    v_lshrrev_b32 v14, 5, v1
    v_lshlrev_b32 v14, 2, v14
    v_bfe_u32 v15, v1, 2, 2
    v_add_u32_e64 v14, v14, v15
    v_mul_u32_u24 v14, 3584, v14
    v_bfe_u32 v15, v1, 4, 1
    v_lshlrev_b32 v15, 6, v15
    v_add_u32 v14, v14, v15
    v_and_b32 v15, 3, v1
    v_lshlrev_b32 v15, 4, v15
    v_add_u32 v14, v14, v15
    v_mov_b32 v176, s88
    v_mov_b32 v177, s88
    v_mov_b32 v178, s88
    v_mov_b32 v179, s88
    v_lshrrev_b32 v10, 3, v1
    s_sub_u32 s74, s53, 1
    v_add_u32 v10, s74, v10
    v_and_b32 v250, 3, v10
    v_mul_u32_u24 v250, 7, v250
    v_and_b32 v13, 7, v1
    v_add_u32 v250, v250, v13
    v_lshlrev_b32_e64 v250, 14, v250
    v_bfe_u32 v10, v10, 2, 3
    v_lshl_add_u32 v250, v10, 10, v250
    v_bfe_u32 v10, s67, v10, 1
    v_lshl_add_u32 v250, v10, 13, v250
    s_add_u32 s79, s48, 50331648
    s_lshl_b32 s77, s60, 14
    s_add_u32 s77, s77, s79
    s_lshr_b32 s72, s77, 8
    s_xor_b32 s72, s72, s69
    s_and_b32 s72, s72, 0x2000
    s_or_b32 s77, s77, s72
    v_lshrrev_b32 v238, 5, v1
    v_mul_u32_u24 v238, 1536, v238
    v_lshl_add_u32 v238, v1, 3, v238
    s_lshl_b32 s74, s60, 16
    s_add_u32 s74, s74, s48
    s_add_u32 s74, s74, 16777216
    s_lshr_b32 s72, s74, 8
    s_xor_b32 s72, s72, s69
    s_and_b32 s72, s72, 0x2000
    s_or_b32 s74, s74, s72
    s_mov_b32 s78, 57344
    s_cmp_eq_u32 s59, 0
    s_cselect_b32 s78, 114688, s78
    v_add_u32 v12, s78, v2
    s_lshl_b32 s76, s58, 10
    s_add_u32 s78, s78, s76
    s_add_u32 s74, s74, s76
    s_cmp_lg_u32 s44, 0
    s_cbranch_scc1 L_poll_21_done
    s_mov_b64 exec, s[80:81]
    buffer_load_dword a233, v3, s[40:43], s52 offen sc1
    s_mov_b32 s73, 0
L_poll_21_loop:
    s_waitcnt vmcnt(1)
    v_accvgpr_read_b32 v11, a232
    v_cmp_gt_u32 vcc, s57, v11
    s_cbranch_vccz L_poll_21_out
    buffer_load_dword a232, v3, s[40:43], s52 offen sc1
    s_waitcnt vmcnt(1)
    v_accvgpr_read_b32 v11, a233
    v_cmp_gt_u32 vcc, s57, v11
    s_cbranch_vccz L_poll_21_out
    buffer_load_dword a233, v3, s[40:43], s52 offen sc1
    s_add_u32 s73, s73, 1
    s_cmp_lt_u32 s73, 0x20000
    s_cbranch_scc1 L_poll_21_loop
L_poll_21_out:
    s_mov_b64 exec, -1
    s_waitcnt vmcnt(1) lgkmcnt(0)
    s_branch L_poll_21_b
L_poll_21_done:
    s_waitcnt vmcnt(0) lgkmcnt(0)
L_poll_21_b:
    s_barrier
    s_mov_b32 m0, s78
    s_cmp_lg_u32 s47, 0
    s_cbranch_scc1 L_f_22_1
    buffer_load_dwordx4 v2, s[40:43], s74 offen offset:0 sc1 lds
    v_mfma_f32_32x32x16_bf16 v[208:223], a[0:3], v[176:179], 0
    v_mfma_f32_32x32x16_bf16 v[208:223], a[4:7], v[176:179], v[208:223]
    v_mfma_f32_32x32x16_bf16 v[208:223], a[8:11], v[176:179], v[208:223]
    buffer_load_dwordx4 v2, s[40:43], s74 offen offset:2048 sc1 lds
    buffer_load_dwordx2 v[224:225], v238, s[40:43], s77 offen offset:0 sc1
    buffer_load_dwordx2 v[226:227], v238, s[40:43], s77 offen offset:256 sc1
    buffer_load_dwordx2 v[228:229], v238, s[40:43], s77 offen offset:512 sc1
    buffer_load_dwordx2 v[230:231], v238, s[40:43], s77 offen offset:768 sc1
    buffer_load_dwordx2 v[232:233], v238, s[40:43], s77 offen offset:1024 sc1
    buffer_load_dwordx2 v[234:235], v238, s[40:43], s77 offen offset:1280 sc1
    buffer_load_dwordx2 v[236:237], v238, s[40:43], s77 offen offset:1536 sc1
    v_mfma_f32_32x32x16_bf16 v[208:223], a[12:15], v[176:179], v[208:223]
    v_mfma_f32_32x32x16_bf16 v[208:223], a[16:19], v[176:179], v[208:223]
    s_add_u32 s74, s74, 4096
    s_add_u32 m0, m0, 4096
    s_nop 0
    buffer_load_dwordx4 v2, s[40:43], s74 offen offset:0 sc1 lds
    v_mfma_f32_32x32x16_bf16 v[208:223], a[20:23], v[176:179], v[208:223]
    v_mfma_f32_32x32x16_bf16 v[208:223], a[24:27], v[176:179], v[208:223]
    buffer_load_dwordx4 v2, s[40:43], s74 offen offset:2048 sc1 lds
    v_mfma_f32_32x32x16_bf16 v[208:223], a[28:31], v[176:179], v[208:223]
    v_mfma_f32_32x32x16_bf16 v[208:223], a[32:35], v[176:179], v[208:223]
    v_mfma_f32_32x32x16_bf16 v[208:223], a[36:39], v[176:179], v[208:223]
    s_add_u32 s74, s74, 12288
    s_add_u32 m0, m0, 4096
    s_nop 0
    buffer_load_dwordx4 v2, s[40:43], s74 offen offset:0 sc1 lds
    v_mfma_f32_32x32x16_bf16 v[208:223], a[40:43], v[176:179], v[208:223]
    v_mfma_f32_32x32x16_bf16 v[208:223], a[44:47], v[176:179], v[208:223]
    buffer_load_dwordx4 v2, s[40:43], s74 offen offset:2048 sc1 lds
    v_mfma_f32_32x32x16_bf16 v[208:223], a[48:51], v[176:179], v[208:223]
    v_mfma_f32_32x32x16_bf16 v[208:223], a[52:55], v[176:179], v[208:223]
    s_add_u32 s74, s74, 4096
    s_add_u32 m0, m0, 4096
    s_nop 0
    buffer_load_dwordx4 v2, s[40:43], s74 offen offset:0 sc1 lds
    v_mfma_f32_32x32x16_bf16 v[208:223], a[56:59], v[176:179], v[208:223]
    v_mfma_f32_32x32x16_bf16 v[208:223], a[60:63], v[176:179], v[208:223]
    v_mfma_f32_32x32x16_bf16 v[208:223], a[64:67], v[176:179], v[208:223]
    buffer_load_dwordx4 v2, s[40:43], s74 offen offset:2048 sc1 lds
    v_mfma_f32_32x32x16_bf16 v[208:223], a[68:71], v[176:179], v[208:223]
    v_mfma_f32_32x32x16_bf16 v[208:223], a[72:75], v[176:179], v[208:223]
    s_add_u32 s74, s74, 12288
    s_add_u32 m0, m0, 4096
    s_nop 0
    buffer_load_dwordx4 v2, s[40:43], s74 offen offset:0 sc1 lds
    v_mfma_f32_32x32x16_bf16 v[208:223], a[76:79], v[176:179], v[208:223]
    v_mfma_f32_32x32x16_bf16 v[208:223], a[80:83], v[176:179], v[208:223]
    buffer_load_dwordx4 v2, s[40:43], s74 offen offset:2048 sc1 lds
    v_mfma_f32_32x32x16_bf16 v[208:223], a[84:87], v[176:179], v[208:223]
    v_mfma_f32_32x32x16_bf16 v[208:223], a[88:91], v[176:179], v[208:223]
    v_mfma_f32_32x32x16_bf16 v[208:223], a[92:95], v[176:179], v[208:223]
    s_add_u32 s74, s74, 4096
    s_add_u32 m0, m0, 4096
    s_nop 0
    buffer_load_dwordx4 v2, s[40:43], s74 offen offset:0 sc1 lds
    v_mfma_f32_32x32x16_bf16 v[208:223], a[96:99], v[176:179], v[208:223]
    v_mfma_f32_32x32x16_bf16 v[208:223], a[100:103], v[176:179], v[208:223]
    buffer_load_dwordx4 v2, s[40:43], s74 offen offset:2048 sc1 lds
    v_mfma_f32_32x32x16_bf16 v[208:223], a[104:107], v[176:179], v[208:223]
    v_mfma_f32_32x32x16_bf16 v[208:223], a[108:111], v[176:179], v[208:223]
    s_branch L_f_22_2
L_f_22_1:
    buffer_load_dwordx4 v2, s[40:43], s74 offen offset:0 sc1 lds
    v_accvgpr_read_b32 v208, a208
    v_accvgpr_read_b32 v209, a209
    buffer_load_dwordx4 v2, s[40:43], s74 offen offset:2048 sc1 lds
    buffer_load_dwordx2 v[224:225], v238, s[40:43], s77 offen offset:0 sc1
    buffer_load_dwordx2 v[226:227], v238, s[40:43], s77 offen offset:256 sc1
    buffer_load_dwordx2 v[228:229], v238, s[40:43], s77 offen offset:512 sc1
    buffer_load_dwordx2 v[230:231], v238, s[40:43], s77 offen offset:768 sc1
    buffer_load_dwordx2 v[232:233], v238, s[40:43], s77 offen offset:1024 sc1
    buffer_load_dwordx2 v[234:235], v238, s[40:43], s77 offen offset:1280 sc1
    buffer_load_dwordx2 v[236:237], v238, s[40:43], s77 offen offset:1536 sc1
    v_accvgpr_read_b32 v210, a210
    s_add_u32 s74, s74, 4096
    s_add_u32 m0, m0, 4096
    s_nop 0
    buffer_load_dwordx4 v2, s[40:43], s74 offen offset:0 sc1 lds
    v_accvgpr_read_b32 v211, a211
    buffer_load_dwordx4 v2, s[40:43], s74 offen offset:2048 sc1 lds
    v_accvgpr_read_b32 v212, a212
    v_accvgpr_read_b32 v213, a213
    s_add_u32 s74, s74, 12288
    s_add_u32 m0, m0, 4096
    s_nop 0
    buffer_load_dwordx4 v2, s[40:43], s74 offen offset:0 sc1 lds
    v_accvgpr_read_b32 v214, a214
    buffer_load_dwordx4 v2, s[40:43], s74 offen offset:2048 sc1 lds
    v_accvgpr_read_b32 v215, a215
    s_add_u32 s74, s74, 4096
    s_add_u32 m0, m0, 4096
    s_nop 0
    buffer_load_dwordx4 v2, s[40:43], s74 offen offset:0 sc1 lds
    v_accvgpr_read_b32 v216, a216
    v_accvgpr_read_b32 v217, a217
    buffer_load_dwordx4 v2, s[40:43], s74 offen offset:2048 sc1 lds
    v_accvgpr_read_b32 v218, a218
    s_add_u32 s74, s74, 12288
    s_add_u32 m0, m0, 4096
    s_nop 0
    buffer_load_dwordx4 v2, s[40:43], s74 offen offset:0 sc1 lds
    v_accvgpr_read_b32 v219, a219
    buffer_load_dwordx4 v2, s[40:43], s74 offen offset:2048 sc1 lds
    v_accvgpr_read_b32 v220, a220
    v_accvgpr_read_b32 v221, a221
    s_add_u32 s74, s74, 4096
    s_add_u32 m0, m0, 4096
    s_nop 0
    buffer_load_dwordx4 v2, s[40:43], s74 offen offset:0 sc1 lds
    v_accvgpr_read_b32 v222, a222
    buffer_load_dwordx4 v2, s[40:43], s74 offen offset:2048 sc1 lds
    v_accvgpr_read_b32 v223, a223
L_f_22_2:
    s_waitcnt vmcnt(7)
    s_barrier
    ds_read_b128 v[16:19], v12 offset:0
    ds_read_b128 v[20:23], v12 offset:1024
    ds_read_b128 v[24:27], v12 offset:2048
    ds_read_b128 v[28:31], v12 offset:3072
    s_waitcnt lgkmcnt(3)
    v_mfma_f32_32x32x16_bf16 v[128:143], a[0:3], v[16:19], 0
    s_add_u32 s74, s74, 12288
    s_add_u32 m0, m0, 4096
    s_nop 0
    buffer_load_dwordx4 v2, s[40:43], s74 offen offset:0 sc1 lds
    ds_read_b128 v[32:35], v12 offset:4096
    s_waitcnt lgkmcnt(3)
    v_mfma_f32_32x32x16_bf16 v[128:143], a[4:7], v[20:23], v[128:143]
    buffer_load_dwordx4 v2, s[40:43], s74 offen offset:2048 sc1 lds
    ds_read_b128 v[36:39], v12 offset:5120
    s_waitcnt lgkmcnt(3)
    v_mfma_f32_32x32x16_bf16 v[128:143], a[8:11], v[24:27], v[128:143]
    s_lshl_b32 s74, s60, 16
    s_lshr_b32 s78, s54, 1
    s_lshl_b32 s78, s78, 14
    s_add_u32 s74, s74, s78
    s_and_b32 s78, s54, 1
    s_lshl_b32 s78, s78, 12
    s_add_u32 s74, s74, s78
    s_lshl_b32 s78, s58, 11
    s_add_u32 s74, s74, s78
    s_add_u32 s74, s74, s48
    s_add_u32 s74, s74, 20971520
    s_lshr_b32 s78, s74, 8
    s_xor_b32 s78, s78, s69
    s_and_b32 s78, s78, 0x2000
    s_or_b32 s74, s74, s78
    ds_read_b128 v[40:43], v12 offset:6144
    s_waitcnt lgkmcnt(3)
    v_mfma_f32_32x32x16_bf16 v[128:143], a[12:15], v[28:31], v[128:143]
    ds_read_b128 v[44:47], v12 offset:7168
    s_waitcnt lgkmcnt(3)
    v_mfma_f32_32x32x16_bf16 v[128:143], a[16:19], v[32:35], v[128:143]
    ds_read_b128 v[48:51], v12 offset:8192
    s_waitcnt lgkmcnt(3)
    v_mfma_f32_32x32x16_bf16 v[128:143], a[20:23], v[36:39], v[128:143]
    ds_read_b128 v[52:55], v12 offset:9216
    s_waitcnt lgkmcnt(3)
    v_mfma_f32_32x32x16_bf16 v[128:143], a[24:27], v[40:43], v[128:143]
    v_add_f32 v224, v224, v226
    v_add_f32 v225, v225, v227
    v_add_f32 v228, v228, v230
    s_waitcnt vmcnt(4)
    s_barrier
    ds_read_b128 v[56:59], v12 offset:10240
    s_waitcnt lgkmcnt(3)
    v_mfma_f32_32x32x16_bf16 v[128:143], a[28:31], v[44:47], v[128:143]
    v_add_f32 v229, v229, v231
    v_add_f32 v232, v232, v234
    v_add_f32 v233, v233, v235
    v_add_f32 v224, v224, v228
    ds_read_b128 v[60:63], v12 offset:11264
    s_waitcnt lgkmcnt(3)
    v_mfma_f32_32x32x16_bf16 v[128:143], a[32:35], v[48:51], v[128:143]
    v_add_f32 v225, v225, v229
    v_add_f32 v232, v232, v236
    v_add_f32 v233, v233, v237
    v_add_f32 v224, v224, v232
    ds_read_b128 v[64:67], v12 offset:12288
    s_waitcnt lgkmcnt(3)
    v_mfma_f32_32x32x16_bf16 v[128:143], a[36:39], v[52:55], v[128:143]
    v_add_f32 v225, v225, v233
    v_mov_b32 v240, v224
    v_mov_b32 v241, v225
    s_nop 0
    v_permlane32_swap_b32 v240, v224
    ds_read_b128 v[68:71], v12 offset:13312
    s_waitcnt lgkmcnt(3)
    v_mfma_f32_32x32x16_bf16 v[128:143], a[40:43], v[56:59], v[128:143]
    s_lshl_b32 s75, s56, 8
    s_mul_i32 s99, s44, 28672
    s_add_u32 s75, s75, s99
    s_add_u32 s75, s75, 802816
    s_lshl_b32 s99, s44, 10
    s_add_u32 s99, s99, 86016
    s_mov_b32 m0, s99
    s_add_u32 s99, s99, 4096
    ds_read_b128 v[72:75], v12 offset:14336
    s_waitcnt lgkmcnt(3)
    v_mfma_f32_32x32x16_bf16 v[128:143], a[44:47], v[60:63], v[128:143]
    buffer_load_dwordx4 v14, s[24:27], s75 offen lds
    s_add_u32 s75, s75, 114688
    ds_read_b128 v[76:79], v12 offset:15360
    s_waitcnt lgkmcnt(3)
    v_mfma_f32_32x32x16_bf16 v[128:143], a[48:51], v[64:67], v[128:143]
    s_mov_b32 m0, s99
    s_add_u32 s99, s99, 4096
    v_permlane32_swap_b32 v241, v225
    v_add_f32 v240, v240, v224
    ds_read_b128 v[80:83], v12 offset:16384
    s_waitcnt lgkmcnt(3)
    v_mfma_f32_32x32x16_bf16 v[128:143], a[52:55], v[68:71], v[128:143]
    buffer_load_dwordx4 v14, s[24:27], s75 offen lds
    s_add_u32 s75, s75, 114688
    ds_read_b128 v[84:87], v12 offset:17408
    s_waitcnt lgkmcnt(3)
    v_mfma_f32_32x32x16_bf16 v[128:143], a[56:59], v[72:75], v[128:143]
    s_mov_b32 m0, s99
    s_add_u32 s99, s99, 4096
    v_add_f32 v241, v241, v225
    v_mul_f32 v8, s90, v240
    ds_read_b128 v[88:91], v12 offset:18432
    s_waitcnt lgkmcnt(3)
    v_mfma_f32_32x32x16_bf16 v[128:143], a[60:63], v[76:79], v[128:143]
    buffer_load_dwordx4 v14, s[24:27], s75 offen lds
    s_add_u32 s75, s75, 114688
    ds_read_b128 v[92:95], v12 offset:19456
    s_waitcnt lgkmcnt(3)
    v_mfma_f32_32x32x16_bf16 v[128:143], a[64:67], v[80:83], v[128:143]
    s_mov_b32 m0, s99
    s_add_u32 s99, s99, 4096
    v_mul_f32 v242, s90, v241
    s_waitcnt vmcnt(3)
    s_barrier
    ds_read_b128 v[96:99], v12 offset:20480
    s_waitcnt lgkmcnt(3)
    v_mfma_f32_32x32x16_bf16 v[128:143], a[68:71], v[84:87], v[128:143]
    buffer_load_dwordx4 v14, s[24:27], s75 offen lds
    s_add_u32 s75, s75, 114688
    ds_read_b128 v[100:103], v12 offset:21504
    s_waitcnt lgkmcnt(3)
    v_mfma_f32_32x32x16_bf16 v[128:143], a[72:75], v[88:91], v[128:143]
    s_mov_b32 m0, s99
    s_add_u32 s99, s99, 4096
    v_fma_f32 v242, -v8, v8, v242
    v_max_f32 v242, 0, v242
    ds_read_b128 v[104:107], v12 offset:22528
    s_waitcnt lgkmcnt(3)
    v_mfma_f32_32x32x16_bf16 v[128:143], a[76:79], v[92:95], v[128:143]
    buffer_load_dwordx4 v14, s[24:27], s75 offen lds
    s_add_u32 s75, s75, 114688
    ds_read_b128 v[108:111], v12 offset:23552
    s_waitcnt lgkmcnt(3)
    v_mfma_f32_32x32x16_bf16 v[128:143], a[80:83], v[96:99], v[128:143]
    s_mov_b32 m0, s99
    s_add_u32 s99, s99, 4096
    v_add_f32 v240, s91, v242
    ds_read_b128 v[112:115], v12 offset:24576
    s_waitcnt lgkmcnt(3)
    v_mfma_f32_32x32x16_bf16 v[128:143], a[84:87], v[100:103], v[128:143]
    buffer_load_dwordx4 v14, s[24:27], s75 offen lds
    s_add_u32 s75, s75, 114688
    ds_read_b128 v[116:119], v12 offset:25600
    s_waitcnt lgkmcnt(3)
    v_mfma_f32_32x32x16_bf16 v[128:143], a[88:91], v[104:107], v[128:143]
    s_mov_b32 m0, s99
    s_add_u32 s99, s99, 4096
    v_rsq_f32 v9, v240
    ds_read_b128 v[120:123], v12 offset:26624
    s_waitcnt lgkmcnt(3)
    v_mfma_f32_32x32x16_bf16 v[128:143], a[92:95], v[108:111], v[128:143]
    buffer_load_dwordx4 v14, s[24:27], s75 offen lds
    s_add_u32 s75, s75, 114688
    ds_read_b128 v[124:127], v12 offset:27648
    s_waitcnt lgkmcnt(3)
    v_mfma_f32_32x32x16_bf16 v[128:143], a[96:99], v[112:115], v[128:143]
    v_mul_f32 v242, v242, v9
    v_fma_f32 v242, v242, v9, s91
    v_rsq_f32 v243, v242
    s_nop 0
    v_mul_f32 v243, v243, v9
    v_mul_f32 v244, s92, v243
    s_waitcnt lgkmcnt(2)
    v_mfma_f32_32x32x16_bf16 v[128:143], a[100:103], v[116:119], v[128:143]
    v_mul_f32 v246, v243, v243
    v_mul_f32 v246, v246, v243
    v_mul_f32 v246, s93, v246
    v_rcp_f32 v248, v243
    s_waitcnt lgkmcnt(1)
    v_mfma_f32_32x32x16_bf16 v[128:143], a[104:107], v[120:123], v[128:143]
    s_waitcnt lgkmcnt(0)
    v_mfma_f32_32x32x16_bf16 v[128:143], a[108:111], v[124:127], v[128:143]
    s_barrier
    s_nop 10
    v_pk_fma_f32 v[128:129], v[8:9], v[208:209], v[128:129] op_sel_hi:[0,1,1] neg_lo:[1,0,0] neg_hi:[1,0,0]
    v_pk_fma_f32 v[130:131], v[8:9], v[210:211], v[130:131] op_sel_hi:[0,1,1] neg_lo:[1,0,0] neg_hi:[1,0,0]
    v_pk_fma_f32 v[132:133], v[8:9], v[212:213], v[132:133] op_sel_hi:[0,1,1] neg_lo:[1,0,0] neg_hi:[1,0,0]
    v_pk_fma_f32 v[134:135], v[8:9], v[214:215], v[134:135] op_sel_hi:[0,1,1] neg_lo:[1,0,0] neg_hi:[1,0,0]
    v_pk_mul_f32 v[160:161], v[128:129], v[128:129]
    v_pk_mul_f32 v[162:163], v[130:131], v[130:131]
    v_pk_mul_f32 v[164:165], v[132:133], v[132:133]
    v_pk_mul_f32 v[166:167], v[134:135], v[134:135]
    v_pk_fma_f32 v[160:161], v[160:161], v[246:247], v[244:245] op_sel_hi:[1,0,0]
    v_pk_fma_f32 v[162:163], v[162:163], v[246:247], v[244:245] op_sel_hi:[1,0,0]
    v_pk_fma_f32 v[164:165], v[164:165], v[246:247], v[244:245] op_sel_hi:[1,0,0]
    v_pk_fma_f32 v[166:167], v[166:167], v[246:247], v[244:245] op_sel_hi:[1,0,0]
    v_pk_mul_f32 v[160:161], v[160:161], v[128:129]
    v_pk_mul_f32 v[162:163], v[162:163], v[130:131]
    v_pk_mul_f32 v[164:165], v[164:165], v[132:133]
    v_pk_mul_f32 v[166:167], v[166:167], v[134:135]
    v_pk_fma_f32 v[136:137], v[8:9], v[216:217], v[136:137] op_sel_hi:[0,1,1] neg_lo:[1,0,0] neg_hi:[1,0,0]
    v_pk_fma_f32 v[138:139], v[8:9], v[218:219], v[138:139] op_sel_hi:[0,1,1] neg_lo:[1,0,0] neg_hi:[1,0,0]
    v_pk_fma_f32 v[140:141], v[8:9], v[220:221], v[140:141] op_sel_hi:[0,1,1] neg_lo:[1,0,0] neg_hi:[1,0,0]
    v_pk_fma_f32 v[142:143], v[8:9], v[222:223], v[142:143] op_sel_hi:[0,1,1] neg_lo:[1,0,0] neg_hi:[1,0,0]
    v_pk_mul_f32 v[168:169], v[136:137], v[136:137]
    v_pk_mul_f32 v[170:171], v[138:139], v[138:139]
    v_pk_mul_f32 v[172:173], v[140:141], v[140:141]
    v_pk_mul_f32 v[174:175], v[142:143], v[142:143]
    v_pk_fma_f32 v[168:169], v[168:169], v[246:247], v[244:245] op_sel_hi:[1,0,0]
    v_pk_fma_f32 v[170:171], v[170:171], v[246:247], v[244:245] op_sel_hi:[1,0,0]
    v_pk_fma_f32 v[172:173], v[172:173], v[246:247], v[244:245] op_sel_hi:[1,0,0]
    v_pk_fma_f32 v[174:175], v[174:175], v[246:247], v[244:245] op_sel_hi:[1,0,0]
    v_pk_mul_f32 v[168:169], v[168:169], v[136:137]
    v_pk_mul_f32 v[170:171], v[170:171], v[138:139]
    v_pk_mul_f32 v[172:173], v[172:173], v[140:141]
    v_pk_mul_f32 v[174:175], v[174:175], v[142:143]
    v_exp_f32 v160, v160
    v_exp_f32 v161, v161
    v_exp_f32 v162, v162
    v_exp_f32 v163, v163
    v_pk_fma_f32 v[160:161], v[160:161], v[248:249], v[248:249] op_sel_hi:[1,0,0]
    v_pk_fma_f32 v[162:163], v[162:163], v[248:249], v[248:249] op_sel_hi:[1,0,0]
    v_rcp_f32 v160, v160
    v_rcp_f32 v161, v161
    v_rcp_f32 v162, v162
    v_rcp_f32 v163, v163
    v_pk_mul_f32 v[128:129], v[128:129], v[160:161]
    v_pk_mul_f32 v[130:131], v[130:131], v[162:163]
    v_exp_f32 v164, v164
    v_exp_f32 v165, v165
    v_exp_f32 v166, v166
    v_exp_f32 v167, v167
    v_pk_fma_f32 v[164:165], v[164:165], v[248:249], v[248:249] op_sel_hi:[1,0,0]
    v_pk_fma_f32 v[166:167], v[166:167], v[248:249], v[248:249] op_sel_hi:[1,0,0]
    v_rcp_f32 v164, v164
    v_rcp_f32 v165, v165
    v_rcp_f32 v166, v166
    v_rcp_f32 v167, v167
    v_pk_mul_f32 v[132:133], v[132:133], v[164:165]
    v_pk_mul_f32 v[134:135], v[134:135], v[166:167]
    v_exp_f32 v168, v168
    v_exp_f32 v169, v169
    v_exp_f32 v170, v170
    v_exp_f32 v171, v171
    v_pk_fma_f32 v[168:169], v[168:169], v[248:249], v[248:249] op_sel_hi:[1,0,0]
    v_pk_fma_f32 v[170:171], v[170:171], v[248:249], v[248:249] op_sel_hi:[1,0,0]
    v_rcp_f32 v168, v168
    v_rcp_f32 v169, v169
    v_rcp_f32 v170, v170
    v_rcp_f32 v171, v171
    v_pk_mul_f32 v[136:137], v[136:137], v[168:169]
    v_pk_mul_f32 v[138:139], v[138:139], v[170:171]
    v_exp_f32 v172, v172
    v_exp_f32 v173, v173
    v_exp_f32 v174, v174
    v_exp_f32 v175, v175
    v_pk_fma_f32 v[172:173], v[172:173], v[248:249], v[248:249] op_sel_hi:[1,0,0]
    v_pk_fma_f32 v[174:175], v[174:175], v[248:249], v[248:249] op_sel_hi:[1,0,0]
    v_rcp_f32 v172, v172
    v_rcp_f32 v173, v173
    v_rcp_f32 v174, v174
    v_rcp_f32 v175, v175
    v_pk_mul_f32 v[140:141], v[140:141], v[172:173]
    v_pk_mul_f32 v[142:143], v[142:143], v[174:175]
    v_cvt_pk_bf16_f32 v16, v128, v129
    v_cvt_pk_bf16_f32 v17, v130, v131
    v_cvt_pk_bf16_f32 v18, v132, v133
    v_cvt_pk_bf16_f32 v19, v134, v135
    buffer_store_dwordx4 v[16:19], v2, s[40:43], s74 offen offset:0 sc1
    v_cvt_pk_bf16_f32 v20, v136, v137
    v_cvt_pk_bf16_f32 v21, v138, v139
    v_cvt_pk_bf16_f32 v22, v140, v141
    v_cvt_pk_bf16_f32 v23, v142, v143
    buffer_store_dwordx4 v[20:23], v2, s[40:43], s74 offen offset:1024 sc1
    s_add_u32 s57, s47, 1
    s_mul_i32 s72, s57, s89
    s_mov_b32 s81, 0
    s_mov_b32 s57, s72
    s_mov_b32 s80, 1
    s_add_u32 s52, s71, 12
    s_getpc_b64 s[96:97]
L_pc_23:
    s_sub_u32 s96, s96, L_pc_23-L_pc
    s_subb_u32 s97, s97, 0
    s_lshl_b32 s72, s46, 2
    s_add_u32 s72, s72, s44
    s_lshl_b32 s72, s72, 9
    v_lshl_add_u32 v88, v1, 3, s72
    s_mov_b32 s72, L_exit-L_pc-8
    v_min_u32 v88, s72, v88
    v_mov_b32 v89, s97
    v_add_co_u32 v88, vcc, s96, v88
    s_nop 1
    v_addc_co_u32 v89, vcc, 0, v89, vcc
    global_load_dwordx2 v[90:91], v[88:89], off
    s_lshl_b32 s74, s58, 8
    s_lshl_b32 s75, s56, 8
    s_mul_i32 s99, s44, 28672
    s_add_u32 s75, s75, s99
    s_add_u32 s75, s75, 0
    s_lshl_b32 s99, s44, 10
    s_add_u32 s99, s99, 57344
    s_mov_b32 m0, s99
    s_add_u32 s99, s99, 4096
    buffer_load_dwordx4 v14, s[24:27], s75 offen lds
    s_add_u32 s75, s75, 114688
    s_add_u32 s74, s74, 0
    v_add_u32 v13, s74, v4
    ds_read_b64_tr_b16 a[0:1], v13 offset:0
    ds_read_b64_tr_b16 a[2:3], v13 offset:1024
    ds_read_b64_tr_b16 a[4:5], v13 offset:2048
    ds_read_b64_tr_b16 a[6:7], v13 offset:3072
    ds_read_b64_tr_b16 a[8:9], v13 offset:4096
    ds_read_b64_tr_b16 a[10:11], v13 offset:5120
    ds_read_b64_tr_b16 a[12:13], v13 offset:6144
    ds_read_b64_tr_b16 a[14:15], v13 offset:7168
    ds_read_b64_tr_b16 a[16:17], v13 offset:8192
    ds_read_b64_tr_b16 a[18:19], v13 offset:9216
    ds_read_b64_tr_b16 a[20:21], v13 offset:10240
    ds_read_b64_tr_b16 a[22:23], v13 offset:11264
    ds_read_b64_tr_b16 a[24:25], v13 offset:12288
    ds_read_b64_tr_b16 a[26:27], v13 offset:13312
    ds_read_b64_tr_b16 a[28:29], v13 offset:14336
    s_mov_b32 m0, s99
    s_add_u32 s99, s99, 4096
    buffer_load_dwordx4 v14, s[24:27], s75 offen lds
    s_add_u32 s75, s75, 114688
    ds_read_b64_tr_b16 a[30:31], v13 offset:15360
    ds_read_b64_tr_b16 a[32:33], v13 offset:16384
    ds_read_b64_tr_b16 a[34:35], v13 offset:17408
    ds_read_b64_tr_b16 a[36:37], v13 offset:18432
    ds_read_b64_tr_b16 a[38:39], v13 offset:19456
    ds_read_b64_tr_b16 a[40:41], v13 offset:20480
    ds_read_b64_tr_b16 a[42:43], v13 offset:21504
    ds_read_b64_tr_b16 a[44:45], v13 offset:22528
    ds_read_b64_tr_b16 a[46:47], v13 offset:23552
    ds_read_b64_tr_b16 a[48:49], v13 offset:24576
    ds_read_b64_tr_b16 a[50:51], v13 offset:25600
    ds_read_b64_tr_b16 a[52:53], v13 offset:26624
    ds_read_b64_tr_b16 a[54:55], v13 offset:27648
    ds_read_b64_tr_b16 a[56:57], v13 offset:28672
    ds_read_b64_tr_b16 a[58:59], v13 offset:29696
    ds_read_b64_tr_b16 a[60:61], v13 offset:30720
    ds_read_b64_tr_b16 a[62:63], v13 offset:31744
    ds_read_b64_tr_b16 a[64:65], v13 offset:32768
    s_mov_b32 m0, s99
    s_add_u32 s99, s99, 4096
    buffer_load_dwordx4 v14, s[24:27], s75 offen lds
    s_add_u32 s75, s75, 114688
    ds_read_b64_tr_b16 a[66:67], v13 offset:33792
    ds_read_b64_tr_b16 a[68:69], v13 offset:34816
    ds_read_b64_tr_b16 a[70:71], v13 offset:35840
    ds_read_b64_tr_b16 a[72:73], v13 offset:36864
    ds_read_b64_tr_b16 a[74:75], v13 offset:37888
    ds_read_b64_tr_b16 a[76:77], v13 offset:38912
    ds_read_b64_tr_b16 a[78:79], v13 offset:39936
    ds_read_b64_tr_b16 a[80:81], v13 offset:40960
    ds_read_b64_tr_b16 a[82:83], v13 offset:41984
    ds_read_b64_tr_b16 a[84:85], v13 offset:43008
    ds_read_b64_tr_b16 a[86:87], v13 offset:44032
    ds_read_b64_tr_b16 a[88:89], v13 offset:45056
    ds_read_b64_tr_b16 a[90:91], v13 offset:46080
    ds_read_b64_tr_b16 a[92:93], v13 offset:47104
    ds_read_b64_tr_b16 a[94:95], v13 offset:48128
    ds_read_b64_tr_b16 a[96:97], v13 offset:49152
    ds_read_b64_tr_b16 a[98:99], v13 offset:50176
    ds_read_b64_tr_b16 a[100:101], v13 offset:51200
    s_mov_b32 m0, s99
    s_add_u32 s99, s99, 4096
    buffer_load_dwordx4 v14, s[24:27], s75 offen lds
    s_add_u32 s75, s75, 114688
    ds_read_b64_tr_b16 a[102:103], v13 offset:52224
    s_waitcnt vmcnt(5)
    s_waitcnt lgkmcnt(0)
    s_barrier
    s_cmp_lg_u32 s44, 0
    s_cbranch_scc1 L_sig_25
    s_mov_b64 exec, s[0:1]
    buffer_atomic_add a238, v250, s[40:43], 0 offen offset:12 sc1
L_sig_25_e:
    s_mov_b64 exec, s[80:81]
    v_accvgpr_write_b32 a232, 0
    buffer_atomic_or a232, v3, s[40:43], s52 offen sc0 sc1
    s_mov_b64 exec, -1
L_sig_25:
    ds_read_b64_tr_b16 a[104:105], v13 offset:53248
    ds_read_b64_tr_b16 a[106:107], v13 offset:54272
    ds_read_b64_tr_b16 a[108:109], v13 offset:55296
    ds_read_b64_tr_b16 a[110:111], v13 offset:56320
    s_lshl_b32 s74, s60, 5
    v_and_b32 v244, 31, v1
    v_add_u32 v244, s74, v244
    v_lshrrev_b32 v245, 5, v1
    v_lshlrev_b32 v245, 9, v245
    v_mov_b32 v11, 1073741824
    v_add_u32 v10, -1, v244
    v_cmp_gt_u32 vcc, 0x800, v10
    v_lshrrev_b32 v240, 5, v10
    v_lshrrev_b32 v246, 3, v240
    v_bfe_u32 v247, s67, v246, 1
    v_lshrrev_b32 v246, 2, v246
    v_xor_b32 v246, v246, v247
    s_mov_b32 m0, s99
    s_add_u32 s99, s99, 4096
    buffer_load_dwordx4 v14, s[24:27], s75 offen lds
    s_add_u32 s75, s75, 114688
    v_and_b32 v246, 1, v246
    v_lshlrev_b32 v240, 16, v240
    v_lshl_add_u32 v240, v246, 13, v240
    v_and_b32 v10, 31, v10
    v_lshl_add_u32 v10, v10, 4, v245
    v_add_u32 v240, v240, v10
    v_cndmask_b32 v240, v11, v240, vcc
    v_add_u32 v10, 1, v244
    v_cmp_gt_u32 vcc, 0x800, v10
    v_lshrrev_b32 v241, 5, v10
    v_lshrrev_b32 v246, 3, v241
    v_bfe_u32 v247, s67, v246, 1
    v_lshrrev_b32 v246, 2, v246
    v_xor_b32 v246, v246, v247
    v_and_b32 v246, 1, v246
    v_lshlrev_b32 v241, 16, v241
    v_lshl_add_u32 v241, v246, 13, v241
    v_and_b32 v10, 31, v10
    s_mov_b32 m0, s99
    s_add_u32 s99, s99, 4096
    buffer_load_dwordx4 v14, s[24:27], s75 offen lds
    s_add_u32 s75, s75, 114688
    v_lshl_add_u32 v10, v10, 4, v245
    v_add_u32 v241, v241, v10
    v_cndmask_b32 v241, v11, v241, vcc
    v_add_u32 v10, -2, v244
    v_cmp_gt_u32 vcc, 0x800, v10
    v_lshrrev_b32 v242, 5, v10
    v_lshrrev_b32 v246, 3, v242
    v_bfe_u32 v247, s67, v246, 1
    v_lshrrev_b32 v246, 2, v246
    v_xor_b32 v246, v246, v247
    v_and_b32 v246, 1, v246
    v_lshlrev_b32 v242, 16, v242
    v_lshl_add_u32 v242, v246, 13, v242
    v_and_b32 v10, 31, v10
    v_lshl_add_u32 v10, v10, 4, v245
    v_add_u32 v242, v242, v10
    v_cndmask_b32 v242, v11, v242, vcc
    v_add_u32 v10, 2, v244
    s_mov_b32 m0, s99
    s_add_u32 s99, s99, 4096
    buffer_load_dwordx4 v14, s[24:27], s75 offen lds
    s_add_u32 s75, s75, 114688
    v_cmp_gt_u32 vcc, 0x800, v10
    v_lshrrev_b32 v243, 5, v10
    v_lshrrev_b32 v246, 3, v243
    v_bfe_u32 v247, s67, v246, 1
    v_lshrrev_b32 v246, 2, v246
    v_xor_b32 v246, v246, v247
    v_and_b32 v246, 1, v246
    v_lshlrev_b32 v243, 16, v243
    v_lshl_add_u32 v243, v246, 13, v243
    v_and_b32 v10, 31, v10
    v_lshl_add_u32 v10, v10, 4, v245
    v_add_u32 v243, v243, v10
    v_cndmask_b32 v243, v11, v243, vcc
    s_cmp_eq_u32 s58, 0
    s_cselect_b64 vcc, 0, -1
    v_cndmask_b32 v244, v240, v241, vcc
    v_cndmask_b32 v245, v242, v243, vcc
    s_cmp_lg_u32 s47, 0
    s_cbranch_scc1 L_l0_24
    v_accvgpr_write_b32 a208, v208
    v_accvgpr_write_b32 a209, v209
    v_accvgpr_write_b32 a210, v210
    v_accvgpr_write_b32 a211, v211
    v_accvgpr_write_b32 a212, v212
    v_accvgpr_write_b32 a213, v213
    v_accvgpr_write_b32 a214, v214
    v_accvgpr_write_b32 a215, v215
    v_accvgpr_write_b32 a216, v216
    v_accvgpr_write_b32 a217, v217
    v_accvgpr_write_b32 a218, v218
    v_accvgpr_write_b32 a219, v219
    v_accvgpr_write_b32 a220, v220
    v_accvgpr_write_b32 a221, v221
    v_accvgpr_write_b32 a222, v222
    v_accvgpr_write_b32 a223, v223
L_l0_24:
    v_accvgpr_read_b32 v208, a240
    v_accvgpr_read_b32 v209, a241
    v_accvgpr_read_b32 v210, a242
    v_accvgpr_read_b32 v211, a243
    v_accvgpr_read_b32 v212, a244
    v_accvgpr_read_b32 v213, a245
    v_accvgpr_read_b32 v214, a246
    v_accvgpr_read_b32 v215, a247
    v_accvgpr_read_b32 v216, a248
    v_accvgpr_read_b32 v217, a249
    v_accvgpr_read_b32 v218, a250
    v_accvgpr_read_b32 v219, a251
    v_accvgpr_read_b32 v220, a252
    v_accvgpr_read_b32 v221, a253
    v_accvgpr_read_b32 v222, a254
    v_accvgpr_read_b32 v223, a255
    v_mov_b32 v12, v9
    s_cmp_lg_u32 s44, 0
    s_cbranch_scc1 L_kick_26
    s_mov_b64 exec, s[80:81]
    v_accvgpr_write_b32 a233, 0
    buffer_atomic_or a233, v3, s[40:43], s52 offen sc0 sc1
    s_mov_b64 exec, -1
L_kick_26:
    s_nop 0
    v_pk_add_f32 v[128:129], v[208:209], v[8:9] op_sel_hi:[1,0] neg_lo:[0,1] neg_hi:[0,1]
    v_pk_add_f32 v[130:131], v[210:211], v[8:9] op_sel_hi:[1,0] neg_lo:[0,1] neg_hi:[0,1]
    v_pk_add_f32 v[132:133], v[212:213], v[8:9] op_sel_hi:[1,0] neg_lo:[0,1] neg_hi:[0,1]
    v_pk_add_f32 v[134:135], v[214:215], v[8:9] op_sel_hi:[1,0] neg_lo:[0,1] neg_hi:[0,1]
    v_pk_add_f32 v[136:137], v[216:217], v[8:9] op_sel_hi:[1,0] neg_lo:[0,1] neg_hi:[0,1]
    v_pk_add_f32 v[138:139], v[218:219], v[8:9] op_sel_hi:[1,0] neg_lo:[0,1] neg_hi:[0,1]
    v_pk_add_f32 v[140:141], v[220:221], v[8:9] op_sel_hi:[1,0] neg_lo:[0,1] neg_hi:[0,1]
    v_pk_add_f32 v[142:143], v[222:223], v[8:9] op_sel_hi:[1,0] neg_lo:[0,1] neg_hi:[0,1]
    v_pk_mul_f32 v[128:129], v[128:129], v[12:13] op_sel_hi:[1,0]
    v_pk_mul_f32 v[130:131], v[130:131], v[12:13] op_sel_hi:[1,0]
    v_pk_mul_f32 v[132:133], v[132:133], v[12:13] op_sel_hi:[1,0]
    v_pk_mul_f32 v[134:135], v[134:135], v[12:13] op_sel_hi:[1,0]
    v_pk_mul_f32 v[136:137], v[136:137], v[12:13] op_sel_hi:[1,0]
    v_pk_mul_f32 v[138:139], v[138:139], v[12:13] op_sel_hi:[1,0]
    v_pk_mul_f32 v[140:141], v[140:141], v[12:13] op_sel_hi:[1,0]
    v_pk_mul_f32 v[142:143], v[142:143], v[12:13] op_sel_hi:[1,0]
    s_add_u32 s74, s48, 20971520
    s_mov_b32 s78, 0
    s_cmp_eq_u32 s59, 0
    s_cselect_b32 s78, 114688, s78
    v_add_u32_e64 v12, s78, v2
    s_lshl_b32 s76, s58, 10
    s_add_u32 s78, s78, s76
    s_add_u32 s74, s74, s76
    s_cmp_lg_u32 s44, 0
    s_cbranch_scc1 L_poll_27_done
    s_mov_b64 exec, s[80:81]
    v_accvgpr_write_b32 a234, 0
    buffer_atomic_or a234, v3, s[40:43], s52 offen sc0 sc1
    s_mov_b32 s73, 0
L_poll_27_loop:
    s_waitcnt vmcnt(2)
    v_accvgpr_read_b32 v11, a232
    v_cmp_gt_u32 vcc, s57, v11
    s_cbranch_vccz L_poll_27_out
    v_accvgpr_write_b32 a232, 0
    buffer_atomic_or a232, v3, s[40:43], s52 offen sc0 sc1
    s_waitcnt vmcnt(2)
    v_accvgpr_read_b32 v11, a233
    v_cmp_gt_u32 vcc, s57, v11
    s_cbranch_vccz L_poll_27_out
    v_accvgpr_write_b32 a233, 0
    buffer_atomic_or a233, v3, s[40:43], s52 offen sc0 sc1
    s_waitcnt vmcnt(2)
    v_accvgpr_read_b32 v11, a234
    v_cmp_gt_u32 vcc, s57, v11
    s_cbranch_vccz L_poll_27_out
    v_accvgpr_write_b32 a234, 0
    buffer_atomic_or a234, v3, s[40:43], s52 offen sc0 sc1
    s_add_u32 s73, s73, 1
    s_cmp_lt_u32 s73, 0x20000
    s_cbranch_scc1 L_poll_27_loop
L_poll_27_out:
    s_mov_b64 exec, -1
    s_waitcnt vmcnt(2) lgkmcnt(0)
    s_branch L_poll_27_b
L_poll_27_done:
    s_waitcnt vmcnt(0) lgkmcnt(0)
L_poll_27_b:
    s_barrier
    s_mov_b32 m0, s78
    s_nop 0
    buffer_load_dwordx4 v240, s[40:43], s74 offen offset:0 sc1 lds
    buffer_load_dwordx4 v240, s[40:43], s74 offen offset:2048 sc1 lds
    s_add_u32 s74, s74, 4096
    s_add_u32 m0, m0, 4096
    s_nop 0
    buffer_load_dwordx4 v240, s[40:43], s74 offen offset:0 sc1 lds
    buffer_load_dwordx4 v244, s[40:43], s74 offen offset:2048 sc1 lds
    s_add_u32 s74, s74, 12288
    s_add_u32 m0, m0, 4096
    s_nop 0
    buffer_load_dwordx4 v241, s[40:43], s74 offen offset:0 sc1 lds
    buffer_load_dwordx4 v241, s[40:43], s74 offen offset:2048 sc1 lds
    s_add_u32 s74, s74, 4096
    s_add_u32 m0, m0, 4096
    s_nop 0
    buffer_load_dwordx4 v241, s[40:43], s74 offen offset:0 sc1 lds
    buffer_load_dwordx4 v242, s[40:43], s74 offen offset:2048 sc1 lds
    s_add_u32 s74, s74, 12288
    s_add_u32 m0, m0, 4096
    s_nop 0
    buffer_load_dwordx4 v242, s[40:43], s74 offen offset:0 sc1 lds
    buffer_load_dwordx4 v242, s[40:43], s74 offen offset:2048 sc1 lds
    s_add_u32 s74, s74, 4096
    s_add_u32 m0, m0, 4096
    s_nop 0
    buffer_load_dwordx4 v245, s[40:43], s74 offen offset:0 sc1 lds
    buffer_load_dwordx4 v243, s[40:43], s74 offen offset:2048 sc1 lds
    s_waitcnt vmcnt(7)
    s_barrier
    ds_read_b128 v[16:19], v12 offset:0
    ds_read_b128 v[20:23], v12 offset:1024
    ds_read_b128 v[24:27], v12 offset:2048
    ds_read_b128 v[28:31], v12 offset:3072
    s_waitcnt lgkmcnt(3)
    v_mfma_f32_32x32x16_bf16 v[128:143], a[0:3], v[16:19], v[128:143]
    s_add_u32 s74, s74, 12288
    s_add_u32 m0, m0, 4096
    s_nop 0
    buffer_load_dwordx4 v243, s[40:43], s74 offen offset:0 sc1 lds
    ds_read_b128 v[32:35], v12 offset:4096
    s_waitcnt lgkmcnt(3)
    v_mfma_f32_32x32x16_bf16 v[128:143], a[4:7], v[20:23], v[128:143]
    buffer_load_dwordx4 v243, s[40:43], s74 offen offset:2048 sc1 lds
    ds_read_b128 v[36:39], v12 offset:5120
    s_waitcnt lgkmcnt(3)
    v_mfma_f32_32x32x16_bf16 v[128:143], a[8:11], v[24:27], v[128:143]
    s_lshl_b32 s74, s60, 16
    s_lshr_b32 s78, s54, 1
    s_lshl_b32 s78, s78, 14
    s_add_u32 s74, s74, s78
    s_and_b32 s78, s54, 1
    s_lshl_b32 s78, s78, 12
    s_add_u32 s74, s74, s78
    s_lshl_b32 s78, s58, 11
    s_add_u32 s74, s74, s78
    s_add_u32 s74, s74, s48
    s_add_u32 s74, s74, 25165824
    s_lshr_b32 s78, s74, 8
    s_xor_b32 s78, s78, s69
    s_and_b32 s78, s78, 0x2000
    s_or_b32 s74, s74, s78
    ds_read_b128 v[40:43], v12 offset:6144
    s_waitcnt lgkmcnt(3)
    v_mfma_f32_32x32x16_bf16 v[128:143], a[12:15], v[28:31], v[128:143]
    ds_read_b128 v[44:47], v12 offset:7168
    s_waitcnt lgkmcnt(3)
    v_mfma_f32_32x32x16_bf16 v[128:143], a[16:19], v[32:35], v[128:143]
    ds_read_b128 v[48:51], v12 offset:8192
    s_waitcnt lgkmcnt(3)
    v_mfma_f32_32x32x16_bf16 v[128:143], a[20:23], v[36:39], v[128:143]
    ds_read_b128 v[52:55], v12 offset:9216
    s_waitcnt lgkmcnt(3)
    v_mfma_f32_32x32x16_bf16 v[128:143], a[24:27], v[40:43], v[128:143]
    s_waitcnt vmcnt(4)
    s_barrier
    ds_read_b128 v[56:59], v12 offset:10240
    s_waitcnt lgkmcnt(3)
    v_mfma_f32_32x32x16_bf16 v[128:143], a[28:31], v[44:47], v[128:143]
    ds_read_b128 v[60:63], v12 offset:11264
    s_waitcnt lgkmcnt(3)
    v_mfma_f32_32x32x16_bf16 v[128:143], a[32:35], v[48:51], v[128:143]
    ds_read_b128 v[64:67], v12 offset:12288
    s_waitcnt lgkmcnt(3)
    v_mfma_f32_32x32x16_bf16 v[128:143], a[36:39], v[52:55], v[128:143]
    ds_read_b128 v[68:71], v12 offset:13312
    s_waitcnt lgkmcnt(3)
    v_mfma_f32_32x32x16_bf16 v[128:143], a[40:43], v[56:59], v[128:143]
    s_lshl_b32 s75, s56, 8
    s_add_u32 s75, s75, 128
    s_mul_i32 s99, s44, 28672
    s_add_u32 s75, s75, s99
    s_add_u32 s75, s75, 802816
    s_lshl_b32 s99, s44, 10
    s_add_u32 s99, s99, 28672
    s_mov_b32 m0, s99
    s_add_u32 s99, s99, 4096
    ds_read_b128 v[72:75], v12 offset:14336
    s_waitcnt lgkmcnt(3)
    v_mfma_f32_32x32x16_bf16 v[128:143], a[44:47], v[60:63], v[128:143]
    buffer_load_dwordx4 v14, s[24:27], s75 offen lds
    s_add_u32 s75, s75, 114688
    ds_read_b128 v[76:79], v12 offset:15360
    s_waitcnt lgkmcnt(3)
    v_mfma_f32_32x32x16_bf16 v[128:143], a[48:51], v[64:67], v[128:143]
    s_mov_b32 m0, s99
    s_add_u32 s99, s99, 4096
    ds_read_b128 v[80:83], v12 offset:16384
    s_waitcnt lgkmcnt(3)
    v_mfma_f32_32x32x16_bf16 v[128:143], a[52:55], v[68:71], v[128:143]
    buffer_load_dwordx4 v14, s[24:27], s75 offen lds
    s_add_u32 s75, s75, 114688
    ds_read_b128 v[84:87], v12 offset:17408
    s_waitcnt lgkmcnt(3)
    v_mfma_f32_32x32x16_bf16 v[128:143], a[56:59], v[72:75], v[128:143]
    s_mov_b32 m0, s99
    s_add_u32 s99, s99, 4096
    ds_read_b128 v[88:91], v12 offset:18432
    s_waitcnt lgkmcnt(3)
    v_mfma_f32_32x32x16_bf16 v[128:143], a[60:63], v[76:79], v[128:143]
    buffer_load_dwordx4 v14, s[24:27], s75 offen lds
    s_add_u32 s75, s75, 114688
    ds_read_b128 v[92:95], v12 offset:19456
    s_waitcnt lgkmcnt(3)
    v_mfma_f32_32x32x16_bf16 v[128:143], a[64:67], v[80:83], v[128:143]
    s_mov_b32 m0, s99
    s_add_u32 s99, s99, 4096
    s_waitcnt vmcnt(3)
    s_barrier
    ds_read_b128 v[96:99], v12 offset:20480
    s_waitcnt lgkmcnt(3)
    v_mfma_f32_32x32x16_bf16 v[128:143], a[68:71], v[84:87], v[128:143]
    buffer_load_dwordx4 v14, s[24:27], s75 offen lds
    s_add_u32 s75, s75, 114688
    ds_read_b128 v[100:103], v12 offset:21504
    s_waitcnt lgkmcnt(3)
    v_mfma_f32_32x32x16_bf16 v[128:143], a[72:75], v[88:91], v[128:143]
    s_mov_b32 m0, s99
    s_add_u32 s99, s99, 4096
    ds_read_b128 v[104:107], v12 offset:22528
    s_waitcnt lgkmcnt(3)
    v_mfma_f32_32x32x16_bf16 v[128:143], a[76:79], v[92:95], v[128:143]
    buffer_load_dwordx4 v14, s[24:27], s75 offen lds
    s_add_u32 s75, s75, 114688
    ds_read_b128 v[108:111], v12 offset:23552
    s_waitcnt lgkmcnt(3)
    v_mfma_f32_32x32x16_bf16 v[128:143], a[80:83], v[96:99], v[128:143]
    s_mov_b32 m0, s99
    s_add_u32 s99, s99, 4096
    ds_read_b128 v[112:115], v12 offset:24576
    s_waitcnt lgkmcnt(3)
    v_mfma_f32_32x32x16_bf16 v[128:143], a[84:87], v[100:103], v[128:143]
    buffer_load_dwordx4 v14, s[24:27], s75 offen lds
    s_add_u32 s75, s75, 114688
    ds_read_b128 v[116:119], v12 offset:25600
    s_waitcnt lgkmcnt(3)
    v_mfma_f32_32x32x16_bf16 v[128:143], a[88:91], v[104:107], v[128:143]
    s_mov_b32 m0, s99
    s_add_u32 s99, s99, 4096
    ds_read_b128 v[120:123], v12 offset:26624
    s_waitcnt lgkmcnt(3)
    v_mfma_f32_32x32x16_bf16 v[128:143], a[92:95], v[108:111], v[128:143]
    buffer_load_dwordx4 v14, s[24:27], s75 offen lds
    s_add_u32 s75, s75, 114688
    ds_read_b128 v[124:127], v12 offset:27648
    s_waitcnt lgkmcnt(3)
    v_mfma_f32_32x32x16_bf16 v[128:143], a[96:99], v[112:115], v[128:143]
    s_waitcnt lgkmcnt(2)
    v_mfma_f32_32x32x16_bf16 v[128:143], a[100:103], v[116:119], v[128:143]
    s_waitcnt lgkmcnt(1)
    v_mfma_f32_32x32x16_bf16 v[128:143], a[104:107], v[120:123], v[128:143]
    s_waitcnt lgkmcnt(0)
    v_mfma_f32_32x32x16_bf16 v[128:143], a[108:111], v[124:127], v[128:143]
    s_barrier
    s_nop 10
    v_cvt_pk_bf16_f32 v16, v128, v129
    v_cvt_pk_bf16_f32 v17, v130, v131
    v_cvt_pk_bf16_f32 v18, v132, v133
    v_cvt_pk_bf16_f32 v19, v134, v135
    buffer_store_dwordx4 v[16:19], v2, s[40:43], s74 offen offset:0 sc1
    v_cvt_pk_bf16_f32 v20, v136, v137
    v_cvt_pk_bf16_f32 v21, v138, v139
    v_cvt_pk_bf16_f32 v22, v140, v141
    v_cvt_pk_bf16_f32 v23, v142, v143
    buffer_store_dwordx4 v[20:23], v2, s[40:43], s74 offen offset:1024 sc1
    v_pk_add_f32 v[24:25], v[128:129], v[130:131]
    v_pk_mul_f32 v[26:27], v[128:129], v[128:129]
    v_pk_fma_f32 v[26:27], v[130:131], v[130:131], v[26:27]
    v_pk_fma_f32 v[26:27], v[132:133], v[132:133], v[26:27]
    v_pk_add_f32 v[24:25], v[24:25], v[132:133]
    v_pk_fma_f32 v[26:27], v[134:135], v[134:135], v[26:27]
    v_pk_add_f32 v[24:25], v[24:25], v[134:135]
    v_pk_fma_f32 v[26:27], v[136:137], v[136:137], v[26:27]
    v_pk_add_f32 v[24:25], v[24:25], v[136:137]
    v_pk_fma_f32 v[26:27], v[138:139], v[138:139], v[26:27]
    v_pk_add_f32 v[24:25], v[24:25], v[138:139]
    v_pk_fma_f32 v[26:27], v[140:141], v[140:141], v[26:27]
    v_pk_add_f32 v[24:25], v[24:25], v[140:141]
    v_pk_fma_f32 v[26:27], v[142:143], v[142:143], v[26:27]
    v_pk_add_f32 v[24:25], v[24:25], v[142:143]
    v_add_f32 v24, v24, v25
    v_add_f32 v25, v26, v27
    s_lshl_b32 s77, s60, 14
    v_mov_b32 v26, v24
    v_mov_b32 v27, v25
    s_lshl_b32 s78, s54, 9
    s_add_u32 s77, s77, s78
    v_permlane32_swap_b32 v24, v26
    v_permlane32_swap_b32 v25, v27
    s_lshl_b32 s78, s58, 8
    s_add_u32 s77, s77, s78
    v_pk_add_f32 v[24:25], v[24:25], v[26:27]
    v_lshlrev_b32 v26, 3, v1
    s_add_u32 s77, s77, s48
    s_add_u32 s77, s77, 51380224
    s_lshr_b32 s78, s77, 8
    s_xor_b32 s78, s78, s69
    s_and_b32 s78, s78, 0x2000
    s_or_b32 s77, s77, s78
    s_mov_b64 exec, 0xffffffff
    buffer_store_dwordx2 v[24:25], v26, s[40:43], s77 offen sc1
    s_mov_b64 exec, -1
    s_add_u32 s57, s47, 1
    s_mul_i32 s72, s57, 14
    s_mov_b32 s81, 0
    s_cmp_eq_u32 s63, 0
    s_cselect_b32 s57, s72, s57
    s_cselect_b32 s80, 1, 0x3fff
    s_cselect_b32 s52, 16, 0x200
    s_add_u32 s52, s52, s71
    s_getpc_b64 s[96:97]
L_pc_28:
    s_sub_u32 s96, s96, L_pc_28-L_pc
    s_subb_u32 s97, s97, 0
    s_lshl_b32 s72, s46, 2
    s_add_u32 s72, s72, s44
    s_lshl_b32 s72, s72, 9
    v_lshl_add_u32 v88, v1, 3, s72
    s_mov_b32 s72, L_exit-L_pc-8
    v_min_u32 v88, s72, v88
    v_mov_b32_e64 v89, s97
    v_add_co_u32 v88, vcc, s96, v88
    s_nop 1
    v_addc_co_u32 v89, vcc, 0, v89, vcc
    global_load_dwordx2 v[90:91], v[88:89], off
    v_pk_add_f32 v[208:209], v[208:209], v[128:129]
    s_lshl_b32 s75, s56, 8
    s_add_u32 s75, s75, 128
    s_mul_i32 s99, s44, 28672
    s_add_u32 s75, s75, s99
    s_add_u32 s75, s75, 0
    s_lshl_b32 s99, s44, 10
    s_add_u32 s99, s99, 0
    s_mov_b32 m0, s99
    s_add_u32 s99, s99, 4096
    buffer_load_dwordx4 v14, s[24:27], s75 offen lds
    s_add_u32 s75, s75, 114688
    v_pk_add_f32 v[210:211], v[210:211], v[130:131]
    v_pk_add_f32 v[212:213], v[212:213], v[132:133]
    v_pk_add_f32 v[214:215], v[214:215], v[134:135]
    s_mov_b32 m0, s99
    s_add_u32 s99, s99, 4096
    buffer_load_dwordx4 v14, s[24:27], s75 offen lds
    s_add_u32 s75, s75, 114688
    v_pk_add_f32 v[216:217], v[216:217], v[136:137]
    v_pk_add_f32 v[218:219], v[218:219], v[138:139]
    v_pk_add_f32 v[220:221], v[220:221], v[140:141]
    s_mov_b32 m0, s99
    s_add_u32 s99, s99, 4096
    buffer_load_dwordx4 v14, s[24:27], s75 offen lds
    s_add_u32 s75, s75, 114688
    v_pk_add_f32 v[222:223], v[222:223], v[142:143]
    v_accvgpr_write_b32 a240, v208
    v_accvgpr_write_b32 a241, v209
    v_accvgpr_write_b32 a242, v210
    s_mov_b32 m0, s99
    s_add_u32 s99, s99, 4096
    buffer_load_dwordx4 v14, s[24:27], s75 offen lds
    s_add_u32 s75, s75, 114688
    v_accvgpr_write_b32 a243, v211
    v_accvgpr_write_b32 a244, v212
    v_accvgpr_write_b32 a245, v213
    s_mov_b32 m0, s99
    s_add_u32 s99, s99, 4096
    buffer_load_dwordx4 v14, s[24:27], s75 offen lds
    s_add_u32 s75, s75, 114688
    v_accvgpr_write_b32 a246, v214
    v_accvgpr_write_b32 a247, v215
    s_waitcnt vmcnt(6)
    s_waitcnt lgkmcnt(0)
    s_barrier
    s_cmp_lg_u32 s44, 0
    s_cbranch_scc1 L_sig_29
    s_mov_b64 exec, 0x3fff
    s_cmp_eq_u32 s63, 0
    s_cbranch_scc1 L_sig_29_s
    s_add_u32 s72, s47, 1
    v_mov_b32 v10, s72
    s_lshl_b32 s72, s56, 2
    s_add_u32 s72, s72, s68
    buffer_store_dword v10, v0, s[40:43], s72 offen offset:496
    s_branch L_sig_29_e
L_sig_29_s:
    buffer_atomic_add a238, v0, s[40:43], s68 offen offset:0 sc1
L_sig_29_e:
    s_mov_b64 exec, s[80:81]
    buffer_load_dword a232, v3, s[40:43], s52 offen sc1
    s_mov_b64 exec, -1
L_sig_29:
    v_accvgpr_write_b32 a248, v216
    v_accvgpr_write_b32 a249, v217
    s_mov_b32 m0, s99
    s_add_u32 s99, s99, 4096
    buffer_load_dwordx4 v14, s[24:27], s75 offen lds
    s_add_u32 s75, s75, 114688
    v_accvgpr_write_b32 a250, v218
    v_accvgpr_write_b32 a251, v219
    v_accvgpr_write_b32 a252, v220
    s_mov_b32 m0, s99
    s_add_u32 s99, s99, 4096
    buffer_load_dwordx4 v14, s[24:27], s75 offen lds
    s_add_u32 s75, s75, 114688
    v_accvgpr_write_b32 a253, v221
    v_accvgpr_write_b32 a254, v222
    v_accvgpr_write_b32 a255, v223
    v_lshrrev_b32 v252, 5, v1
    v_lshlrev_b32 v252, 4, v252
    v_add_u32 v252, 161792, v252
    v_add_u32 v250, 57344, v4
    v_add_u32 v251, 0, v4
    s_mul_i32 s62, s44, 14336
    s_lshl_b32 s75, s54, 7
    s_add_u32 s62, s62, s75
    s_cmp_lt_u32 s44, 2
    s_cselect_b32 s74, 57344, 0
    s_lshl_b32 s75, s59, 8
    s_add_u32 s74, s74, s75
    v_add_u32 v12, s74, v4
    v_mov_b32 v144, s88
    v_mov_b32 v145, s88
    v_mov_b32 v146, s88
    v_mov_b32 v147, s88
    s_lshl_b32 s79, s55, 2
    s_add_u32 s79, s79, s44
    s_lshl_b32 s74, s79, 16
    s_add_u32 s74, s74, s48
    s_add_u32 s74, s74, 25165824
    s_lshr_b32 s72, s74, 8
    s_xor_b32 s72, s72, s69
    s_and_b32 s72, s72, 0x2000
    s_or_b32 s74, s74, s72
    s_add_u32 s78, s48, 51380224
    s_lshl_b32 s76, s79, 18
    s_lshl_b32 s72, s56, 14
    s_add_u32 s76, s76, s72
    s_add_u32 s76, s76, s48
    s_add_u32 s76, s76, 33554432
    s_lshr_b32 s72, s76, 8
    s_xor_b32 s72, s72, s69
    s_and_b32 s72, s72, 0x2000
    s_or_b32 s76, s76, s72
    s_mul_i32 s72, s44, 10240
    s_lshl_b32 s73, s58, 8
    s_add_u32 s72, s72, s73
    s_add_u32 s72, s72, 114688
    v_add_u32 v224, s72, v4
    v_xor_b32 v225, 256, v224
    s_mul_i32 s72, s44, 14336
    s_lshl_b32 s73, s58, 8
    s_add_u32 s72, s72, s73
    s_add_u32 s72, s72, 57344
    v_add_u32_e64 v226, s72, v4
    v_xor_b32 v227, 256, v226
    s_mul_i32 s72, s44, 14336
    s_lshl_b32 s73, s58, 8
    s_add_u32 s72, s72, s73
    s_add_u32 s72, s72, 0
    v_add_u32 v228, s72, v4
    v_xor_b32 v229, 256, v228
    s_nop 1
    s_cmp_lg_u32 s44, 0
    s_cbranch_scc1 L_poll_30_done
    s_mov_b64 exec, s[80:81]
    buffer_load_dword a233, v3, s[40:43], s52 offen sc1
    s_mov_b32 s73, 0
L_poll_30_loop:
    s_waitcnt vmcnt(1)
    v_accvgpr_read_b32 v11, a232
    v_cmp_gt_u32 vcc, s57, v11
    s_cbranch_vccz L_poll_30_out
    buffer_load_dword a232, v3, s[40:43], s52 offen sc1
    s_waitcnt vmcnt(1)
    v_accvgpr_read_b32 v11, a233
    v_cmp_gt_u32 vcc, s57, v11
    s_cbranch_vccz L_poll_30_out
    buffer_load_dword a233, v3, s[40:43], s52 offen sc1
    s_add_u32 s73, s73, 1
    s_cmp_lt_u32 s73, 0x20000
    s_cbranch_scc1 L_poll_30_loop
L_poll_30_out:
    s_mov_b64 exec, -1
    s_waitcnt vmcnt(1) lgkmcnt(0)
    s_branch L_poll_30_b
L_poll_30_done:
    s_waitcnt vmcnt(0) lgkmcnt(0)
L_poll_30_b:
    s_barrier
    buffer_load_dwordx4 a[0:3], v2, s[40:43], s74 offen offset:0 sc1
    buffer_load_dwordx4 a[4:7], v2, s[40:43], s74 offen offset:1024 sc1
    buffer_load_dwordx4 a[8:11], v2, s[40:43], s74 offen offset:2048 sc1
    buffer_load_dwordx4 a[12:15], v2, s[40:43], s74 offen offset:3072 sc1
    s_add_u32 s74, s74, 4096
    buffer_load_dwordx4 a[16:19], v2, s[40:43], s74 offen offset:0 sc1
    buffer_load_dwordx4 a[20:23], v2, s[40:43], s74 offen offset:1024 sc1
    buffer_load_dwordx4 a[24:27], v2, s[40:43], s74 offen offset:2048 sc1
    buffer_load_dwordx4 a[28:31], v2, s[40:43], s74 offen offset:3072 sc1
    ds_read_b64_tr_b16 v[80:81], v250 offset:0
    ds_read_b64_tr_b16 v[82:83], v250 offset:1024
    ds_read_b64_tr_b16 v[84:85], v250 offset:256
    ds_read_b64_tr_b16 v[86:87], v250 offset:1280
    ds_read_b64_tr_b16 v[88:89], v250 offset:2048
    ds_read_b64_tr_b16 v[90:91], v250 offset:3072
    ds_read_b64_tr_b16 v[92:93], v250 offset:2304
    ds_read_b64_tr_b16 v[94:95], v250 offset:3328
    ds_read_b64_tr_b16 v[96:97], v250 offset:4096
    ds_read_b64_tr_b16 v[98:99], v250 offset:5120
    ds_read_b64_tr_b16 v[100:101], v250 offset:4352
    ds_read_b64_tr_b16 v[102:103], v250 offset:5376
    s_cmp_lg_u32 s47, 0
    s_cbranch_scc1 L_w3p1_31_0
    ds_read_b64_tr_b16 v[208:209], v12 offset:0
    ds_read_b64_tr_b16 v[210:211], v12 offset:1024
    ds_read_b64_tr_b16 v[212:213], v12 offset:2048
    ds_read_b64_tr_b16 v[214:215], v12 offset:3072
    ds_read_b64_tr_b16 v[216:217], v12 offset:4096
    ds_read_b64_tr_b16 v[218:219], v12 offset:5120
    s_waitcnt lgkmcnt(4)
    v_mfma_f32_32x32x16_bf16 v[192:207], v[208:211], v[144:147], 0
    ds_read_b64_tr_b16 v[220:221], v12 offset:6144
    ds_read_b64_tr_b16 v[222:223], v12 offset:7168
    s_waitcnt lgkmcnt(4)
    v_mfma_f32_32x32x16_bf16 v[192:207], v[212:215], v[144:147], v[192:207]
    s_lshl_b32 s77, s79, 14
    s_add_u32 s77, s77, s78
    s_lshr_b32 s72, s77, 8
    s_xor_b32 s72, s72, s69
    s_and_b32 s72, s72, 0x2000
    s_or_b32 s77, s77, s72
    v_lshrrev_b32 v190, 5, v1
    v_mul_u32_u24 v190, 1536, v190
    v_lshl_add_u32 v190, v1, 3, v190
    buffer_load_dwordx2 v[176:177], v190, s[40:43], s77 offen offset:0 sc1
    ds_read_b64_tr_b16 v[208:209], v12 offset:8192
    ds_read_b64_tr_b16 v[210:211], v12 offset:9216
    s_waitcnt lgkmcnt(4)
    v_mfma_f32_32x32x16_bf16 v[192:207], v[216:219], v[144:147], v[192:207]
    buffer_load_dwordx2 v[178:179], v190, s[40:43], s77 offen offset:256 sc1
    ds_read_b64_tr_b16 v[212:213], v12 offset:10240
    ds_read_b64_tr_b16 v[214:215], v12 offset:11264
    s_waitcnt lgkmcnt(4)
    v_mfma_f32_32x32x16_bf16 v[192:207], v[220:223], v[144:147], v[192:207]
    buffer_load_dwordx2 v[180:181], v190, s[40:43], s77 offen offset:512 sc1
    ds_read_b64_tr_b16 v[216:217], v12 offset:12288
    ds_read_b64_tr_b16 v[218:219], v12 offset:13312
    s_waitcnt lgkmcnt(4)
    v_mfma_f32_32x32x16_bf16 v[192:207], v[208:211], v[144:147], v[192:207]
    buffer_load_dwordx2 v[182:183], v190, s[40:43], s77 offen offset:768 sc1
    ds_read_b64_tr_b16 v[220:221], v12 offset:14336
    ds_read_b64_tr_b16 v[222:223], v12 offset:15360
    s_waitcnt lgkmcnt(4)
    v_mfma_f32_32x32x16_bf16 v[192:207], v[212:215], v[144:147], v[192:207]
    buffer_load_dwordx2 v[184:185], v190, s[40:43], s77 offen offset:1024 sc1
    ds_read_b64_tr_b16 v[208:209], v12 offset:16384
    ds_read_b64_tr_b16 v[210:211], v12 offset:17408
    s_waitcnt lgkmcnt(4)
    v_mfma_f32_32x32x16_bf16 v[192:207], v[216:219], v[144:147], v[192:207]
    buffer_load_dwordx2 v[186:187], v190, s[40:43], s77 offen offset:1280 sc1
    ds_read_b64_tr_b16 v[212:213], v12 offset:18432
    ds_read_b64_tr_b16 v[214:215], v12 offset:19456
    s_waitcnt lgkmcnt(4)
    v_mfma_f32_32x32x16_bf16 v[192:207], v[220:223], v[144:147], v[192:207]
    buffer_load_dwordx2 v[188:189], v190, s[40:43], s77 offen offset:1536 sc1
    ds_read_b64_tr_b16 v[216:217], v12 offset:20480
    ds_read_b64_tr_b16 v[218:219], v12 offset:21504
    s_waitcnt lgkmcnt(4)
    v_mfma_f32_32x32x16_bf16 v[192:207], v[208:211], v[144:147], v[192:207]
    ds_read_b64_tr_b16 v[220:221], v12 offset:22528
    ds_read_b64_tr_b16 v[222:223], v12 offset:23552
    s_waitcnt lgkmcnt(4)
    v_mfma_f32_32x32x16_bf16 v[192:207], v[212:215], v[144:147], v[192:207]
    ds_read_b64_tr_b16 v[208:209], v12 offset:24576
    ds_read_b64_tr_b16 v[210:211], v12 offset:25600
    s_waitcnt lgkmcnt(4)
    v_mfma_f32_32x32x16_bf16 v[192:207], v[216:219], v[144:147], v[192:207]
    ds_read_b64_tr_b16 v[212:213], v12 offset:26624
    ds_read_b64_tr_b16 v[214:215], v12 offset:27648
    s_waitcnt lgkmcnt(4)
    v_mfma_f32_32x32x16_bf16 v[192:207], v[220:223], v[144:147], v[192:207]
    ds_read_b64_tr_b16 v[216:217], v12 offset:28672
    ds_read_b64_tr_b16 v[218:219], v12 offset:29696
    s_waitcnt lgkmcnt(4)
    v_mfma_f32_32x32x16_bf16 v[192:207], v[208:211], v[144:147], v[192:207]
    ds_read_b64_tr_b16 v[220:221], v12 offset:30720
    ds_read_b64_tr_b16 v[222:223], v12 offset:31744
    s_waitcnt lgkmcnt(4)
    v_mfma_f32_32x32x16_bf16 v[192:207], v[212:215], v[144:147], v[192:207]
    ds_read_b64_tr_b16 v[208:209], v12 offset:32768
    ds_read_b64_tr_b16 v[210:211], v12 offset:33792
    s_waitcnt lgkmcnt(4)
    v_mfma_f32_32x32x16_bf16 v[192:207], v[216:219], v[144:147], v[192:207]
    ds_read_b64_tr_b16 v[212:213], v12 offset:34816
    ds_read_b64_tr_b16 v[214:215], v12 offset:35840
    s_waitcnt lgkmcnt(4)
    v_mfma_f32_32x32x16_bf16 v[192:207], v[220:223], v[144:147], v[192:207]
    ds_read_b64_tr_b16 v[216:217], v12 offset:36864
    ds_read_b64_tr_b16 v[218:219], v12 offset:37888
    s_waitcnt lgkmcnt(4)
    v_mfma_f32_32x32x16_bf16 v[192:207], v[208:211], v[144:147], v[192:207]
    ds_read_b64_tr_b16 v[220:221], v12 offset:38912
    ds_read_b64_tr_b16 v[222:223], v12 offset:39936
    s_waitcnt lgkmcnt(4)
    v_mfma_f32_32x32x16_bf16 v[192:207], v[212:215], v[144:147], v[192:207]
    ds_read_b64_tr_b16 v[208:209], v12 offset:40960
    ds_read_b64_tr_b16 v[210:211], v12 offset:41984
    s_waitcnt lgkmcnt(4)
    v_mfma_f32_32x32x16_bf16 v[192:207], v[216:219], v[144:147], v[192:207]
    ds_read_b64_tr_b16 v[212:213], v12 offset:43008
    ds_read_b64_tr_b16 v[214:215], v12 offset:44032
    s_waitcnt lgkmcnt(4)
    v_mfma_f32_32x32x16_bf16 v[192:207], v[220:223], v[144:147], v[192:207]
    ds_read_b64_tr_b16 v[216:217], v12 offset:45056
    ds_read_b64_tr_b16 v[218:219], v12 offset:46080
    s_waitcnt lgkmcnt(4)
    v_mfma_f32_32x32x16_bf16 v[192:207], v[208:211], v[144:147], v[192:207]
    s_add_u32 s74, s74, 12288
    buffer_load_dwordx4 a[32:35], v2, s[40:43], s74 offen offset:0 sc1
    ds_read_b64_tr_b16 v[220:221], v12 offset:47104
    ds_read_b64_tr_b16 v[222:223], v12 offset:48128
    s_waitcnt lgkmcnt(4)
    v_mfma_f32_32x32x16_bf16 v[192:207], v[212:215], v[144:147], v[192:207]
    ds_read_b64_tr_b16 v[208:209], v12 offset:49152
    ds_read_b64_tr_b16 v[210:211], v12 offset:50176
    s_waitcnt lgkmcnt(4)
    v_mfma_f32_32x32x16_bf16 v[192:207], v[216:219], v[144:147], v[192:207]
    buffer_load_dwordx4 a[36:39], v2, s[40:43], s74 offen offset:1024 sc1
    ds_read_b64_tr_b16 v[212:213], v12 offset:51200
    ds_read_b64_tr_b16 v[214:215], v12 offset:52224
    s_waitcnt lgkmcnt(4)
    v_mfma_f32_32x32x16_bf16 v[192:207], v[220:223], v[144:147], v[192:207]
    ds_read_b64_tr_b16 v[216:217], v12 offset:53248
    ds_read_b64_tr_b16 v[218:219], v12 offset:54272
    s_waitcnt lgkmcnt(4)
    v_mfma_f32_32x32x16_bf16 v[192:207], v[208:211], v[144:147], v[192:207]
    buffer_load_dwordx4 a[40:43], v2, s[40:43], s74 offen offset:2048 sc1
    ds_read_b64_tr_b16 v[220:221], v12 offset:55296
    ds_read_b64_tr_b16 v[222:223], v12 offset:56320
    s_waitcnt lgkmcnt(4)
    v_mfma_f32_32x32x16_bf16 v[192:207], v[212:215], v[144:147], v[192:207]
    s_waitcnt lgkmcnt(2)
    v_mfma_f32_32x32x16_bf16 v[192:207], v[216:219], v[144:147], v[192:207]
    s_lshl_b32 s72, s44, 7
    v_lshrrev_b32 v10, 5, v1
    v_lshlrev_b32 v10, 4, v10
    v_add_u32_e64 v10, s72, v10
    v_add_u32 v11, 161792, v10
    s_add_u32 s72, s61, 512
    s_waitcnt lgkmcnt(0)
    v_mfma_f32_32x32x16_bf16 v[192:207], v[220:223], v[144:147], v[192:207]
    s_waitcnt vmcnt(17)
    v_mfma_f32_32x32x16_bf16 v[16:31], v[80:83], a[0:3], 0
    buffer_load_dwordx4 a[44:47], v2, s[40:43], s74 offen offset:3072 sc1
    ds_read_b64_tr_b16 v[104:105], v250 offset:6144
    ds_read_b64_tr_b16 v[106:107], v250 offset:7168
    v_mfma_f32_32x32x16_bf16 v[32:47], v[84:87], a[0:3], 0
    ds_read_b64_tr_b16 v[108:109], v250 offset:6400
    ds_read_b64_tr_b16 v[110:111], v250 offset:7424
    s_waitcnt vmcnt(17)
    v_mfma_f32_32x32x16_bf16 v[16:31], v[88:91], a[4:7], v[16:31]
    s_add_u32 s74, s74, 4096
    buffer_load_dwordx4 a[48:51], v2, s[40:43], s74 offen offset:0 sc1
    ds_read_b64_tr_b16 v[80:81], v250 offset:8192
    ds_read_b64_tr_b16 v[82:83], v250 offset:9216
    s_mov_b32 exec_lo, 1
    s_mov_b32 exec_hi, 1
    ds_write_b128 v11, v[192:195] offset:0
    ds_write_b128 v11, v[196:199] offset:32
    ds_write_b128 v11, v[200:203] offset:64
    ds_write_b128 v11, v[204:207] offset:96
    s_mov_b64 exec, -1
    v_mfma_f32_32x32x16_bf16 v[32:47], v[92:95], a[4:7], v[32:47]
    ds_read_b64_tr_b16 v[84:85], v250 offset:8448
    ds_read_b64_tr_b16 v[86:87], v250 offset:9472
    s_waitcnt vmcnt(17)
    v_mfma_f32_32x32x16_bf16 v[16:31], v[96:99], a[8:11], v[16:31]
    buffer_load_dwordx4 a[52:55], v2, s[40:43], s74 offen offset:1024 sc1
    ds_read_b64_tr_b16 v[88:89], v250 offset:10240
    ds_read_b64_tr_b16 v[90:91], v250 offset:11264
    v_mfma_f32_32x32x16_bf16 v[32:47], v[100:103], a[8:11], v[32:47]
    ds_read_b64_tr_b16 v[92:93], v250 offset:10496
    ds_read_b64_tr_b16 v[94:95], v250 offset:11520
    s_waitcnt vmcnt(17) lgkmcnt(14)
    v_mfma_f32_32x32x16_bf16 v[16:31], v[104:107], a[12:15], v[16:31]
    buffer_load_dwordx4 a[56:59], v2, s[40:43], s74 offen offset:2048 sc1
    ds_read_b64_tr_b16 v[96:97], v250 offset:12288
    ds_read_b64_tr_b16 v[98:99], v250 offset:13312
    s_waitcnt lgkmcnt(14)
    v_mfma_f32_32x32x16_bf16 v[32:47], v[108:111], a[12:15], v[32:47]
    ds_read_b64_tr_b16 v[100:101], v250 offset:12544
    ds_read_b64_tr_b16 v[102:103], v250 offset:13568
    s_waitcnt vmcnt(17) lgkmcnt(14)
    v_mfma_f32_32x32x16_bf16 v[16:31], v[80:83], a[16:19], v[16:31]
    buffer_load_dwordx4 a[60:63], v2, s[40:43], s74 offen offset:3072 sc1
    ds_read_b64_tr_b16 v[104:105], v250 offset:14336
    ds_read_b64_tr_b16 v[106:107], v250 offset:15360
    s_waitcnt lgkmcnt(10)
    v_mfma_f32_32x32x16_bf16 v[32:47], v[84:87], a[16:19], v[32:47]
    ds_read_b64_tr_b16 v[108:109], v250 offset:14592
    ds_read_b64_tr_b16 v[110:111], v250 offset:15616
    s_barrier
    s_waitcnt vmcnt(17) lgkmcnt(10)
    v_mfma_f32_32x32x16_bf16 v[16:31], v[88:91], a[20:23], v[16:31]
    s_add_u32 s74, s74, 12288
    buffer_load_dwordx4 a[64:67], v2, s[40:43], s74 offen offset:0 sc1
    ds_read_b64_tr_b16 v[80:81], v250 offset:16384
    ds_read_b64_tr_b16 v[82:83], v250 offset:17408
    s_waitcnt lgkmcnt(10)
    v_mfma_f32_32x32x16_bf16 v[32:47], v[92:95], a[20:23], v[32:47]
    ds_read_b128 v[112:115], v252 offset:0
    ds_read_b64_tr_b16 v[84:85], v250 offset:16640
    ds_read_b64_tr_b16 v[86:87], v250 offset:17664
    s_waitcnt vmcnt(17) lgkmcnt(11)
    v_mfma_f32_32x32x16_bf16 v[16:31], v[96:99], a[24:27], v[16:31]
    buffer_load_dwordx4 a[68:71], v2, s[40:43], s74 offen offset:1024 sc1
    ds_read_b64_tr_b16 v[88:89], v250 offset:18432
    ds_read_b64_tr_b16 v[90:91], v250 offset:19456
    s_waitcnt lgkmcnt(11)
    v_mfma_f32_32x32x16_bf16 v[32:47], v[100:103], a[24:27], v[32:47]
    ds_read_b128 v[116:119], v252 offset:32
    ds_read_b64_tr_b16 v[92:93], v250 offset:18688
    ds_read_b64_tr_b16 v[94:95], v250 offset:19712
    s_waitcnt vmcnt(17) lgkmcnt(12)
    v_mfma_f32_32x32x16_bf16 v[16:31], v[104:107], a[28:31], v[16:31]
    buffer_load_dwordx4 a[72:75], v2, s[40:43], s74 offen offset:2048 sc1
    ds_read_b64_tr_b16 v[96:97], v250 offset:20480
    ds_read_b64_tr_b16 v[98:99], v250 offset:21504
    s_waitcnt lgkmcnt(12)
    v_mfma_f32_32x32x16_bf16 v[32:47], v[108:111], a[28:31], v[32:47]
    ds_read_b128 v[120:123], v252 offset:64
    ds_read_b64_tr_b16 v[100:101], v250 offset:20736
    ds_read_b64_tr_b16 v[102:103], v250 offset:21760
    s_waitcnt vmcnt(10) lgkmcnt(13)
    v_mfma_f32_32x32x16_bf16 v[16:31], v[80:83], a[32:35], v[16:31]
    buffer_load_dwordx4 a[76:79], v2, s[40:43], s74 offen offset:3072 sc1
    ds_read_b64_tr_b16 v[104:105], v250 offset:22528
    ds_read_b64_tr_b16 v[106:107], v250 offset:23552
    s_waitcnt lgkmcnt(12)
    v_mfma_f32_32x32x16_bf16 v[32:47], v[84:87], a[32:35], v[32:47]
    ds_read_b128 v[124:127], v252 offset:96
    ds_read_b64_tr_b16 v[108:109], v250 offset:22784
    ds_read_b64_tr_b16 v[110:111], v250 offset:23808
    s_waitcnt vmcnt(10) lgkmcnt(13)
    v_mfma_f32_32x32x16_bf16 v[16:31], v[88:91], a[36:39], v[16:31]
    s_add_u32 s74, s74, 4096
    buffer_load_dwordx4 a[80:83], v2, s[40:43], s74 offen offset:0 sc1
    ds_read_b64_tr_b16 v[80:81], v250 offset:24576
    ds_read_b64_tr_b16 v[82:83], v250 offset:25600
    s_waitcnt lgkmcnt(12)
    v_mfma_f32_32x32x16_bf16 v[32:47], v[92:95], a[36:39], v[32:47]
    ds_read_b128 v[128:131], v252 offset:128
    ds_read_b64_tr_b16 v[84:85], v250 offset:24832
    ds_read_b64_tr_b16 v[86:87], v250 offset:25856
    s_waitcnt vmcnt(10) lgkmcnt(13)
    v_mfma_f32_32x32x16_bf16 v[16:31], v[96:99], a[40:43], v[16:31]
    buffer_load_dwordx4 a[84:87], v2, s[40:43], s74 offen offset:1024 sc1
    ds_read_b64_tr_b16 v[88:89], v250 offset:26624
    ds_read_b64_tr_b16 v[90:91], v250 offset:27648
    s_waitcnt lgkmcnt(12)
    v_mfma_f32_32x32x16_bf16 v[32:47], v[100:103], a[40:43], v[32:47]
    ds_read_b128 v[132:135], v252 offset:160
    ds_read_b64_tr_b16 v[92:93], v250 offset:26880
    ds_read_b64_tr_b16 v[94:95], v250 offset:27904
    s_waitcnt vmcnt(10) lgkmcnt(13)
    v_mfma_f32_32x32x16_bf16 v[16:31], v[104:107], a[44:47], v[16:31]
    buffer_load_dwordx4 a[88:91], v2, s[40:43], s74 offen offset:2048 sc1
    ds_read_b64_tr_b16 v[96:97], v250 offset:28672
    ds_read_b64_tr_b16 v[98:99], v250 offset:29696
    s_waitcnt lgkmcnt(12)
    v_mfma_f32_32x32x16_bf16 v[32:47], v[108:111], a[44:47], v[32:47]
    ds_read_b128 v[136:139], v252 offset:192
    ds_read_b64_tr_b16 v[100:101], v250 offset:28928
    ds_read_b64_tr_b16 v[102:103], v250 offset:29952
    s_waitcnt vmcnt(10) lgkmcnt(13)
    v_mfma_f32_32x32x16_bf16 v[16:31], v[80:83], a[48:51], v[16:31]
    buffer_load_dwordx4 a[92:95], v2, s[40:43], s74 offen offset:3072 sc1
    ds_read_b64_tr_b16 v[104:105], v250 offset:30720
    ds_read_b64_tr_b16 v[106:107], v250 offset:31744
    s_waitcnt lgkmcnt(12)
    v_mfma_f32_32x32x16_bf16 v[32:47], v[84:87], a[48:51], v[32:47]
    ds_read_b128 v[140:143], v252 offset:224
    ds_read_b64_tr_b16 v[108:109], v250 offset:30976
    ds_read_b64_tr_b16 v[110:111], v250 offset:32000
    s_waitcnt vmcnt(10) lgkmcnt(13)
    v_mfma_f32_32x32x16_bf16 v[16:31], v[88:91], a[52:55], v[16:31]
    s_add_u32 s74, s74, 12288
    buffer_load_dwordx4 a[96:99], v2, s[40:43], s74 offen offset:0 sc1
    ds_read_b64_tr_b16 v[80:81], v250 offset:32768
    ds_read_b64_tr_b16 v[82:83], v250 offset:33792
    s_waitcnt lgkmcnt(12)
    v_mfma_f32_32x32x16_bf16 v[32:47], v[92:95], a[52:55], v[32:47]
    ds_read_b128 v[144:147], v252 offset:256
    ds_read_b64_tr_b16 v[84:85], v250 offset:33024
    ds_read_b64_tr_b16 v[86:87], v250 offset:34048
    s_waitcnt vmcnt(10) lgkmcnt(13)
    v_mfma_f32_32x32x16_bf16 v[16:31], v[96:99], a[56:59], v[16:31]
    buffer_load_dwordx4 a[100:103], v2, s[40:43], s74 offen offset:1024 sc1
    ds_read_b64_tr_b16 v[88:89], v250 offset:34816
    ds_read_b64_tr_b16 v[90:91], v250 offset:35840
    s_waitcnt lgkmcnt(12)
    v_mfma_f32_32x32x16_bf16 v[32:47], v[100:103], a[56:59], v[32:47]
    ds_read_b128 v[148:151], v252 offset:288
    ds_read_b64_tr_b16 v[92:93], v250 offset:35072
    ds_read_b64_tr_b16 v[94:95], v250 offset:36096
    s_waitcnt vmcnt(10) lgkmcnt(13)
    v_mfma_f32_32x32x16_bf16 v[16:31], v[104:107], a[60:63], v[16:31]
    buffer_load_dwordx4 a[104:107], v2, s[40:43], s74 offen offset:2048 sc1
    ds_read_b64_tr_b16 v[96:97], v250 offset:36864
    ds_read_b64_tr_b16 v[98:99], v250 offset:37888
    s_waitcnt lgkmcnt(12)
    v_mfma_f32_32x32x16_bf16 v[32:47], v[108:111], a[60:63], v[32:47]
    ds_read_b128 v[152:155], v252 offset:320
    ds_read_b64_tr_b16 v[100:101], v250 offset:37120
    ds_read_b64_tr_b16 v[102:103], v250 offset:38144
    s_waitcnt vmcnt(10) lgkmcnt(13)
    v_mfma_f32_32x32x16_bf16 v[16:31], v[80:83], a[64:67], v[16:31]
    buffer_load_dwordx4 a[108:111], v2, s[40:43], s74 offen offset:3072 sc1
    ds_read_b64_tr_b16 v[104:105], v250 offset:38912
    ds_read_b64_tr_b16 v[106:107], v250 offset:39936
    s_waitcnt lgkmcnt(12)
    v_mfma_f32_32x32x16_bf16 v[32:47], v[84:87], a[64:67], v[32:47]
    s_mul_i32 s98, s44, 10240
    s_add_u32 m0, s98, 114688
    s_add_u32 s99, s62, 0
    s_add_u32 s100, s62, 6144
    ds_read_b64_tr_b16 v[108:109], v250 offset:39168
    ds_read_b64_tr_b16 v[110:111], v250 offset:40192
    s_waitcnt vmcnt(10) lgkmcnt(12)
    v_mfma_f32_32x32x16_bf16 v[16:31], v[88:91], a[68:71], v[16:31]
    buffer_load_dwordx4 v6, s[28:31], s99 offen offset:0 lds
    ds_read_b64_tr_b16 v[80:81], v250 offset:40960
    ds_read_b64_tr_b16 v[82:83], v250 offset:41984
    s_waitcnt lgkmcnt(11)
    v_mfma_f32_32x32x16_bf16 v[32:47], v[92:95], a[68:71], v[32:47]
    ds_read_b128 v[156:159], v252 offset:352
    ds_read_b64_tr_b16 v[84:85], v250 offset:41216
    ds_read_b64_tr_b16 v[86:87], v250 offset:42240
    s_waitcnt vmcnt(10) lgkmcnt(12)
    v_mfma_f32_32x32x16_bf16 v[16:31], v[96:99], a[72:75], v[16:31]
    buffer_load_dwordx4 v6, s[28:31], s100 offen offset:1024 lds
    ds_read_b64_tr_b16 v[88:89], v250 offset:43008
    ds_read_b64_tr_b16 v[90:91], v250 offset:44032
    s_waitcnt lgkmcnt(11)
    v_mfma_f32_32x32x16_bf16 v[32:47], v[100:103], a[72:75], v[32:47]
    s_add_u32 m0, s98, 116736
    s_add_u32 s99, s62, 114688
    s_add_u32 s100, s62, 120832
    v_add_f32 v176, v176, v178
    ds_read_b64_tr_b16 v[92:93], v250 offset:43264
    ds_read_b64_tr_b16 v[94:95], v250 offset:44288
    s_waitcnt vmcnt(10) lgkmcnt(11)
    v_mfma_f32_32x32x16_bf16 v[16:31], v[104:107], a[76:79], v[16:31]
    buffer_load_dwordx4 v6, s[28:31], s99 offen offset:0 lds
    ds_read_b64_tr_b16 v[96:97], v250 offset:45056
    ds_read_b64_tr_b16 v[98:99], v250 offset:46080
    s_waitcnt lgkmcnt(11)
    v_mfma_f32_32x32x16_bf16 v[32:47], v[108:111], a[76:79], v[32:47]
    v_add_f32 v177, v177, v179
    v_add_f32 v180, v180, v182
    v_add_f32 v181, v181, v183
    v_add_f32 v184, v184, v186
    ds_read_b64_tr_b16 v[100:101], v250 offset:45312
    ds_read_b64_tr_b16 v[102:103], v250 offset:46336
    s_waitcnt vmcnt(10) lgkmcnt(11)
    v_mfma_f32_32x32x16_bf16 v[16:31], v[80:83], a[80:83], v[16:31]
    buffer_load_dwordx4 v6, s[28:31], s100 offen offset:1024 lds
    ds_read_b64_tr_b16 v[104:105], v250 offset:47104
    ds_read_b64_tr_b16 v[106:107], v250 offset:48128
    s_waitcnt lgkmcnt(10)
    v_mfma_f32_32x32x16_bf16 v[32:47], v[84:87], a[80:83], v[32:47]
    s_add_u32 m0, s98, 118784
    s_add_u32 s99, s62, 229376
    s_add_u32 s100, s62, 235520
    v_add_f32 v185, v185, v187
    ds_read_b64_tr_b16 v[108:109], v250 offset:47360
    ds_read_b64_tr_b16 v[110:111], v250 offset:48384
    s_waitcnt vmcnt(10) lgkmcnt(10)
    v_mfma_f32_32x32x16_bf16 v[16:31], v[88:91], a[84:87], v[16:31]
    buffer_load_dwordx4 v6, s[28:31], s99 offen offset:0 lds
    ds_read_b64_tr_b16 v[80:81], v250 offset:49152
    ds_read_b64_tr_b16 v[82:83], v250 offset:50176
    s_waitcnt lgkmcnt(10)
    v_mfma_f32_32x32x16_bf16 v[32:47], v[92:95], a[84:87], v[32:47]
    v_add_f32 v176, v176, v180
    v_add_f32 v177, v177, v181
    v_add_f32 v184, v184, v188
    v_add_f32 v185, v185, v189
    ds_read_b64_tr_b16 v[84:85], v250 offset:49408
    ds_read_b64_tr_b16 v[86:87], v250 offset:50432
    s_waitcnt vmcnt(10) lgkmcnt(10)
    v_mfma_f32_32x32x16_bf16 v[16:31], v[96:99], a[88:91], v[16:31]
    buffer_load_dwordx4 v6, s[28:31], s100 offen offset:1024 lds
    ds_read_b64_tr_b16 v[88:89], v250 offset:51200
    ds_read_b64_tr_b16 v[90:91], v250 offset:52224
    s_waitcnt lgkmcnt(10)
    v_mfma_f32_32x32x16_bf16 v[32:47], v[100:103], a[88:91], v[32:47]
    s_add_u32 m0, s98, 120832
    s_add_u32 s99, s62, 344064
    s_add_u32 s100, s62, 350208
    v_add_f32 v176, v176, v184
    ds_read_b64_tr_b16 v[92:93], v250 offset:51456
    ds_read_b64_tr_b16 v[94:95], v250 offset:52480
    s_waitcnt vmcnt(10) lgkmcnt(10)
    v_mfma_f32_32x32x16_bf16 v[16:31], v[104:107], a[92:95], v[16:31]
    buffer_load_dwordx4 v6, s[28:31], s99 offen offset:0 lds
    ds_read_b64_tr_b16 v[96:97], v250 offset:53248
    ds_read_b64_tr_b16 v[98:99], v250 offset:54272
    s_waitcnt lgkmcnt(10)
    v_mfma_f32_32x32x16_bf16 v[32:47], v[108:111], a[92:95], v[32:47]
    v_add_f32 v177, v177, v185
    v_mov_b32 v240, v176
    v_mov_b32 v241, v177
    s_nop 0
    v_permlane32_swap_b32 v240, v176
    ds_read_b64_tr_b16 v[100:101], v250 offset:53504
    ds_read_b64_tr_b16 v[102:103], v250 offset:54528
    s_waitcnt vmcnt(10) lgkmcnt(10)
    v_mfma_f32_32x32x16_bf16 v[16:31], v[80:83], a[96:99], v[16:31]
    buffer_load_dwordx4 v6, s[28:31], s100 offen offset:1024 lds
    ds_read_b64_tr_b16 v[104:105], v250 offset:55296
    ds_read_b64_tr_b16 v[106:107], v250 offset:56320
    s_waitcnt lgkmcnt(10)
    v_mfma_f32_32x32x16_bf16 v[32:47], v[84:87], a[96:99], v[32:47]
    s_add_u32 m0, s98, 122880
    s_add_u32 s99, s62, 458752
    s_add_u32 s100, s62, 464896
    v_permlane32_swap_b32 v241, v177
    ds_read_b64_tr_b16 v[108:109], v250 offset:55552
    ds_read_b64_tr_b16 v[110:111], v250 offset:56576
    s_waitcnt vmcnt(10) lgkmcnt(10)
    v_mfma_f32_32x32x16_bf16 v[16:31], v[88:91], a[100:103], v[16:31]
    buffer_load_dwordx4 v6, s[28:31], s99 offen offset:0 lds
    ds_read_b64_tr_b16 v[80:81], v251 offset:0
    ds_read_b64_tr_b16 v[82:83], v251 offset:1024
    s_waitcnt lgkmcnt(10)
    v_mfma_f32_32x32x16_bf16 v[32:47], v[92:95], a[100:103], v[32:47]
    v_add_f32 v240, v240, v176
    v_add_f32 v241, v241, v177
    v_mul_f32 v244, s90, v240
    v_mul_f32 v242, s90, v241
    ds_read_b64_tr_b16 v[84:85], v251 offset:256
    ds_read_b64_tr_b16 v[86:87], v251 offset:1280
    s_waitcnt vmcnt(10) lgkmcnt(10)
    v_mfma_f32_32x32x16_bf16 v[16:31], v[96:99], a[104:107], v[16:31]
    buffer_load_dwordx4 v6, s[28:31], s100 offen offset:1024 lds
    ds_read_b64_tr_b16 v[88:89], v251 offset:2048
    ds_read_b64_tr_b16 v[90:91], v251 offset:3072
    s_waitcnt lgkmcnt(10)
    v_mfma_f32_32x32x16_bf16 v[32:47], v[100:103], a[104:107], v[32:47]
    v_fma_f32 v242, -v244, v244, v242
    v_max_f32 v242, 0, v242
    v_add_f32 v242, s91, v242
    ds_read_b64_tr_b16 v[92:93], v251 offset:2304
    ds_read_b64_tr_b16 v[94:95], v251 offset:3328
    s_waitcnt vmcnt(10) lgkmcnt(10)
    v_mfma_f32_32x32x16_bf16 v[16:31], v[104:107], a[108:111], v[16:31]
    v_rsq_f32 v243, v242
    s_nop 0
    v_mul_f32 v246, s92, v243
    v_mul_f32 v248, v243, v243
    ds_read_b64_tr_b16 v[96:97], v251 offset:4096
    ds_read_b64_tr_b16 v[98:99], v251 offset:5120
    s_waitcnt lgkmcnt(10)
    v_mfma_f32_32x32x16_bf16 v[32:47], v[108:111], a[108:111], v[32:47]
    ds_read_b64_tr_b16 v[100:101], v251 offset:4352
    ds_read_b64_tr_b16 v[102:103], v251 offset:5376
    s_mov_b32 exec_lo, 1
    s_mov_b32 exec_hi, 1
    buffer_store_dwordx4 v[192:195], v10, s[40:43], s72 offen offset:0 sc1
    buffer_store_dwordx4 v[196:199], v10, s[40:43], s72 offen offset:32 sc1
    buffer_store_dwordx4 v[200:203], v10, s[40:43], s72 offen offset:64 sc1
    buffer_store_dwordx4 v[204:207], v10, s[40:43], s72 offen offset:96 sc1
    s_mov_b64 exec, -1
    v_mul_f32 v248, v248, v243
    v_mul_f32 v248, s93, v248
    v_rcp_f32 v238, v243
    ds_read_b128 v[160:163], v252 offset:384
    ds_read_b128 v[164:167], v252 offset:416
    ds_read_b128 v[168:171], v252 offset:448
    ds_read_b128 v[172:175], v252 offset:480
    s_barrier
    s_waitcnt lgkmcnt(0)
    s_branch L_w3p1_31_2
L_w3p1_31_0:
    s_waitcnt vmcnt(7) lgkmcnt(10)
    v_mfma_f32_32x32x16_bf16 v[16:31], v[80:83], a[0:3], 0
    s_add_u32 s74, s74, 12288
    buffer_load_dwordx4 a[32:35], v2, s[40:43], s74 offen offset:0 sc1
    ds_read_b64_tr_b16 v[104:105], v250 offset:6144
    ds_read_b64_tr_b16 v[106:107], v250 offset:7168
    s_waitcnt lgkmcnt(10)
    v_mfma_f32_32x32x16_bf16 v[32:47], v[84:87], a[0:3], 0
    s_lshl_b32 s77, s79, 14
    s_add_u32 s77, s77, s78
    s_lshr_b32 s72, s77, 8
    s_xor_b32 s72, s72, s69
    s_and_b32 s72, s72, 0x2000
    s_or_b32 s77, s77, s72
    v_lshrrev_b32_e64 v190, 5, v1
    v_mul_u32_u24 v190, 1536, v190
    v_lshl_add_u32 v190, v1, 3, v190
    buffer_load_dwordx2 v[176:177], v190, s[40:43], s77 offen offset:0 sc1
    ds_read_b64_tr_b16 v[108:109], v250 offset:6400
    ds_read_b64_tr_b16 v[110:111], v250 offset:7424
    s_waitcnt vmcnt(8) lgkmcnt(10)
    v_mfma_f32_32x32x16_bf16 v[16:31], v[88:91], a[4:7], v[16:31]
    buffer_load_dwordx4 a[36:39], v2, s[40:43], s74 offen offset:1024 sc1
    ds_read_b64_tr_b16 v[80:81], v250 offset:8192
    ds_read_b64_tr_b16 v[82:83], v250 offset:9216
    s_waitcnt lgkmcnt(10)
    v_mfma_f32_32x32x16_bf16 v[32:47], v[92:95], a[4:7], v[32:47]
    buffer_load_dwordx2 v[178:179], v190, s[40:43], s77 offen offset:256 sc1
    ds_read_b64_tr_b16 v[84:85], v250 offset:8448
    ds_read_b64_tr_b16 v[86:87], v250 offset:9472
    s_waitcnt vmcnt(9) lgkmcnt(10)
    v_mfma_f32_32x32x16_bf16 v[16:31], v[96:99], a[8:11], v[16:31]
    buffer_load_dwordx4 a[40:43], v2, s[40:43], s74 offen offset:2048 sc1
    ds_read_b64_tr_b16 v[88:89], v250 offset:10240
    ds_read_b64_tr_b16 v[90:91], v250 offset:11264
    s_waitcnt lgkmcnt(10)
    v_mfma_f32_32x32x16_bf16 v[32:47], v[100:103], a[8:11], v[32:47]
    buffer_load_dwordx2 v[180:181], v190, s[40:43], s77 offen offset:512 sc1
    ds_read_b64_tr_b16 v[92:93], v250 offset:10496
    ds_read_b64_tr_b16 v[94:95], v250 offset:11520
    s_waitcnt vmcnt(10) lgkmcnt(10)
    v_mfma_f32_32x32x16_bf16 v[16:31], v[104:107], a[12:15], v[16:31]
    buffer_load_dwordx4 a[44:47], v2, s[40:43], s74 offen offset:3072 sc1
    ds_read_b64_tr_b16 v[96:97], v250 offset:12288
    ds_read_b64_tr_b16 v[98:99], v250 offset:13312
    s_waitcnt lgkmcnt(10)
    v_mfma_f32_32x32x16_bf16 v[32:47], v[108:111], a[12:15], v[32:47]
    buffer_load_dwordx2 v[182:183], v190, s[40:43], s77 offen offset:768 sc1
    ds_read_b64_tr_b16 v[100:101], v250 offset:12544
    ds_read_b64_tr_b16 v[102:103], v250 offset:13568
    s_waitcnt vmcnt(11) lgkmcnt(10)
    v_mfma_f32_32x32x16_bf16 v[16:31], v[80:83], a[16:19], v[16:31]
    s_add_u32 s74, s74, 4096
    buffer_load_dwordx4 a[48:51], v2, s[40:43], s74 offen offset:0 sc1
    ds_read_b64_tr_b16 v[104:105], v250 offset:14336
    ds_read_b64_tr_b16 v[106:107], v250 offset:15360
    s_waitcnt lgkmcnt(10)
    v_mfma_f32_32x32x16_bf16 v[32:47], v[84:87], a[16:19], v[32:47]
    buffer_load_dwordx2 v[184:185], v190, s[40:43], s77 offen offset:1024 sc1
    ds_read_b64_tr_b16 v[108:109], v250 offset:14592
    ds_read_b64_tr_b16 v[110:111], v250 offset:15616
    s_waitcnt vmcnt(12) lgkmcnt(10)
    v_mfma_f32_32x32x16_bf16 v[16:31], v[88:91], a[20:23], v[16:31]
    buffer_load_dwordx4 a[52:55], v2, s[40:43], s74 offen offset:1024 sc1
    ds_read_b64_tr_b16 v[80:81], v250 offset:16384
    ds_read_b64_tr_b16 v[82:83], v250 offset:17408
    s_waitcnt lgkmcnt(10)
    v_mfma_f32_32x32x16_bf16 v[32:47], v[92:95], a[20:23], v[32:47]
    buffer_load_dwordx2 v[186:187], v190, s[40:43], s77 offen offset:1280 sc1
    ds_read_b64_tr_b16 v[84:85], v250 offset:16640
    ds_read_b64_tr_b16 v[86:87], v250 offset:17664
    s_waitcnt vmcnt(13) lgkmcnt(10)
    v_mfma_f32_32x32x16_bf16 v[16:31], v[96:99], a[24:27], v[16:31]
    buffer_load_dwordx4 a[56:59], v2, s[40:43], s74 offen offset:2048 sc1
    ds_read_b64_tr_b16 v[88:89], v250 offset:18432
    ds_read_b64_tr_b16 v[90:91], v250 offset:19456
    s_waitcnt lgkmcnt(10)
    v_mfma_f32_32x32x16_bf16 v[32:47], v[100:103], a[24:27], v[32:47]
    buffer_load_dwordx2 v[188:189], v190, s[40:43], s77 offen offset:1536 sc1
    ds_read_b64_tr_b16 v[92:93], v250 offset:18688
    ds_read_b64_tr_b16 v[94:95], v250 offset:19712
    s_waitcnt vmcnt(14) lgkmcnt(10)
    v_mfma_f32_32x32x16_bf16 v[16:31], v[104:107], a[28:31], v[16:31]
    buffer_load_dwordx4 a[60:63], v2, s[40:43], s74 offen offset:3072 sc1
    ds_read_b64_tr_b16 v[96:97], v250 offset:20480
    ds_read_b64_tr_b16 v[98:99], v250 offset:21504
    s_waitcnt lgkmcnt(10)
    v_mfma_f32_32x32x16_bf16 v[32:47], v[108:111], a[28:31], v[32:47]
    ds_read_b64_tr_b16 v[100:101], v250 offset:20736
    ds_read_b64_tr_b16 v[102:103], v250 offset:21760
    s_waitcnt vmcnt(14) lgkmcnt(10)
    v_mfma_f32_32x32x16_bf16 v[16:31], v[80:83], a[32:35], v[16:31]
    s_add_u32 s74, s74, 12288
    buffer_load_dwordx4 a[64:67], v2, s[40:43], s74 offen offset:0 sc1
    ds_read_b64_tr_b16 v[104:105], v250 offset:22528
    ds_read_b64_tr_b16 v[106:107], v250 offset:23552
    s_waitcnt lgkmcnt(10)
    v_mfma_f32_32x32x16_bf16 v[32:47], v[84:87], a[32:35], v[32:47]
    ds_read_b64_tr_b16 v[108:109], v250 offset:22784
    ds_read_b64_tr_b16 v[110:111], v250 offset:23808
    s_waitcnt vmcnt(13) lgkmcnt(10)
    v_mfma_f32_32x32x16_bf16 v[16:31], v[88:91], a[36:39], v[16:31]
    buffer_load_dwordx4 a[68:71], v2, s[40:43], s74 offen offset:1024 sc1
    ds_read_b64_tr_b16 v[80:81], v250 offset:24576
    ds_read_b64_tr_b16 v[82:83], v250 offset:25600
    s_waitcnt lgkmcnt(10)
    v_mfma_f32_32x32x16_bf16 v[32:47], v[92:95], a[36:39], v[32:47]
    ds_read_b64_tr_b16 v[84:85], v250 offset:24832
    ds_read_b64_tr_b16 v[86:87], v250 offset:25856
    s_waitcnt vmcnt(12) lgkmcnt(10)
    v_mfma_f32_32x32x16_bf16 v[16:31], v[96:99], a[40:43], v[16:31]
    buffer_load_dwordx4 a[72:75], v2, s[40:43], s74 offen offset:2048 sc1
    ds_read_b64_tr_b16 v[88:89], v250 offset:26624
    ds_read_b64_tr_b16 v[90:91], v250 offset:27648
    s_waitcnt lgkmcnt(10)
    v_mfma_f32_32x32x16_bf16 v[32:47], v[100:103], a[40:43], v[32:47]
    ds_read_b64_tr_b16 v[92:93], v250 offset:26880
    ds_read_b64_tr_b16 v[94:95], v250 offset:27904
    s_waitcnt vmcnt(11) lgkmcnt(10)
    v_mfma_f32_32x32x16_bf16 v[16:31], v[104:107], a[44:47], v[16:31]
    buffer_load_dwordx4 a[76:79], v2, s[40:43], s74 offen offset:3072 sc1
    ds_read_b64_tr_b16 v[96:97], v250 offset:28672
    ds_read_b64_tr_b16 v[98:99], v250 offset:29696
    s_waitcnt lgkmcnt(10)
    v_mfma_f32_32x32x16_bf16 v[32:47], v[108:111], a[44:47], v[32:47]
    ds_read_b64_tr_b16 v[100:101], v250 offset:28928
    ds_read_b64_tr_b16 v[102:103], v250 offset:29952
    s_waitcnt vmcnt(10) lgkmcnt(10)
    v_mfma_f32_32x32x16_bf16 v[16:31], v[80:83], a[48:51], v[16:31]
    s_add_u32 s74, s74, 4096
    buffer_load_dwordx4 a[80:83], v2, s[40:43], s74 offen offset:0 sc1
    ds_read_b64_tr_b16 v[104:105], v250 offset:30720
    ds_read_b64_tr_b16 v[106:107], v250 offset:31744
    s_waitcnt lgkmcnt(10)
    v_mfma_f32_32x32x16_bf16 v[32:47], v[84:87], a[48:51], v[32:47]
    ds_read_b64_tr_b16 v[108:109], v250 offset:30976
    ds_read_b64_tr_b16 v[110:111], v250 offset:32000
    s_waitcnt vmcnt(9) lgkmcnt(10)
    v_mfma_f32_32x32x16_bf16 v[16:31], v[88:91], a[52:55], v[16:31]
    buffer_load_dwordx4 a[84:87], v2, s[40:43], s74 offen offset:1024 sc1
    ds_read_b64_tr_b16 v[80:81], v250 offset:32768
    ds_read_b64_tr_b16 v[82:83], v250 offset:33792
    s_waitcnt lgkmcnt(10)
    v_mfma_f32_32x32x16_bf16 v[32:47], v[92:95], a[52:55], v[32:47]
    ds_read_b64_tr_b16 v[84:85], v250 offset:33024
    ds_read_b64_tr_b16 v[86:87], v250 offset:34048
    s_waitcnt vmcnt(8) lgkmcnt(10)
    v_mfma_f32_32x32x16_bf16 v[16:31], v[96:99], a[56:59], v[16:31]
    buffer_load_dwordx4 a[88:91], v2, s[40:43], s74 offen offset:2048 sc1
    ds_read_b64_tr_b16 v[88:89], v250 offset:34816
    ds_read_b64_tr_b16 v[90:91], v250 offset:35840
    s_waitcnt lgkmcnt(10)
    v_mfma_f32_32x32x16_bf16 v[32:47], v[100:103], a[56:59], v[32:47]
    ds_read_b64_tr_b16 v[92:93], v250 offset:35072
    ds_read_b64_tr_b16 v[94:95], v250 offset:36096
    s_waitcnt vmcnt(7) lgkmcnt(10)
    v_mfma_f32_32x32x16_bf16 v[16:31], v[104:107], a[60:63], v[16:31]
    buffer_load_dwordx4 a[92:95], v2, s[40:43], s74 offen offset:3072 sc1
    ds_read_b64_tr_b16 v[96:97], v250 offset:36864
    ds_read_b64_tr_b16 v[98:99], v250 offset:37888
    s_waitcnt lgkmcnt(10)
    v_mfma_f32_32x32x16_bf16 v[32:47], v[108:111], a[60:63], v[32:47]
    ds_read_b128 v[112:115], v252 offset:0
    ds_read_b64_tr_b16 v[100:101], v250 offset:37120
    ds_read_b64_tr_b16 v[102:103], v250 offset:38144
    s_waitcnt vmcnt(7) lgkmcnt(11)
    v_mfma_f32_32x32x16_bf16 v[16:31], v[80:83], a[64:67], v[16:31]
    s_add_u32 s74, s74, 12288
    buffer_load_dwordx4 a[96:99], v2, s[40:43], s74 offen offset:0 sc1
    ds_read_b64_tr_b16 v[104:105], v250 offset:38912
    ds_read_b64_tr_b16 v[106:107], v250 offset:39936
    s_waitcnt lgkmcnt(11)
    v_mfma_f32_32x32x16_bf16 v[32:47], v[84:87], a[64:67], v[32:47]
    ds_read_b128 v[116:119], v252 offset:32
    ds_read_b64_tr_b16 v[108:109], v250 offset:39168
    ds_read_b64_tr_b16 v[110:111], v250 offset:40192
    s_waitcnt vmcnt(7) lgkmcnt(12)
    v_mfma_f32_32x32x16_bf16 v[16:31], v[88:91], a[68:71], v[16:31]
    buffer_load_dwordx4 a[100:103], v2, s[40:43], s74 offen offset:1024 sc1
    ds_read_b64_tr_b16 v[80:81], v250 offset:40960
    ds_read_b64_tr_b16 v[82:83], v250 offset:41984
    s_waitcnt lgkmcnt(12)
    v_mfma_f32_32x32x16_bf16 v[32:47], v[92:95], a[68:71], v[32:47]
    ds_read_b128 v[120:123], v252 offset:64
    ds_read_b64_tr_b16 v[84:85], v250 offset:41216
    ds_read_b64_tr_b16 v[86:87], v250 offset:42240
    s_waitcnt vmcnt(7) lgkmcnt(13)
    v_mfma_f32_32x32x16_bf16 v[16:31], v[96:99], a[72:75], v[16:31]
    buffer_load_dwordx4 a[104:107], v2, s[40:43], s74 offen offset:2048 sc1
    ds_read_b64_tr_b16 v[88:89], v250 offset:43008
    ds_read_b64_tr_b16 v[90:91], v250 offset:44032
    s_waitcnt lgkmcnt(12)
    v_mfma_f32_32x32x16_bf16 v[32:47], v[100:103], a[72:75], v[32:47]
    v_add_f32 v176, v176, v178
    v_add_f32 v177, v177, v179
    v_add_f32 v180, v180, v182
    v_add_f32 v181, v181, v183
    ds_read_b64_tr_b16 v[92:93], v250 offset:43264
    ds_read_b64_tr_b16 v[94:95], v250 offset:44288
    s_waitcnt vmcnt(7) lgkmcnt(12)
    v_mfma_f32_32x32x16_bf16 v[16:31], v[104:107], a[76:79], v[16:31]
    buffer_load_dwordx4 a[108:111], v2, s[40:43], s74 offen offset:3072 sc1
    ds_read_b64_tr_b16 v[96:97], v250 offset:45056
    ds_read_b64_tr_b16 v[98:99], v250 offset:46080
    s_waitcnt lgkmcnt(11)
    v_mfma_f32_32x32x16_bf16 v[32:47], v[108:111], a[76:79], v[32:47]
    v_add_f32 v184, v184, v186
    v_add_f32 v185, v185, v187
    v_add_f32 v176, v176, v180
    v_add_f32 v177, v177, v181
    ds_read_b64_tr_b16 v[100:101], v250 offset:45312
    ds_read_b64_tr_b16 v[102:103], v250 offset:46336
    s_waitcnt vmcnt(7) lgkmcnt(11)
    v_mfma_f32_32x32x16_bf16 v[16:31], v[80:83], a[80:83], v[16:31]
    s_mul_i32 s98, s44, 10240
    s_add_u32 m0, s98, 114688
    s_add_u32 s99, s62, 1146880
    s_add_u32 s100, s62, 1153024
    ds_read_b64_tr_b16 v[104:105], v250 offset:47104
    ds_read_b64_tr_b16 v[106:107], v250 offset:48128
    s_waitcnt lgkmcnt(10)
    v_mfma_f32_32x32x16_bf16 v[32:47], v[84:87], a[80:83], v[32:47]
    buffer_load_dwordx4 v6, s[28:31], s99 offen offset:0 lds
    ds_read_b64_tr_b16 v[108:109], v250 offset:47360
    ds_read_b64_tr_b16 v[110:111], v250 offset:48384
    s_waitcnt vmcnt(7) lgkmcnt(10)
    v_mfma_f32_32x32x16_bf16 v[16:31], v[88:91], a[84:87], v[16:31]
    v_add_f32 v184, v184, v188
    v_add_f32 v185, v185, v189
    v_add_f32 v176, v176, v184
    v_add_f32 v177, v177, v185
    ds_read_b64_tr_b16 v[80:81], v250 offset:49152
    ds_read_b64_tr_b16 v[82:83], v250 offset:50176
    s_waitcnt lgkmcnt(10)
    v_mfma_f32_32x32x16_bf16 v[32:47], v[92:95], a[84:87], v[32:47]
    buffer_load_dwordx4 v6, s[28:31], s100 offen offset:1024 lds
    ds_read_b64_tr_b16 v[84:85], v250 offset:49408
    ds_read_b64_tr_b16 v[86:87], v250 offset:50432
    s_waitcnt vmcnt(7) lgkmcnt(10)
    v_mfma_f32_32x32x16_bf16 v[16:31], v[96:99], a[88:91], v[16:31]
    s_add_u32 m0, s98, 116736
    s_add_u32 s99, s62, 1261568
    s_add_u32 s100, s62, 1267712
    v_mov_b32 v240, v176
    ds_read_b64_tr_b16 v[88:89], v250 offset:51200
    ds_read_b64_tr_b16 v[90:91], v250 offset:52224
    s_waitcnt lgkmcnt(10)
    v_mfma_f32_32x32x16_bf16 v[32:47], v[100:103], a[88:91], v[32:47]
    buffer_load_dwordx4 v6, s[28:31], s99 offen offset:0 lds
    ds_read_b64_tr_b16 v[92:93], v250 offset:51456
    ds_read_b64_tr_b16 v[94:95], v250 offset:52480
    s_waitcnt vmcnt(7) lgkmcnt(10)
    v_mfma_f32_32x32x16_bf16 v[16:31], v[104:107], a[92:95], v[16:31]
    v_mov_b32 v241, v177
    v_permlane32_swap_b32 v240, v176
    s_nop 0
    v_permlane32_swap_b32 v241, v177
    v_add_f32 v240, v240, v176
    ds_read_b64_tr_b16 v[96:97], v250 offset:53248
    ds_read_b64_tr_b16 v[98:99], v250 offset:54272
    s_waitcnt lgkmcnt(10)
    v_mfma_f32_32x32x16_bf16 v[32:47], v[108:111], a[92:95], v[32:47]
    buffer_load_dwordx4 v6, s[28:31], s100 offen offset:1024 lds
    ds_read_b64_tr_b16 v[100:101], v250 offset:53504
    ds_read_b64_tr_b16 v[102:103], v250 offset:54528
    s_waitcnt vmcnt(7) lgkmcnt(10)
    v_mfma_f32_32x32x16_bf16 v[16:31], v[80:83], a[96:99], v[16:31]
    s_add_u32 m0, s98, 118784
    s_add_u32 s99, s62, 1376256
    s_add_u32 s100, s62, 1382400
    v_add_f32 v241, v241, v177
    ds_read_b64_tr_b16 v[104:105], v250 offset:55296
    ds_read_b64_tr_b16 v[106:107], v250 offset:56320
    s_waitcnt lgkmcnt(10)
    v_mfma_f32_32x32x16_bf16 v[32:47], v[84:87], a[96:99], v[32:47]
    buffer_load_dwordx4 v6, s[28:31], s99 offen offset:0 lds
    ds_read_b64_tr_b16 v[108:109], v250 offset:55552
    ds_read_b64_tr_b16 v[110:111], v250 offset:56576
    s_waitcnt vmcnt(7) lgkmcnt(10)
    v_mfma_f32_32x32x16_bf16 v[16:31], v[88:91], a[100:103], v[16:31]
    v_mul_f32 v244, s90, v240
    v_mul_f32 v242, s90, v241
    v_fma_f32 v242, -v244, v244, v242
    v_max_f32 v242, 0, v242
    ds_read_b64_tr_b16 v[80:81], v251 offset:0
    ds_read_b64_tr_b16 v[82:83], v251 offset:1024
    s_waitcnt lgkmcnt(10)
    v_mfma_f32_32x32x16_bf16 v[32:47], v[92:95], a[100:103], v[32:47]
    buffer_load_dwordx4 v6, s[28:31], s100 offen offset:1024 lds
    ds_read_b64_tr_b16 v[84:85], v251 offset:256
    ds_read_b64_tr_b16 v[86:87], v251 offset:1280
    s_waitcnt vmcnt(7) lgkmcnt(10)
    v_mfma_f32_32x32x16_bf16 v[16:31], v[96:99], a[104:107], v[16:31]
    s_add_u32 m0, s98, 120832
    s_add_u32 s99, s62, 1490944
    s_add_u32 s100, s62, 1497088
    v_add_f32 v242, s91, v242
    ds_read_b64_tr_b16 v[88:89], v251 offset:2048
    ds_read_b64_tr_b16 v[90:91], v251 offset:3072
    s_waitcnt lgkmcnt(10)
    v_mfma_f32_32x32x16_bf16 v[32:47], v[100:103], a[104:107], v[32:47]
    buffer_load_dwordx4 v6, s[28:31], s99 offen offset:0 lds
    ds_read_b64_tr_b16 v[92:93], v251 offset:2304
    ds_read_b64_tr_b16 v[94:95], v251 offset:3328
    s_waitcnt vmcnt(7) lgkmcnt(10)
    v_mfma_f32_32x32x16_bf16 v[16:31], v[104:107], a[108:111], v[16:31]
    v_rsq_f32 v243, v242
    s_nop 0
    v_mul_f32 v246, s92, v243
    v_mul_f32 v248, v243, v243
    ds_read_b64_tr_b16 v[96:97], v251 offset:4096
    ds_read_b64_tr_b16 v[98:99], v251 offset:5120
    s_waitcnt lgkmcnt(10)
    v_mfma_f32_32x32x16_bf16 v[32:47], v[108:111], a[108:111], v[32:47]
    buffer_load_dwordx4 v6, s[28:31], s100 offen offset:1024 lds
    ds_read_b64_tr_b16 v[100:101], v251 offset:4352
    ds_read_b64_tr_b16 v[102:103], v251 offset:5376
    s_add_u32 m0, s98, 122880
    s_add_u32 s99, s62, 57344
    s_add_u32 s100, s62, 63488
    buffer_load_dwordx4 v6, s[28:31], s99 offen offset:0 lds
    buffer_load_dwordx4 v6, s[28:31], s100 offen offset:1024 lds
    v_mul_f32 v248, v248, v243
    v_mul_f32 v248, s93, v248
    v_rcp_f32 v238, v243
    ds_read_b128 v[124:127], v252 offset:96
    ds_read_b128 v[128:131], v252 offset:128
    ds_read_b128 v[132:135], v252 offset:160
    ds_read_b128 v[136:139], v252 offset:192
    ds_read_b128 v[140:143], v252 offset:224
    ds_read_b128 v[144:147], v252 offset:256
    ds_read_b128 v[148:151], v252 offset:288
    ds_read_b128 v[152:155], v252 offset:320
    ds_read_b128 v[156:159], v252 offset:352
    ds_read_b128 v[160:163], v252 offset:384
    ds_read_b128 v[164:167], v252 offset:416
    ds_read_b128 v[168:171], v252 offset:448
    ds_read_b128 v[172:175], v252 offset:480
    s_barrier
    s_waitcnt lgkmcnt(0)
L_w3p1_31_2:
    v_pk_fma_f32 v[16:17], v[244:245], v[112:113], v[16:17] op_sel_hi:[0,1,1] neg_lo:[1,0,0] neg_hi:[1,0,0]
    s_mul_i32 s98, s44, 14336
    s_add_u32 m0, s98, 57344
    s_add_u32 s99, s62, 172032
    s_add_u32 s100, s62, 178176
    buffer_load_dwordx4 v6, s[28:31], s99 offen offset:0 lds
    buffer_load_dwordx4 v6, s[28:31], s100 offen offset:1024 lds
    v_pk_fma_f32 v[18:19], v[244:245], v[114:115], v[18:19] op_sel_hi:[0,1,1] neg_lo:[1,0,0] neg_hi:[1,0,0]
    v_pk_fma_f32 v[20:21], v[244:245], v[116:117], v[20:21] op_sel_hi:[0,1,1] neg_lo:[1,0,0] neg_hi:[1,0,0]
    v_pk_fma_f32 v[22:23], v[244:245], v[118:119], v[22:23] op_sel_hi:[0,1,1] neg_lo:[1,0,0] neg_hi:[1,0,0]
    v_pk_mul_f32 v[176:177], v[16:17], v[16:17]
    v_pk_mul_f32 v[178:179], v[18:19], v[18:19]
    v_pk_mul_f32 v[180:181], v[20:21], v[20:21]
    v_pk_mul_f32 v[182:183], v[22:23], v[22:23]
    v_pk_fma_f32 v[176:177], v[176:177], v[248:249], v[246:247] op_sel_hi:[1,0,0]
    v_pk_fma_f32 v[178:179], v[178:179], v[248:249], v[246:247] op_sel_hi:[1,0,0]
    v_pk_fma_f32 v[180:181], v[180:181], v[248:249], v[246:247] op_sel_hi:[1,0,0]
    v_pk_fma_f32 v[182:183], v[182:183], v[248:249], v[246:247] op_sel_hi:[1,0,0]
    v_pk_mul_f32 v[176:177], v[176:177], v[16:17]
    v_pk_mul_f32 v[178:179], v[178:179], v[18:19]
    v_pk_mul_f32 v[180:181], v[180:181], v[20:21]
    v_pk_mul_f32 v[182:183], v[182:183], v[22:23]
    v_pk_fma_f32 v[24:25], v[244:245], v[120:121], v[24:25] op_sel_hi:[0,1,1] neg_lo:[1,0,0] neg_hi:[1,0,0]
    v_pk_fma_f32 v[26:27], v[244:245], v[122:123], v[26:27] op_sel_hi:[0,1,1] neg_lo:[1,0,0] neg_hi:[1,0,0]
    v_pk_fma_f32 v[28:29], v[244:245], v[124:125], v[28:29] op_sel_hi:[0,1,1] neg_lo:[1,0,0] neg_hi:[1,0,0]
    v_pk_fma_f32 v[30:31], v[244:245], v[126:127], v[30:31] op_sel_hi:[0,1,1] neg_lo:[1,0,0] neg_hi:[1,0,0]
    v_pk_mul_f32 v[184:185], v[24:25], v[24:25]
    v_pk_mul_f32 v[186:187], v[26:27], v[26:27]
    v_pk_mul_f32 v[188:189], v[28:29], v[28:29]
    v_pk_mul_f32 v[190:191], v[30:31], v[30:31]
    v_pk_fma_f32 v[184:185], v[184:185], v[248:249], v[246:247] op_sel_hi:[1,0,0]
    v_pk_fma_f32 v[186:187], v[186:187], v[248:249], v[246:247] op_sel_hi:[1,0,0]
    v_pk_fma_f32 v[188:189], v[188:189], v[248:249], v[246:247] op_sel_hi:[1,0,0]
    v_pk_fma_f32 v[190:191], v[190:191], v[248:249], v[246:247] op_sel_hi:[1,0,0]
    v_pk_mul_f32 v[184:185], v[184:185], v[24:25]
    v_pk_mul_f32 v[186:187], v[186:187], v[26:27]
    v_pk_mul_f32 v[188:189], v[188:189], v[28:29]
    v_pk_mul_f32 v[190:191], v[190:191], v[30:31]
    v_exp_f32 v176, v176
    v_exp_f32 v177, v177
    v_exp_f32 v178, v178
    v_exp_f32 v179, v179
    v_pk_fma_f32 v[176:177], v[176:177], v[238:239], v[238:239] op_sel_hi:[1,0,0]
    v_pk_fma_f32 v[178:179], v[178:179], v[238:239], v[238:239] op_sel_hi:[1,0,0]
    v_rcp_f32 v176, v176
    v_rcp_f32 v177, v177
    v_rcp_f32 v178, v178
    v_rcp_f32 v179, v179
    v_pk_mul_f32 v[16:17], v[16:17], v[176:177]
    v_pk_mul_f32 v[18:19], v[18:19], v[178:179]
    v_exp_f32 v180, v180
    v_exp_f32 v181, v181
    v_exp_f32 v182, v182
    v_exp_f32 v183, v183
    v_pk_fma_f32 v[180:181], v[180:181], v[238:239], v[238:239] op_sel_hi:[1,0,0]
    v_pk_fma_f32 v[182:183], v[182:183], v[238:239], v[238:239] op_sel_hi:[1,0,0]
    v_rcp_f32 v180, v180
    s_add_u32 m0, s98, 59392
    s_add_u32 s99, s62, 286720
    s_add_u32 s100, s62, 292864
    buffer_load_dwordx4 v6, s[28:31], s99 offen offset:0 lds
    buffer_load_dwordx4 v6, s[28:31], s100 offen offset:1024 lds
    v_rcp_f32 v181, v181
    v_rcp_f32 v182, v182
    v_rcp_f32 v183, v183
    v_pk_mul_f32 v[20:21], v[20:21], v[180:181]
    v_pk_mul_f32 v[22:23], v[22:23], v[182:183]
    v_exp_f32 v184, v184
    v_exp_f32 v185, v185
    v_exp_f32 v186, v186
    v_exp_f32 v187, v187
    v_pk_fma_f32 v[184:185], v[184:185], v[238:239], v[238:239] op_sel_hi:[1,0,0]
    v_pk_fma_f32 v[186:187], v[186:187], v[238:239], v[238:239] op_sel_hi:[1,0,0]
    v_rcp_f32 v184, v184
    v_rcp_f32 v185, v185
    v_rcp_f32 v186, v186
    v_rcp_f32 v187, v187
    v_pk_mul_f32 v[24:25], v[24:25], v[184:185]
    v_pk_mul_f32 v[26:27], v[26:27], v[186:187]
    v_exp_f32 v188, v188
    v_exp_f32 v189, v189
    v_exp_f32 v190, v190
    v_exp_f32 v191, v191
    v_pk_fma_f32 v[188:189], v[188:189], v[238:239], v[238:239] op_sel_hi:[1,0,0]
    v_pk_fma_f32 v[190:191], v[190:191], v[238:239], v[238:239] op_sel_hi:[1,0,0]
    v_rcp_f32 v188, v188
    v_rcp_f32 v189, v189
    v_rcp_f32 v190, v190
    v_rcp_f32 v191, v191
    v_pk_mul_f32 v[28:29], v[28:29], v[188:189]
    v_pk_mul_f32 v[30:31], v[30:31], v[190:191]
    v_cvt_pk_bf16_f32 v208, v16, v17
    v_cvt_pk_bf16_f32 v209, v18, v19
    v_cvt_pk_bf16_f32 v210, v20, v21
    v_cvt_pk_bf16_f32 v211, v22, v23
    buffer_store_dwordx4 v[208:211], v2, s[40:43], s76 offen offset:0 sc1
    v_cvt_pk_bf16_f32 v212, v24, v25
    v_cvt_pk_bf16_f32 v213, v26, v27
    v_cvt_pk_bf16_f32 v214, v28, v29
    v_cvt_pk_bf16_f32 v215, v30, v31
    buffer_store_dwordx4 v[212:215], v2, s[40:43], s76 offen offset:1024 sc1
    v_pk_fma_f32 v[32:33], v[244:245], v[128:129], v[32:33] op_sel_hi:[0,1,1] neg_lo:[1,0,0] neg_hi:[1,0,0]
    v_pk_fma_f32 v[34:35], v[244:245], v[130:131], v[34:35] op_sel_hi:[0,1,1] neg_lo:[1,0,0] neg_hi:[1,0,0]
    v_pk_fma_f32 v[36:37], v[244:245], v[132:133], v[36:37] op_sel_hi:[0,1,1] neg_lo:[1,0,0] neg_hi:[1,0,0]
    v_pk_fma_f32 v[38:39], v[244:245], v[134:135], v[38:39] op_sel_hi:[0,1,1] neg_lo:[1,0,0] neg_hi:[1,0,0]
    v_pk_mul_f32 v[192:193], v[32:33], v[32:33]
    v_pk_mul_f32 v[194:195], v[34:35], v[34:35]
    v_pk_mul_f32 v[196:197], v[36:37], v[36:37]
    v_pk_mul_f32 v[198:199], v[38:39], v[38:39]
    v_pk_fma_f32 v[192:193], v[192:193], v[248:249], v[246:247] op_sel_hi:[1,0,0]
    v_pk_fma_f32 v[194:195], v[194:195], v[248:249], v[246:247] op_sel_hi:[1,0,0]
    v_pk_fma_f32 v[196:197], v[196:197], v[248:249], v[246:247] op_sel_hi:[1,0,0]
    v_pk_fma_f32 v[198:199], v[198:199], v[248:249], v[246:247] op_sel_hi:[1,0,0]
    v_pk_mul_f32 v[192:193], v[192:193], v[32:33]
    v_pk_mul_f32 v[194:195], v[194:195], v[34:35]
    v_pk_mul_f32 v[196:197], v[196:197], v[36:37]
    v_pk_mul_f32 v[198:199], v[198:199], v[38:39]
    v_pk_fma_f32 v[40:41], v[244:245], v[136:137], v[40:41] op_sel_hi:[0,1,1] neg_lo:[1,0,0] neg_hi:[1,0,0]
    v_pk_fma_f32 v[42:43], v[244:245], v[138:139], v[42:43] op_sel_hi:[0,1,1] neg_lo:[1,0,0] neg_hi:[1,0,0]
    v_pk_fma_f32 v[44:45], v[244:245], v[140:141], v[44:45] op_sel_hi:[0,1,1] neg_lo:[1,0,0] neg_hi:[1,0,0]
    v_pk_fma_f32 v[46:47], v[244:245], v[142:143], v[46:47] op_sel_hi:[0,1,1] neg_lo:[1,0,0] neg_hi:[1,0,0]
    v_pk_mul_f32 v[200:201], v[40:41], v[40:41]
    v_pk_mul_f32 v[202:203], v[42:43], v[42:43]
    v_pk_mul_f32 v[204:205], v[44:45], v[44:45]
    v_pk_mul_f32 v[206:207], v[46:47], v[46:47]
    v_pk_fma_f32 v[200:201], v[200:201], v[248:249], v[246:247] op_sel_hi:[1,0,0]
    v_pk_fma_f32 v[202:203], v[202:203], v[248:249], v[246:247] op_sel_hi:[1,0,0]
    v_pk_fma_f32 v[204:205], v[204:205], v[248:249], v[246:247] op_sel_hi:[1,0,0]
    v_pk_fma_f32 v[206:207], v[206:207], v[248:249], v[246:247] op_sel_hi:[1,0,0]
    v_pk_mul_f32 v[200:201], v[200:201], v[40:41]
    v_pk_mul_f32 v[202:203], v[202:203], v[42:43]
    v_pk_mul_f32 v[204:205], v[204:205], v[44:45]
    v_pk_mul_f32 v[206:207], v[206:207], v[46:47]
    v_exp_f32 v192, v192
    v_exp_f32 v193, v193
    v_exp_f32 v194, v194
    v_exp_f32 v195, v195
    v_pk_fma_f32 v[192:193], v[192:193], v[238:239], v[238:239] op_sel_hi:[1,0,0]
    v_pk_fma_f32 v[194:195], v[194:195], v[238:239], v[238:239] op_sel_hi:[1,0,0]
    v_rcp_f32 v192, v192
    v_rcp_f32 v193, v193
    v_rcp_f32 v194, v194
    v_rcp_f32 v195, v195
    v_pk_mul_f32 v[32:33], v[32:33], v[192:193]
    v_pk_mul_f32 v[34:35], v[34:35], v[194:195]
    v_exp_f32 v196, v196
    v_exp_f32 v197, v197
    v_exp_f32 v198, v198
    v_exp_f32 v199, v199
    v_pk_fma_f32 v[196:197], v[196:197], v[238:239], v[238:239] op_sel_hi:[1,0,0]
    v_pk_fma_f32 v[198:199], v[198:199], v[238:239], v[238:239] op_sel_hi:[1,0,0]
    v_rcp_f32 v196, v196
    v_rcp_f32 v197, v197
    v_rcp_f32 v198, v198
    v_rcp_f32 v199, v199
    v_pk_mul_f32 v[36:37], v[36:37], v[196:197]
    v_pk_mul_f32 v[38:39], v[38:39], v[198:199]
    v_exp_f32 v200, v200
    v_exp_f32 v201, v201
    v_exp_f32 v202, v202
    v_exp_f32 v203, v203
    v_pk_fma_f32 v[200:201], v[200:201], v[238:239], v[238:239] op_sel_hi:[1,0,0]
    v_pk_fma_f32 v[202:203], v[202:203], v[238:239], v[238:239] op_sel_hi:[1,0,0]
    v_rcp_f32 v200, v200
    v_rcp_f32 v201, v201
    v_rcp_f32 v202, v202
    v_rcp_f32 v203, v203
    v_pk_mul_f32 v[40:41], v[40:41], v[200:201]
    v_pk_mul_f32 v[42:43], v[42:43], v[202:203]
    v_exp_f32 v204, v204
    v_exp_f32 v205, v205
    v_exp_f32 v206, v206
    v_exp_f32 v207, v207
    v_pk_fma_f32 v[204:205], v[204:205], v[238:239], v[238:239] op_sel_hi:[1,0,0]
    v_pk_fma_f32 v[206:207], v[206:207], v[238:239], v[238:239] op_sel_hi:[1,0,0]
    v_rcp_f32 v204, v204
    v_rcp_f32 v205, v205
    v_rcp_f32 v206, v206
    v_rcp_f32 v207, v207
    v_pk_mul_f32 v[44:45], v[44:45], v[204:205]
    v_pk_mul_f32 v[46:47], v[46:47], v[206:207]
    v_cvt_pk_bf16_f32 v216, v32, v33
    v_cvt_pk_bf16_f32 v217, v34, v35
    v_cvt_pk_bf16_f32 v218, v36, v37
    v_cvt_pk_bf16_f32 v219, v38, v39
    buffer_store_dwordx4 v[216:219], v2, s[40:43], s76 offen offset:2048 sc1
    v_cvt_pk_bf16_f32 v220, v40, v41
    v_cvt_pk_bf16_f32 v221, v42, v43
    v_cvt_pk_bf16_f32 v222, v44, v45
    v_cvt_pk_bf16_f32 v223, v46, v47
    buffer_store_dwordx4 v[220:223], v2, s[40:43], s76 offen offset:3072 sc1
    s_nop 1
    s_cmp_lg_u32 s47, 0
    s_cbranch_scc1 L_w3p2_32_0
    v_mfma_f32_32x32x16_bf16 v[48:63], v[80:83], a[0:3], 0
    s_mul_i32 s98, s44, 14336
    s_add_u32 m0, s98, 61440
    s_add_u32 s99, s62, 401408
    s_add_u32 s100, s62, 407552
    ds_read_b64_tr_b16 v[104:105], v251 offset:6144
    ds_read_b64_tr_b16 v[106:107], v251 offset:7168
    v_mfma_f32_32x32x16_bf16 v[64:79], v[84:87], a[0:3], 0
    buffer_load_dwordx4 v6, s[28:31], s99 offen offset:0 lds
    ds_read_b64_tr_b16 v[108:109], v251 offset:6400
    ds_read_b64_tr_b16 v[110:111], v251 offset:7424
    v_mfma_f32_32x32x16_bf16 v[48:63], v[88:91], a[4:7], v[48:63]
    s_waitcnt vmcnt(9)
    ds_read_b64_tr_b16 a[128:129], v224 offset:0
    ds_read_b64_tr_b16 a[130:131], v224 offset:1024
    ds_read_b64_tr_b16 a[132:133], v225 offset:0
    ds_read_b64_tr_b16 a[134:135], v225 offset:1024
    ds_read_b64_tr_b16 v[80:81], v251 offset:8192
    ds_read_b64_tr_b16 v[82:83], v251 offset:9216
    v_mfma_f32_32x32x16_bf16 v[64:79], v[92:95], a[4:7], v[64:79]
    ds_read_b64_tr_b16 a[136:137], v224 offset:2048
    ds_read_b64_tr_b16 a[138:139], v224 offset:3072
    ds_read_b64_tr_b16 a[140:141], v225 offset:2048
    ds_read_b64_tr_b16 a[142:143], v225 offset:3072
    ds_read_b64_tr_b16 v[84:85], v251 offset:8448
    ds_read_b64_tr_b16 v[86:87], v251 offset:9472
    v_mfma_f32_32x32x16_bf16 v[48:63], v[96:99], a[8:11], v[48:63]
    ds_read_b64_tr_b16 a[144:145], v224 offset:4096
    ds_read_b64_tr_b16 a[146:147], v224 offset:5120
    ds_read_b64_tr_b16 a[148:149], v225 offset:4096
    ds_read_b64_tr_b16 a[150:151], v225 offset:5120
    ds_read_b64_tr_b16 v[88:89], v251 offset:10240
    ds_read_b64_tr_b16 v[90:91], v251 offset:11264
    v_mfma_f32_32x32x16_bf16 v[64:79], v[100:103], a[8:11], v[64:79]
    ds_read_b64_tr_b16 a[152:153], v224 offset:6144
    ds_read_b64_tr_b16 a[154:155], v224 offset:7168
    ds_read_b64_tr_b16 a[156:157], v225 offset:6144
    ds_read_b64_tr_b16 a[158:159], v225 offset:7168
    ds_read_b64_tr_b16 v[92:93], v251 offset:10496
    ds_read_b64_tr_b16 v[94:95], v251 offset:11520
    s_waitcnt lgkmcnt(15)
    v_mfma_f32_32x32x16_bf16 v[48:63], v[104:107], a[12:15], v[48:63]
    ds_read_b64_tr_b16 a[160:161], v224 offset:8192
    ds_read_b64_tr_b16 a[162:163], v224 offset:9216
    ds_read_b64_tr_b16 a[164:165], v225 offset:8192
    ds_read_b64_tr_b16 a[166:167], v225 offset:9216
    ds_read_b64_tr_b16 v[96:97], v251 offset:12288
    ds_read_b64_tr_b16 v[98:99], v251 offset:13312
    v_mfma_f32_32x32x16_bf16 v[64:79], v[108:111], a[12:15], v[64:79]
    buffer_load_dwordx4 v6, s[28:31], s100 offen offset:1024 lds
    ds_read_b64_tr_b16 v[100:101], v251 offset:12544
    ds_read_b64_tr_b16 v[102:103], v251 offset:13568
    v_mfma_f32_32x32x16_bf16 v[48:63], v[80:83], a[16:19], v[48:63]
    s_add_u32 m0, s98, 63488
    s_add_u32 s99, s62, 516096
    s_add_u32 s100, s62, 522240
    ds_read_b64_tr_b16 v[104:105], v251 offset:14336
    ds_read_b64_tr_b16 v[106:107], v251 offset:15360
    s_waitcnt lgkmcnt(15)
    v_mfma_f32_32x32x16_bf16 v[64:79], v[84:87], a[16:19], v[64:79]
    buffer_load_dwordx4 v6, s[28:31], s99 offen offset:0 lds
    ds_read_b64_tr_b16 v[108:109], v251 offset:14592
    ds_read_b64_tr_b16 v[110:111], v251 offset:15616
    v_mfma_f32_32x32x16_bf16 v[48:63], v[88:91], a[20:23], v[48:63]
    ds_read_b64_tr_b16 v[80:81], v251 offset:16384
    ds_read_b64_tr_b16 v[82:83], v251 offset:17408
    s_waitcnt lgkmcnt(14)
    v_mfma_f32_32x32x16_bf16 v[64:79], v[92:95], a[20:23], v[64:79]
    buffer_load_dwordx4 v6, s[28:31], s100 offen offset:1024 lds
    ds_read_b64_tr_b16 v[84:85], v251 offset:16640
    ds_read_b64_tr_b16 v[86:87], v251 offset:17664
    s_waitcnt lgkmcnt(10)
    v_mfma_f32_32x32x16_bf16 v[48:63], v[96:99], a[24:27], v[48:63]
    s_add_u32 m0, s98, 65536
    s_add_u32 s99, s62, 630784
    s_add_u32 s100, s62, 636928
    ds_read_b64_tr_b16 v[88:89], v251 offset:18432
    ds_read_b64_tr_b16 v[90:91], v251 offset:19456
    s_waitcnt lgkmcnt(10)
    v_mfma_f32_32x32x16_bf16 v[64:79], v[100:103], a[24:27], v[64:79]
    buffer_load_dwordx4 v6, s[28:31], s99 offen offset:0 lds
    ds_read_b64_tr_b16 v[92:93], v251 offset:18688
    ds_read_b64_tr_b16 v[94:95], v251 offset:19712
    s_waitcnt lgkmcnt(10)
    v_mfma_f32_32x32x16_bf16 v[48:63], v[104:107], a[28:31], v[48:63]
    ds_read_b64_tr_b16 v[96:97], v251 offset:20480
    ds_read_b64_tr_b16 v[98:99], v251 offset:21504
    s_waitcnt lgkmcnt(10)
    v_mfma_f32_32x32x16_bf16 v[64:79], v[108:111], a[28:31], v[64:79]
    buffer_load_dwordx4 v6, s[28:31], s100 offen offset:1024 lds
    ds_read_b64_tr_b16 v[100:101], v251 offset:20736
    ds_read_b64_tr_b16 v[102:103], v251 offset:21760
    s_waitcnt lgkmcnt(10)
    v_mfma_f32_32x32x16_bf16 v[48:63], v[80:83], a[32:35], v[48:63]
    s_add_u32 m0, s98, 67584
    s_add_u32 s99, s62, 745472
    s_add_u32 s100, s62, 751616
    ds_read_b64_tr_b16 v[104:105], v251 offset:22528
    ds_read_b64_tr_b16 v[106:107], v251 offset:23552
    s_waitcnt lgkmcnt(10)
    v_mfma_f32_32x32x16_bf16 v[64:79], v[84:87], a[32:35], v[64:79]
    buffer_load_dwordx4 v6, s[28:31], s99 offen offset:0 lds
    ds_read_b64_tr_b16 v[108:109], v251 offset:22784
    ds_read_b64_tr_b16 v[110:111], v251 offset:23808
    s_waitcnt lgkmcnt(10)
    v_mfma_f32_32x32x16_bf16 v[48:63], v[88:91], a[36:39], v[48:63]
    ds_read_b64_tr_b16 v[80:81], v251 offset:24576
    ds_read_b64_tr_b16 v[82:83], v251 offset:25600
    s_waitcnt lgkmcnt(10)
    v_mfma_f32_32x32x16_bf16 v[64:79], v[92:95], a[36:39], v[64:79]
    buffer_load_dwordx4 v6, s[28:31], s100 offen offset:1024 lds
    ds_read_b64_tr_b16 v[84:85], v251 offset:24832
    ds_read_b64_tr_b16 v[86:87], v251 offset:25856
    s_waitcnt lgkmcnt(10)
    v_mfma_f32_32x32x16_bf16 v[48:63], v[96:99], a[40:43], v[48:63]
    s_add_u32 m0, s98, 69632
    s_add_u32 s99, s62, 860160
    s_add_u32 s100, s62, 866304
    ds_read_b64_tr_b16 v[88:89], v251 offset:26624
    ds_read_b64_tr_b16 v[90:91], v251 offset:27648
    s_waitcnt lgkmcnt(10)
    v_mfma_f32_32x32x16_bf16 v[64:79], v[100:103], a[40:43], v[64:79]
    buffer_load_dwordx4 v6, s[28:31], s99 offen offset:0 lds
    ds_read_b64_tr_b16 v[92:93], v251 offset:26880
    ds_read_b64_tr_b16 v[94:95], v251 offset:27904
    s_waitcnt lgkmcnt(10)
    v_mfma_f32_32x32x16_bf16 v[48:63], v[104:107], a[44:47], v[48:63]
    ds_read_b64_tr_b16 v[96:97], v251 offset:28672
    ds_read_b64_tr_b16 v[98:99], v251 offset:29696
    s_waitcnt lgkmcnt(10)
    v_mfma_f32_32x32x16_bf16 v[64:79], v[108:111], a[44:47], v[64:79]
    buffer_load_dwordx4 v6, s[28:31], s100 offen offset:1024 lds
    ds_read_b64_tr_b16 v[100:101], v251 offset:28928
    ds_read_b64_tr_b16 v[102:103], v251 offset:29952
    s_waitcnt lgkmcnt(10)
    v_mfma_f32_32x32x16_bf16 v[48:63], v[80:83], a[48:51], v[48:63]
    s_mul_i32 s98, s44, 10240
    s_add_u32 m0, s98, 114688
    s_add_u32 s99, s62, 573440
    s_add_u32 s100, s62, 579584
    ds_read_b64_tr_b16 v[104:105], v251 offset:30720
    ds_read_b64_tr_b16 v[106:107], v251 offset:31744
    s_waitcnt lgkmcnt(10)
    v_mfma_f32_32x32x16_bf16 v[64:79], v[84:87], a[48:51], v[64:79]
    buffer_load_dwordx4 v6, s[28:31], s99 offen offset:0 lds
    ds_read_b64_tr_b16 v[108:109], v251 offset:30976
    ds_read_b64_tr_b16 v[110:111], v251 offset:32000
    s_waitcnt lgkmcnt(10)
    v_mfma_f32_32x32x16_bf16 v[48:63], v[88:91], a[52:55], v[48:63]
    ds_read_b64_tr_b16 v[80:81], v251 offset:32768
    ds_read_b64_tr_b16 v[82:83], v251 offset:33792
    s_waitcnt lgkmcnt(10)
    v_mfma_f32_32x32x16_bf16 v[64:79], v[92:95], a[52:55], v[64:79]
    buffer_load_dwordx4 v6, s[28:31], s100 offen offset:1024 lds
    ds_read_b64_tr_b16 v[84:85], v251 offset:33024
    ds_read_b64_tr_b16 v[86:87], v251 offset:34048
    s_waitcnt lgkmcnt(10)
    v_mfma_f32_32x32x16_bf16 v[48:63], v[96:99], a[56:59], v[48:63]
    s_add_u32 m0, s98, 116736
    s_add_u32 s99, s62, 688128
    s_add_u32 s100, s62, 694272
    ds_read_b64_tr_b16 v[88:89], v251 offset:34816
    ds_read_b64_tr_b16 v[90:91], v251 offset:35840
    s_waitcnt lgkmcnt(10)
    v_mfma_f32_32x32x16_bf16 v[64:79], v[100:103], a[56:59], v[64:79]
    buffer_load_dwordx4 v6, s[28:31], s99 offen offset:0 lds
    ds_read_b64_tr_b16 v[92:93], v251 offset:35072
    ds_read_b64_tr_b16 v[94:95], v251 offset:36096
    s_waitcnt lgkmcnt(10)
    v_mfma_f32_32x32x16_bf16 v[48:63], v[104:107], a[60:63], v[48:63]
    ds_read_b64_tr_b16 v[96:97], v251 offset:36864
    ds_read_b64_tr_b16 v[98:99], v251 offset:37888
    s_waitcnt lgkmcnt(10)
    v_mfma_f32_32x32x16_bf16 v[64:79], v[108:111], a[60:63], v[64:79]
    buffer_load_dwordx4 v6, s[28:31], s100 offen offset:1024 lds
    ds_read_b64_tr_b16 v[100:101], v251 offset:37120
    ds_read_b64_tr_b16 v[102:103], v251 offset:38144
    s_waitcnt lgkmcnt(10)
    v_mfma_f32_32x32x16_bf16 v[48:63], v[80:83], a[64:67], v[48:63]
    s_add_u32 m0, s98, 118784
    s_add_u32 s99, s62, 802816
    s_add_u32 s100, s62, 808960
    ds_read_b64_tr_b16 v[104:105], v251 offset:38912
    ds_read_b64_tr_b16 v[106:107], v251 offset:39936
    s_waitcnt lgkmcnt(10)
    v_mfma_f32_32x32x16_bf16 v[64:79], v[84:87], a[64:67], v[64:79]
    buffer_load_dwordx4 v6, s[28:31], s99 offen offset:0 lds
    ds_read_b64_tr_b16 v[108:109], v251 offset:39168
    ds_read_b64_tr_b16 v[110:111], v251 offset:40192
    s_waitcnt lgkmcnt(10)
    v_mfma_f32_32x32x16_bf16 v[48:63], v[88:91], a[68:71], v[48:63]
    ds_read_b64_tr_b16 v[80:81], v251 offset:40960
    ds_read_b64_tr_b16 v[82:83], v251 offset:41984
    s_waitcnt lgkmcnt(10)
    v_mfma_f32_32x32x16_bf16 v[64:79], v[92:95], a[68:71], v[64:79]
    buffer_load_dwordx4 v6, s[28:31], s100 offen offset:1024 lds
    ds_read_b64_tr_b16 v[84:85], v251 offset:41216
    ds_read_b64_tr_b16 v[86:87], v251 offset:42240
    s_waitcnt lgkmcnt(10)
    v_mfma_f32_32x32x16_bf16 v[48:63], v[96:99], a[72:75], v[48:63]
    s_add_u32 m0, s98, 120832
    s_add_u32 s99, s62, 917504
    s_add_u32 s100, s62, 923648
    ds_read_b64_tr_b16 v[88:89], v251 offset:43008
    ds_read_b64_tr_b16 v[90:91], v251 offset:44032
    s_waitcnt lgkmcnt(10)
    v_mfma_f32_32x32x16_bf16 v[64:79], v[100:103], a[72:75], v[64:79]
    buffer_load_dwordx4 v6, s[28:31], s99 offen offset:0 lds
    ds_read_b64_tr_b16 v[92:93], v251 offset:43264
    ds_read_b64_tr_b16 v[94:95], v251 offset:44288
    s_waitcnt lgkmcnt(10)
    v_mfma_f32_32x32x16_bf16 v[48:63], v[104:107], a[76:79], v[48:63]
    ds_read_b64_tr_b16 v[96:97], v251 offset:45056
    ds_read_b64_tr_b16 v[98:99], v251 offset:46080
    s_waitcnt lgkmcnt(10)
    v_mfma_f32_32x32x16_bf16 v[64:79], v[108:111], a[76:79], v[64:79]
    buffer_load_dwordx4 v6, s[28:31], s100 offen offset:1024 lds
    ds_read_b64_tr_b16 v[100:101], v251 offset:45312
    ds_read_b64_tr_b16 v[102:103], v251 offset:46336
    s_waitcnt lgkmcnt(10)
    v_mfma_f32_32x32x16_bf16 v[48:63], v[80:83], a[80:83], v[48:63]
    s_add_u32 m0, s98, 122880
    s_add_u32 s99, s62, 1032192
    s_add_u32 s100, s62, 1038336
    ds_read_b64_tr_b16 v[104:105], v251 offset:47104
    ds_read_b64_tr_b16 v[106:107], v251 offset:48128
    s_waitcnt lgkmcnt(10)
    v_mfma_f32_32x32x16_bf16 v[64:79], v[84:87], a[80:83], v[64:79]
    buffer_load_dwordx4 v6, s[28:31], s99 offen offset:0 lds
    ds_read_b64_tr_b16 v[108:109], v251 offset:47360
    ds_read_b64_tr_b16 v[110:111], v251 offset:48384
    s_waitcnt lgkmcnt(10)
    v_mfma_f32_32x32x16_bf16 v[48:63], v[88:91], a[84:87], v[48:63]
    ds_read_b64_tr_b16 v[80:81], v251 offset:49152
    ds_read_b64_tr_b16 v[82:83], v251 offset:50176
    s_waitcnt lgkmcnt(10)
    v_mfma_f32_32x32x16_bf16 v[64:79], v[92:95], a[84:87], v[64:79]
    buffer_load_dwordx4 v6, s[28:31], s100 offen offset:1024 lds
    ds_read_b64_tr_b16 v[84:85], v251 offset:49408
    ds_read_b64_tr_b16 v[86:87], v251 offset:50432
    s_waitcnt lgkmcnt(10)
    v_mfma_f32_32x32x16_bf16 v[48:63], v[96:99], a[88:91], v[48:63]
    ds_read_b64_tr_b16 v[88:89], v251 offset:51200
    ds_read_b64_tr_b16 v[90:91], v251 offset:52224
    s_waitcnt lgkmcnt(10)
    v_mfma_f32_32x32x16_bf16 v[64:79], v[100:103], a[88:91], v[64:79]
    ds_read_b64_tr_b16 v[92:93], v251 offset:51456
    ds_read_b64_tr_b16 v[94:95], v251 offset:52480
    s_waitcnt lgkmcnt(10)
    v_mfma_f32_32x32x16_bf16 v[48:63], v[104:107], a[92:95], v[48:63]
    ds_read_b64_tr_b16 v[96:97], v251 offset:53248
    ds_read_b64_tr_b16 v[98:99], v251 offset:54272
    s_waitcnt lgkmcnt(10)
    v_mfma_f32_32x32x16_bf16 v[64:79], v[108:111], a[92:95], v[64:79]
    ds_read_b64_tr_b16 v[100:101], v251 offset:53504
    ds_read_b64_tr_b16 v[102:103], v251 offset:54528
    s_waitcnt lgkmcnt(10)
    v_mfma_f32_32x32x16_bf16 v[48:63], v[80:83], a[96:99], v[48:63]
    ds_read_b64_tr_b16 v[104:105], v251 offset:55296
    ds_read_b64_tr_b16 v[106:107], v251 offset:56320
    s_waitcnt lgkmcnt(10)
    v_mfma_f32_32x32x16_bf16 v[64:79], v[84:87], a[96:99], v[64:79]
    ds_read_b64_tr_b16 v[108:109], v251 offset:55552
    ds_read_b64_tr_b16 v[110:111], v251 offset:56576
    s_waitcnt lgkmcnt(10)
    v_mfma_f32_32x32x16_bf16 v[48:63], v[88:91], a[100:103], v[48:63]
    s_waitcnt lgkmcnt(8)
    v_mfma_f32_32x32x16_bf16 v[64:79], v[92:95], a[100:103], v[64:79]
    s_waitcnt lgkmcnt(6)
    v_mfma_f32_32x32x16_bf16 v[48:63], v[96:99], a[104:107], v[48:63]
    s_waitcnt lgkmcnt(4)
    v_mfma_f32_32x32x16_bf16 v[64:79], v[100:103], a[104:107], v[64:79]
    s_waitcnt lgkmcnt(2)
    v_mfma_f32_32x32x16_bf16 v[48:63], v[104:107], a[108:111], v[48:63]
    s_waitcnt lgkmcnt(0)
    v_mfma_f32_32x32x16_bf16 v[64:79], v[108:111], a[108:111], v[64:79]
    s_waitcnt vmcnt(20)
    s_nop 10
    s_branch L_w3p2_32_2
L_w3p2_32_0:
    v_mfma_f32_32x32x16_bf16 v[48:63], v[80:83], a[0:3], 0
    s_mul_i32 s98, s44, 14336
    s_add_u32 m0, s98, 61440
    s_add_u32 s99, s62, 401408
    s_add_u32 s100, s62, 407552
    ds_read_b64_tr_b16 v[104:105], v251 offset:6144
    ds_read_b64_tr_b16 v[106:107], v251 offset:7168
    v_mfma_f32_32x32x16_bf16 v[64:79], v[84:87], a[0:3], 0
    buffer_load_dwordx4 v6, s[28:31], s99 offen offset:0 lds
    ds_read_b64_tr_b16 v[108:109], v251 offset:6400
    ds_read_b64_tr_b16 v[110:111], v251 offset:7424
    v_mfma_f32_32x32x16_bf16 v[48:63], v[88:91], a[4:7], v[48:63]
    ds_read_b64_tr_b16 v[80:81], v251 offset:8192
    ds_read_b64_tr_b16 v[82:83], v251 offset:9216
    v_mfma_f32_32x32x16_bf16 v[64:79], v[92:95], a[4:7], v[64:79]
    buffer_load_dwordx4 v6, s[28:31], s100 offen offset:1024 lds
    ds_read_b64_tr_b16 v[84:85], v251 offset:8448
    ds_read_b64_tr_b16 v[86:87], v251 offset:9472
    v_mfma_f32_32x32x16_bf16 v[48:63], v[96:99], a[8:11], v[48:63]
    s_add_u32 m0, s98, 63488
    s_add_u32 s99, s62, 516096
    s_add_u32 s100, s62, 522240
    ds_read_b64_tr_b16 v[88:89], v251 offset:10240
    ds_read_b64_tr_b16 v[90:91], v251 offset:11264
    v_mfma_f32_32x32x16_bf16 v[64:79], v[100:103], a[8:11], v[64:79]
    buffer_load_dwordx4 v6, s[28:31], s99 offen offset:0 lds
    ds_read_b64_tr_b16 v[92:93], v251 offset:10496
    ds_read_b64_tr_b16 v[94:95], v251 offset:11520
    s_waitcnt lgkmcnt(10)
    v_mfma_f32_32x32x16_bf16 v[48:63], v[104:107], a[12:15], v[48:63]
    ds_read_b64_tr_b16 v[96:97], v251 offset:12288
    ds_read_b64_tr_b16 v[98:99], v251 offset:13312
    s_waitcnt lgkmcnt(10)
    v_mfma_f32_32x32x16_bf16 v[64:79], v[108:111], a[12:15], v[64:79]
    buffer_load_dwordx4 v6, s[28:31], s100 offen offset:1024 lds
    ds_read_b64_tr_b16 v[100:101], v251 offset:12544
    ds_read_b64_tr_b16 v[102:103], v251 offset:13568
    s_waitcnt lgkmcnt(10)
    v_mfma_f32_32x32x16_bf16 v[48:63], v[80:83], a[16:19], v[48:63]
    s_add_u32 m0, s98, 65536
    s_add_u32 s99, s62, 630784
    s_add_u32 s100, s62, 636928
    ds_read_b64_tr_b16 v[104:105], v251 offset:14336
    ds_read_b64_tr_b16 v[106:107], v251 offset:15360
    s_waitcnt lgkmcnt(10)
    v_mfma_f32_32x32x16_bf16 v[64:79], v[84:87], a[16:19], v[64:79]
    buffer_load_dwordx4 v6, s[28:31], s99 offen offset:0 lds
    ds_read_b64_tr_b16 v[108:109], v251 offset:14592
    ds_read_b64_tr_b16 v[110:111], v251 offset:15616
    s_waitcnt lgkmcnt(10)
    v_mfma_f32_32x32x16_bf16 v[48:63], v[88:91], a[20:23], v[48:63]
    ds_read_b64_tr_b16 v[80:81], v251 offset:16384
    ds_read_b64_tr_b16 v[82:83], v251 offset:17408
    s_waitcnt lgkmcnt(10)
    v_mfma_f32_32x32x16_bf16 v[64:79], v[92:95], a[20:23], v[64:79]
    buffer_load_dwordx4 v6, s[28:31], s100 offen offset:1024 lds
    ds_read_b64_tr_b16 v[84:85], v251 offset:16640
    ds_read_b64_tr_b16 v[86:87], v251 offset:17664
    s_waitcnt lgkmcnt(10)
    v_mfma_f32_32x32x16_bf16 v[48:63], v[96:99], a[24:27], v[48:63]
    s_add_u32 m0, s98, 67584
    s_add_u32 s99, s62, 745472
    s_add_u32 s100, s62, 751616
    ds_read_b64_tr_b16 v[88:89], v251 offset:18432
    ds_read_b64_tr_b16 v[90:91], v251 offset:19456
    s_waitcnt lgkmcnt(10)
    v_mfma_f32_32x32x16_bf16 v[64:79], v[100:103], a[24:27], v[64:79]
    buffer_load_dwordx4 v6, s[28:31], s99 offen offset:0 lds
    ds_read_b64_tr_b16 v[92:93], v251 offset:18688
    ds_read_b64_tr_b16 v[94:95], v251 offset:19712
    s_waitcnt lgkmcnt(10)
    v_mfma_f32_32x32x16_bf16 v[48:63], v[104:107], a[28:31], v[48:63]
    ds_read_b64_tr_b16 v[96:97], v251 offset:20480
    ds_read_b64_tr_b16 v[98:99], v251 offset:21504
    s_waitcnt lgkmcnt(10)
    v_mfma_f32_32x32x16_bf16 v[64:79], v[108:111], a[28:31], v[64:79]
    buffer_load_dwordx4 v6, s[28:31], s100 offen offset:1024 lds
    ds_read_b64_tr_b16 v[100:101], v251 offset:20736
    ds_read_b64_tr_b16 v[102:103], v251 offset:21760
    s_waitcnt lgkmcnt(10)
    v_mfma_f32_32x32x16_bf16 v[48:63], v[80:83], a[32:35], v[48:63]
    s_add_u32 m0, s98, 69632
    s_add_u32 s99, s62, 860160
    s_add_u32 s100, s62, 866304
    ds_read_b64_tr_b16 v[104:105], v251 offset:22528
    ds_read_b64_tr_b16 v[106:107], v251 offset:23552
    s_waitcnt lgkmcnt(10)
    v_mfma_f32_32x32x16_bf16 v[64:79], v[84:87], a[32:35], v[64:79]
    buffer_load_dwordx4 v6, s[28:31], s99 offen offset:0 lds
    ds_read_b64_tr_b16 v[108:109], v251 offset:22784
    ds_read_b64_tr_b16 v[110:111], v251 offset:23808
    s_waitcnt lgkmcnt(10)
    v_mfma_f32_32x32x16_bf16 v[48:63], v[88:91], a[36:39], v[48:63]
    ds_read_b64_tr_b16 v[80:81], v251 offset:24576
    ds_read_b64_tr_b16 v[82:83], v251 offset:25600
    s_waitcnt lgkmcnt(10)
    v_mfma_f32_32x32x16_bf16 v[64:79], v[92:95], a[36:39], v[64:79]
    buffer_load_dwordx4 v6, s[28:31], s100 offen offset:1024 lds
    ds_read_b64_tr_b16 v[84:85], v251 offset:24832
    ds_read_b64_tr_b16 v[86:87], v251 offset:25856
    s_waitcnt lgkmcnt(10)
    v_mfma_f32_32x32x16_bf16 v[48:63], v[96:99], a[40:43], v[48:63]
    ds_read_b64_tr_b16 v[88:89], v251 offset:26624
    ds_read_b64_tr_b16 v[90:91], v251 offset:27648
    s_waitcnt lgkmcnt(10)
    v_mfma_f32_32x32x16_bf16 v[64:79], v[100:103], a[40:43], v[64:79]
    ds_read_b64_tr_b16 v[92:93], v251 offset:26880
    ds_read_b64_tr_b16 v[94:95], v251 offset:27904
    s_waitcnt lgkmcnt(10)
    v_mfma_f32_32x32x16_bf16 v[48:63], v[104:107], a[44:47], v[48:63]
    ds_read_b64_tr_b16 v[96:97], v251 offset:28672
    ds_read_b64_tr_b16 v[98:99], v251 offset:29696
    s_waitcnt lgkmcnt(10)
    v_mfma_f32_32x32x16_bf16 v[64:79], v[108:111], a[44:47], v[64:79]
    ds_read_b64_tr_b16 v[100:101], v251 offset:28928
    ds_read_b64_tr_b16 v[102:103], v251 offset:29952
    s_waitcnt lgkmcnt(10)
    v_mfma_f32_32x32x16_bf16 v[48:63], v[80:83], a[48:51], v[48:63]
    ds_read_b64_tr_b16 v[104:105], v251 offset:30720
    ds_read_b64_tr_b16 v[106:107], v251 offset:31744
    s_waitcnt lgkmcnt(10)
    v_mfma_f32_32x32x16_bf16 v[64:79], v[84:87], a[48:51], v[64:79]
    ds_read_b64_tr_b16 v[108:109], v251 offset:30976
    ds_read_b64_tr_b16 v[110:111], v251 offset:32000
    s_waitcnt lgkmcnt(10)
    v_mfma_f32_32x32x16_bf16 v[48:63], v[88:91], a[52:55], v[48:63]
    ds_read_b64_tr_b16 v[80:81], v251 offset:32768
    ds_read_b64_tr_b16 v[82:83], v251 offset:33792
    s_waitcnt lgkmcnt(10)
    v_mfma_f32_32x32x16_bf16 v[64:79], v[92:95], a[52:55], v[64:79]
    ds_read_b64_tr_b16 v[84:85], v251 offset:33024
    ds_read_b64_tr_b16 v[86:87], v251 offset:34048
    s_waitcnt lgkmcnt(10)
    v_mfma_f32_32x32x16_bf16 v[48:63], v[96:99], a[56:59], v[48:63]
    ds_read_b64_tr_b16 v[88:89], v251 offset:34816
    ds_read_b64_tr_b16 v[90:91], v251 offset:35840
    s_waitcnt lgkmcnt(10)
    v_mfma_f32_32x32x16_bf16 v[64:79], v[100:103], a[56:59], v[64:79]
    ds_read_b64_tr_b16 v[92:93], v251 offset:35072
    ds_read_b64_tr_b16 v[94:95], v251 offset:36096
    s_waitcnt lgkmcnt(10)
    v_mfma_f32_32x32x16_bf16 v[48:63], v[104:107], a[60:63], v[48:63]
    ds_read_b64_tr_b16 v[96:97], v251 offset:36864
    ds_read_b64_tr_b16 v[98:99], v251 offset:37888
    s_waitcnt lgkmcnt(10)
    v_mfma_f32_32x32x16_bf16 v[64:79], v[108:111], a[60:63], v[64:79]
    ds_read_b64_tr_b16 v[100:101], v251 offset:37120
    ds_read_b64_tr_b16 v[102:103], v251 offset:38144
    s_waitcnt lgkmcnt(10)
    v_mfma_f32_32x32x16_bf16 v[48:63], v[80:83], a[64:67], v[48:63]
    ds_read_b64_tr_b16 v[104:105], v251 offset:38912
    ds_read_b64_tr_b16 v[106:107], v251 offset:39936
    s_waitcnt lgkmcnt(10)
    v_mfma_f32_32x32x16_bf16 v[64:79], v[84:87], a[64:67], v[64:79]
    ds_read_b64_tr_b16 v[108:109], v251 offset:39168
    ds_read_b64_tr_b16 v[110:111], v251 offset:40192
    s_waitcnt lgkmcnt(10)
    v_mfma_f32_32x32x16_bf16 v[48:63], v[88:91], a[68:71], v[48:63]
    ds_read_b64_tr_b16 v[80:81], v251 offset:40960
    ds_read_b64_tr_b16 v[82:83], v251 offset:41984
    s_waitcnt lgkmcnt(10)
    v_mfma_f32_32x32x16_bf16 v[64:79], v[92:95], a[68:71], v[64:79]
    ds_read_b64_tr_b16 v[84:85], v251 offset:41216
    ds_read_b64_tr_b16 v[86:87], v251 offset:42240
    s_waitcnt lgkmcnt(10)
    v_mfma_f32_32x32x16_bf16 v[48:63], v[96:99], a[72:75], v[48:63]
    ds_read_b64_tr_b16 v[88:89], v251 offset:43008
    ds_read_b64_tr_b16 v[90:91], v251 offset:44032
    s_waitcnt lgkmcnt(10)
    v_mfma_f32_32x32x16_bf16 v[64:79], v[100:103], a[72:75], v[64:79]
    ds_read_b64_tr_b16 v[92:93], v251 offset:43264
    ds_read_b64_tr_b16 v[94:95], v251 offset:44288
    s_waitcnt lgkmcnt(10)
    v_mfma_f32_32x32x16_bf16 v[48:63], v[104:107], a[76:79], v[48:63]
    ds_read_b64_tr_b16 v[96:97], v251 offset:45056
    ds_read_b64_tr_b16 v[98:99], v251 offset:46080
    s_waitcnt lgkmcnt(10)
    v_mfma_f32_32x32x16_bf16 v[64:79], v[108:111], a[76:79], v[64:79]
    ds_read_b64_tr_b16 v[100:101], v251 offset:45312
    ds_read_b64_tr_b16 v[102:103], v251 offset:46336
    s_waitcnt lgkmcnt(10)
    v_mfma_f32_32x32x16_bf16 v[48:63], v[80:83], a[80:83], v[48:63]
    ds_read_b64_tr_b16 v[104:105], v251 offset:47104
    ds_read_b64_tr_b16 v[106:107], v251 offset:48128
    s_waitcnt lgkmcnt(10)
    v_mfma_f32_32x32x16_bf16 v[64:79], v[84:87], a[80:83], v[64:79]
    ds_read_b64_tr_b16 v[108:109], v251 offset:47360
    ds_read_b64_tr_b16 v[110:111], v251 offset:48384
    s_waitcnt lgkmcnt(10)
    v_mfma_f32_32x32x16_bf16 v[48:63], v[88:91], a[84:87], v[48:63]
    ds_read_b64_tr_b16 v[80:81], v251 offset:49152
    ds_read_b64_tr_b16 v[82:83], v251 offset:50176
    s_waitcnt lgkmcnt(10)
    v_mfma_f32_32x32x16_bf16 v[64:79], v[92:95], a[84:87], v[64:79]
    ds_read_b64_tr_b16 v[84:85], v251 offset:49408
    ds_read_b64_tr_b16 v[86:87], v251 offset:50432
    s_waitcnt lgkmcnt(10)
    v_mfma_f32_32x32x16_bf16 v[48:63], v[96:99], a[88:91], v[48:63]
    ds_read_b64_tr_b16 v[88:89], v251 offset:51200
    ds_read_b64_tr_b16 v[90:91], v251 offset:52224
    s_waitcnt lgkmcnt(10)
    v_mfma_f32_32x32x16_bf16 v[64:79], v[100:103], a[88:91], v[64:79]
    ds_read_b64_tr_b16 v[92:93], v251 offset:51456
    ds_read_b64_tr_b16 v[94:95], v251 offset:52480
    s_waitcnt lgkmcnt(10)
    v_mfma_f32_32x32x16_bf16 v[48:63], v[104:107], a[92:95], v[48:63]
    ds_read_b64_tr_b16 v[96:97], v251 offset:53248
    ds_read_b64_tr_b16 v[98:99], v251 offset:54272
    s_waitcnt lgkmcnt(10)
    v_mfma_f32_32x32x16_bf16 v[64:79], v[108:111], a[92:95], v[64:79]
    ds_read_b64_tr_b16 v[100:101], v251 offset:53504
    ds_read_b64_tr_b16 v[102:103], v251 offset:54528
    s_waitcnt lgkmcnt(10)
    v_mfma_f32_32x32x16_bf16 v[48:63], v[80:83], a[96:99], v[48:63]
    ds_read_b64_tr_b16 v[104:105], v251 offset:55296
    ds_read_b64_tr_b16 v[106:107], v251 offset:56320
    s_waitcnt lgkmcnt(10)
    v_mfma_f32_32x32x16_bf16 v[64:79], v[84:87], a[96:99], v[64:79]
    ds_read_b64_tr_b16 v[108:109], v251 offset:55552
    ds_read_b64_tr_b16 v[110:111], v251 offset:56576
    s_waitcnt lgkmcnt(10)
    v_mfma_f32_32x32x16_bf16 v[48:63], v[88:91], a[100:103], v[48:63]
    s_waitcnt lgkmcnt(8)
    v_mfma_f32_32x32x16_bf16 v[64:79], v[92:95], a[100:103], v[64:79]
    s_waitcnt lgkmcnt(6)
    v_mfma_f32_32x32x16_bf16 v[48:63], v[96:99], a[104:107], v[48:63]
    s_waitcnt lgkmcnt(4)
    v_mfma_f32_32x32x16_bf16 v[64:79], v[100:103], a[104:107], v[64:79]
    s_waitcnt lgkmcnt(2)
    v_mfma_f32_32x32x16_bf16 v[48:63], v[104:107], a[108:111], v[48:63]
    s_waitcnt lgkmcnt(0)
    v_mfma_f32_32x32x16_bf16 v[64:79], v[108:111], a[108:111], v[64:79]
    s_waitcnt vmcnt(10)
L_w3p2_32_2:
    s_barrier
    s_cmp_lg_u32 s44, 0
    s_cbranch_scc1 L_sig_33
    s_mov_b64 exec, 0x3fff
    s_cmp_eq_u32 s63, 0
    s_cbranch_scc1 L_sig_33_s
    s_add_u32 s72, s47, 1
    v_mov_b32_e64 v10, s72
    s_lshl_b32 s72, s56, 2
    s_add_u32 s72, s72, s68
    buffer_store_dword v10, v0, s[40:43], s72 offen offset:880
    s_branch L_sig_33_e
L_sig_33_s:
    buffer_atomic_add a238, v0, s[40:43], s68 offen offset:12 sc1
L_sig_33_e:
    s_mov_b64 exec, -1
L_sig_33:
    s_add_u32 s57, s47, 1
    s_mul_i32 s98, s44, 14336
    s_add_u32 m0, s98, 0
    s_add_u32 s99, s62, 974848
    s_add_u32 s100, s62, 980992
    s_add_u32 s101, s62, 1087488
    s_add_u32 s75, s62, 1093632
    buffer_load_dwordx4 v6, s[28:31], s99 offen offset:0 lds
    buffer_load_dwordx4 v6, s[28:31], s100 offen offset:1024 lds
    buffer_load_dwordx4 v6, s[28:31], s101 offen offset:2048 lds
    buffer_load_dwordx4 v6, s[28:31], s75 offen offset:3072 lds
    s_mul_i32 s72, s57, 14
    s_mov_b32 s81, 0
    s_cmp_eq_u32 s63, 0
    s_cselect_b32 s57, s72, s57
    s_cselect_b32 s80, 1, 0x3fff
    s_cselect_b32 s52, 28, 0x380
    s_add_u32 s52, s52, s71
    v_pk_fma_f32 v[48:49], v[244:245], v[144:145], v[48:49] op_sel_hi:[0,1,1] neg_lo:[1,0,0] neg_hi:[1,0,0]
    v_pk_fma_f32 v[50:51], v[244:245], v[146:147], v[50:51] op_sel_hi:[0,1,1] neg_lo:[1,0,0] neg_hi:[1,0,0]
    v_pk_fma_f32 v[52:53], v[244:245], v[148:149], v[52:53] op_sel_hi:[0,1,1] neg_lo:[1,0,0] neg_hi:[1,0,0]
    v_pk_fma_f32 v[54:55], v[244:245], v[150:151], v[54:55] op_sel_hi:[0,1,1] neg_lo:[1,0,0] neg_hi:[1,0,0]
    v_pk_mul_f32 v[176:177], v[48:49], v[48:49]
    v_pk_mul_f32 v[178:179], v[50:51], v[50:51]
    v_pk_mul_f32 v[180:181], v[52:53], v[52:53]
    v_pk_mul_f32 v[182:183], v[54:55], v[54:55]
    v_pk_fma_f32 v[176:177], v[176:177], v[248:249], v[246:247] op_sel_hi:[1,0,0]
    v_pk_fma_f32 v[178:179], v[178:179], v[248:249], v[246:247] op_sel_hi:[1,0,0]
    v_pk_fma_f32 v[180:181], v[180:181], v[248:249], v[246:247] op_sel_hi:[1,0,0]
    v_pk_fma_f32 v[182:183], v[182:183], v[248:249], v[246:247] op_sel_hi:[1,0,0]
    v_pk_mul_f32 v[176:177], v[176:177], v[48:49]
    v_pk_mul_f32 v[178:179], v[178:179], v[50:51]
    v_pk_mul_f32 v[180:181], v[180:181], v[52:53]
    v_pk_mul_f32 v[182:183], v[182:183], v[54:55]
    v_pk_fma_f32 v[56:57], v[244:245], v[152:153], v[56:57] op_sel_hi:[0,1,1] neg_lo:[1,0,0] neg_hi:[1,0,0]
    v_pk_fma_f32 v[58:59], v[244:245], v[154:155], v[58:59] op_sel_hi:[0,1,1] neg_lo:[1,0,0] neg_hi:[1,0,0]
    v_pk_fma_f32 v[60:61], v[244:245], v[156:157], v[60:61] op_sel_hi:[0,1,1] neg_lo:[1,0,0] neg_hi:[1,0,0]
    v_pk_fma_f32 v[62:63], v[244:245], v[158:159], v[62:63] op_sel_hi:[0,1,1] neg_lo:[1,0,0] neg_hi:[1,0,0]
    v_pk_mul_f32 v[184:185], v[56:57], v[56:57]
    v_pk_mul_f32 v[186:187], v[58:59], v[58:59]
    v_pk_mul_f32 v[188:189], v[60:61], v[60:61]
    s_add_u32 m0, s98, 4096
    s_add_u32 s99, s62, 1204224
    s_add_u32 s100, s62, 1210368
    s_add_u32 s101, s62, 1316864
    s_add_u32 s75, s62, 1323008
    buffer_load_dwordx4 v6, s[28:31], s99 offen offset:0 lds
    buffer_load_dwordx4 v6, s[28:31], s100 offen offset:1024 lds
    buffer_load_dwordx4 v6, s[28:31], s101 offen offset:2048 lds
    buffer_load_dwordx4 v6, s[28:31], s75 offen offset:3072 lds
    v_pk_mul_f32 v[190:191], v[62:63], v[62:63]
    v_pk_fma_f32 v[184:185], v[184:185], v[248:249], v[246:247] op_sel_hi:[1,0,0]
    v_pk_fma_f32 v[186:187], v[186:187], v[248:249], v[246:247] op_sel_hi:[1,0,0]
    v_pk_fma_f32 v[188:189], v[188:189], v[248:249], v[246:247] op_sel_hi:[1,0,0]
    v_pk_fma_f32 v[190:191], v[190:191], v[248:249], v[246:247] op_sel_hi:[1,0,0]
    v_pk_mul_f32 v[184:185], v[184:185], v[56:57]
    v_pk_mul_f32 v[186:187], v[186:187], v[58:59]
    v_pk_mul_f32 v[188:189], v[188:189], v[60:61]
    v_pk_mul_f32 v[190:191], v[190:191], v[62:63]
    v_exp_f32 v176, v176
    v_exp_f32 v177, v177
    v_exp_f32 v178, v178
    v_exp_f32 v179, v179
    v_pk_fma_f32 v[176:177], v[176:177], v[238:239], v[238:239] op_sel_hi:[1,0,0]
    v_pk_fma_f32 v[178:179], v[178:179], v[238:239], v[238:239] op_sel_hi:[1,0,0]
    v_rcp_f32 v176, v176
    v_rcp_f32 v177, v177
    v_rcp_f32 v178, v178
    v_rcp_f32 v179, v179
    v_pk_mul_f32 v[48:49], v[48:49], v[176:177]
    v_pk_mul_f32 v[50:51], v[50:51], v[178:179]
    v_exp_f32 v180, v180
    v_exp_f32 v181, v181
    v_exp_f32 v182, v182
    v_exp_f32 v183, v183
    v_pk_fma_f32 v[180:181], v[180:181], v[238:239], v[238:239] op_sel_hi:[1,0,0]
    v_pk_fma_f32 v[182:183], v[182:183], v[238:239], v[238:239] op_sel_hi:[1,0,0]
    v_rcp_f32 v180, v180
    v_rcp_f32 v181, v181
    v_rcp_f32 v182, v182
    v_rcp_f32 v183, v183
    v_pk_mul_f32 v[52:53], v[52:53], v[180:181]
    v_pk_mul_f32 v[54:55], v[54:55], v[182:183]
    v_exp_f32 v184, v184
    v_exp_f32 v185, v185
    v_exp_f32 v186, v186
    v_exp_f32 v187, v187
    v_pk_fma_f32 v[184:185], v[184:185], v[238:239], v[238:239] op_sel_hi:[1,0,0]
    v_pk_fma_f32 v[186:187], v[186:187], v[238:239], v[238:239] op_sel_hi:[1,0,0]
    v_rcp_f32 v184, v184
    v_rcp_f32 v185, v185
    v_rcp_f32 v186, v186
    v_rcp_f32 v187, v187
    v_pk_mul_f32 v[56:57], v[56:57], v[184:185]
    v_pk_mul_f32 v[58:59], v[58:59], v[186:187]
    v_exp_f32 v188, v188
    v_exp_f32 v189, v189
    v_exp_f32 v190, v190
    v_exp_f32 v191, v191
    v_pk_fma_f32 v[188:189], v[188:189], v[238:239], v[238:239] op_sel_hi:[1,0,0]
    v_pk_fma_f32 v[190:191], v[190:191], v[238:239], v[238:239] op_sel_hi:[1,0,0]
    v_rcp_f32 v188, v188
    v_rcp_f32 v189, v189
    v_rcp_f32 v190, v190
    v_rcp_f32 v191, v191
    v_pk_mul_f32 v[60:61], v[60:61], v[188:189]
    v_pk_mul_f32 v[62:63], v[62:63], v[190:191]
    s_add_u32 s76, s76, 4096
    v_cvt_pk_bf16_f32 v208, v48, v49
    v_cvt_pk_bf16_f32 v209, v50, v51
    v_cvt_pk_bf16_f32 v210, v52, v53
    v_cvt_pk_bf16_f32 v211, v54, v55
    buffer_store_dwordx4 v[208:211], v2, s[40:43], s76 offen offset:0 sc1
    v_cvt_pk_bf16_f32 v212, v56, v57
    v_cvt_pk_bf16_f32 v213, v58, v59
    v_cvt_pk_bf16_f32 v214, v60, v61
    v_cvt_pk_bf16_f32 v215, v62, v63
    buffer_store_dwordx4 v[212:215], v2, s[40:43], s76 offen offset:1024 sc1
    s_cmp_lg_u32 s47, 0
    s_cbranch_scc1 L_l0_34
    s_waitcnt vmcnt(10)
    ds_read_b64_tr_b16 a[168:169], v224 offset:0
    ds_read_b64_tr_b16 a[170:171], v224 offset:1024
    ds_read_b64_tr_b16 a[172:173], v225 offset:0
    ds_read_b64_tr_b16 a[174:175], v225 offset:1024
    ds_read_b64_tr_b16 a[176:177], v224 offset:2048
    ds_read_b64_tr_b16 a[178:179], v224 offset:3072
    ds_read_b64_tr_b16 a[180:181], v225 offset:2048
    ds_read_b64_tr_b16 a[182:183], v225 offset:3072
    ds_read_b64_tr_b16 a[184:185], v224 offset:4096
    ds_read_b64_tr_b16 a[186:187], v224 offset:5120
    ds_read_b64_tr_b16 a[188:189], v225 offset:4096
    ds_read_b64_tr_b16 a[190:191], v225 offset:5120
    ds_read_b64_tr_b16 a[192:193], v224 offset:6144
    ds_read_b64_tr_b16 a[194:195], v224 offset:7168
    ds_read_b64_tr_b16 a[196:197], v225 offset:6144
    ds_read_b64_tr_b16 a[198:199], v225 offset:7168
    ds_read_b64_tr_b16 a[200:201], v224 offset:8192
    ds_read_b64_tr_b16 a[202:203], v224 offset:9216
    ds_read_b64_tr_b16 a[204:205], v225 offset:8192
    ds_read_b64_tr_b16 a[206:207], v225 offset:9216
    s_waitcnt lgkmcnt(0)
    s_mul_i32 s98, s44, 10240
    s_add_u32 m0, s98, 114688
    s_add_u32 s99, s62, 1146880
    s_add_u32 s100, s62, 1153024
    s_add_u32 s101, s62, 1259520
    s_add_u32 s75, s62, 1265664
    buffer_load_dwordx4 v6, s[28:31], s99 offen offset:0 lds
    buffer_load_dwordx4 v6, s[28:31], s100 offen offset:1024 lds
    buffer_load_dwordx4 v6, s[28:31], s101 offen offset:2048 lds
    buffer_load_dwordx4 v6, s[28:31], s75 offen offset:3072 lds
    s_add_u32 m0, s98, 118784
    s_add_u32 s99, s62, 1376256
    s_add_u32 s100, s62, 1382400
    s_add_u32 s101, s62, 1488896
    s_add_u32 s75, s62, 1495040
    buffer_load_dwordx4 v6, s[28:31], s99 offen offset:0 lds
    buffer_load_dwordx4 v6, s[28:31], s100 offen offset:1024 lds
    buffer_load_dwordx4 v6, s[28:31], s101 offen offset:2048 lds
    buffer_load_dwordx4 v6, s[28:31], s75 offen offset:3072 lds
    s_add_u32 m0, s98, 122880
    s_add_u32 s99, s62, 57344
    s_add_u32 s100, s62, 63488
    buffer_load_dwordx4 v6, s[28:31], s99 offen offset:0 lds
    buffer_load_dwordx4 v6, s[28:31], s100 offen offset:1024 lds
L_l0_34:
    v_pk_fma_f32 v[64:65], v[244:245], v[160:161], v[64:65] op_sel_hi:[0,1,1] neg_lo:[1,0,0] neg_hi:[1,0,0]
    v_pk_fma_f32 v[66:67], v[244:245], v[162:163], v[66:67] op_sel_hi:[0,1,1] neg_lo:[1,0,0] neg_hi:[1,0,0]
    v_pk_fma_f32 v[68:69], v[244:245], v[164:165], v[68:69] op_sel_hi:[0,1,1] neg_lo:[1,0,0] neg_hi:[1,0,0]
    v_pk_fma_f32 v[70:71], v[244:245], v[166:167], v[70:71] op_sel_hi:[0,1,1] neg_lo:[1,0,0] neg_hi:[1,0,0]
    v_pk_mul_f32 v[192:193], v[64:65], v[64:65]
    v_pk_mul_f32 v[194:195], v[66:67], v[66:67]
    v_pk_mul_f32 v[196:197], v[68:69], v[68:69]
    v_pk_mul_f32 v[198:199], v[70:71], v[70:71]
    v_pk_fma_f32 v[192:193], v[192:193], v[248:249], v[246:247] op_sel_hi:[1,0,0]
    v_pk_fma_f32 v[194:195], v[194:195], v[248:249], v[246:247] op_sel_hi:[1,0,0]
    v_pk_fma_f32 v[196:197], v[196:197], v[248:249], v[246:247] op_sel_hi:[1,0,0]
    v_pk_fma_f32 v[198:199], v[198:199], v[248:249], v[246:247] op_sel_hi:[1,0,0]
    v_pk_mul_f32 v[192:193], v[192:193], v[64:65]
    v_pk_mul_f32 v[194:195], v[194:195], v[66:67]
    v_pk_mul_f32 v[196:197], v[196:197], v[68:69]
    v_pk_mul_f32 v[198:199], v[198:199], v[70:71]
    v_pk_fma_f32 v[72:73], v[244:245], v[168:169], v[72:73] op_sel_hi:[0,1,1] neg_lo:[1,0,0] neg_hi:[1,0,0]
    v_pk_fma_f32 v[74:75], v[244:245], v[170:171], v[74:75] op_sel_hi:[0,1,1] neg_lo:[1,0,0] neg_hi:[1,0,0]
    v_pk_fma_f32 v[76:77], v[244:245], v[172:173], v[76:77] op_sel_hi:[0,1,1] neg_lo:[1,0,0] neg_hi:[1,0,0]
    v_pk_fma_f32 v[78:79], v[244:245], v[174:175], v[78:79] op_sel_hi:[0,1,1] neg_lo:[1,0,0] neg_hi:[1,0,0]
    v_pk_mul_f32 v[200:201], v[72:73], v[72:73]
    v_pk_mul_f32 v[202:203], v[74:75], v[74:75]
    v_pk_mul_f32 v[204:205], v[76:77], v[76:77]
    v_pk_mul_f32 v[206:207], v[78:79], v[78:79]
    s_cmp_lg_u32 s44, 0
    s_cbranch_scc1 L_kick_35
    s_mov_b64 exec, s[80:81]
    buffer_load_dword a232, v3, s[40:43], s52 offen sc1
    s_mov_b64 exec, -1
L_kick_35:
    v_pk_fma_f32 v[200:201], v[200:201], v[248:249], v[246:247] op_sel_hi:[1,0,0]
    v_pk_fma_f32 v[202:203], v[202:203], v[248:249], v[246:247] op_sel_hi:[1,0,0]
    v_pk_fma_f32 v[204:205], v[204:205], v[248:249], v[246:247] op_sel_hi:[1,0,0]
    v_pk_fma_f32 v[206:207], v[206:207], v[248:249], v[246:247] op_sel_hi:[1,0,0]
    v_pk_mul_f32 v[200:201], v[200:201], v[72:73]
    v_pk_mul_f32 v[202:203], v[202:203], v[74:75]
    v_pk_mul_f32 v[204:205], v[204:205], v[76:77]
    v_pk_mul_f32 v[206:207], v[206:207], v[78:79]
    v_exp_f32 v192, v192
    v_exp_f32 v193, v193
    v_exp_f32 v194, v194
    v_exp_f32 v195, v195
    v_pk_fma_f32 v[192:193], v[192:193], v[238:239], v[238:239] op_sel_hi:[1,0,0]
    v_pk_fma_f32 v[194:195], v[194:195], v[238:239], v[238:239] op_sel_hi:[1,0,0]
    v_rcp_f32 v192, v192
    v_rcp_f32 v193, v193
    v_rcp_f32 v194, v194
    v_rcp_f32 v195, v195
    v_pk_mul_f32 v[64:65], v[64:65], v[192:193]
    v_pk_mul_f32 v[66:67], v[66:67], v[194:195]
    v_exp_f32 v196, v196
    v_exp_f32 v197, v197
    v_exp_f32 v198, v198
    v_exp_f32 v199, v199
    v_pk_fma_f32 v[196:197], v[196:197], v[238:239], v[238:239] op_sel_hi:[1,0,0]
    v_pk_fma_f32 v[198:199], v[198:199], v[238:239], v[238:239] op_sel_hi:[1,0,0]
    v_rcp_f32 v196, v196
    v_rcp_f32 v197, v197
    v_rcp_f32 v198, v198
    v_rcp_f32 v199, v199
    v_pk_mul_f32 v[68:69], v[68:69], v[196:197]
    v_pk_mul_f32 v[70:71], v[70:71], v[198:199]
    v_exp_f32 v200, v200
    v_exp_f32 v201, v201
    v_exp_f32 v202, v202
    v_exp_f32 v203, v203
    v_pk_fma_f32 v[200:201], v[200:201], v[238:239], v[238:239] op_sel_hi:[1,0,0]
    v_pk_fma_f32 v[202:203], v[202:203], v[238:239], v[238:239] op_sel_hi:[1,0,0]
    v_rcp_f32 v200, v200
    v_rcp_f32 v201, v201
    v_rcp_f32 v202, v202
    v_rcp_f32 v203, v203
    v_pk_mul_f32 v[72:73], v[72:73], v[200:201]
    v_pk_mul_f32 v[74:75], v[74:75], v[202:203]
    v_exp_f32 v204, v204
    v_exp_f32 v205, v205
    v_exp_f32 v206, v206
    v_exp_f32 v207, v207
    v_pk_fma_f32 v[204:205], v[204:205], v[238:239], v[238:239] op_sel_hi:[1,0,0]
    v_pk_fma_f32 v[206:207], v[206:207], v[238:239], v[238:239] op_sel_hi:[1,0,0]
    v_rcp_f32 v204, v204
    v_rcp_f32 v205, v205
    v_rcp_f32 v206, v206
    v_rcp_f32 v207, v207
    v_pk_mul_f32 v[76:77], v[76:77], v[204:205]
    v_pk_mul_f32 v[78:79], v[78:79], v[206:207]
    v_cvt_pk_bf16_f32 v216, v64, v65
    v_cvt_pk_bf16_f32 v217, v66, v67
    v_cvt_pk_bf16_f32 v218, v68, v69
    v_cvt_pk_bf16_f32 v219, v70, v71
    buffer_store_dwordx4 v[216:219], v2, s[40:43], s76 offen offset:2048 sc1
    v_cvt_pk_bf16_f32 v220, v72, v73
    v_cvt_pk_bf16_f32 v221, v74, v75
    v_cvt_pk_bf16_f32 v222, v76, v77
    v_cvt_pk_bf16_f32 v223, v78, v79
    buffer_store_dwordx4 v[220:223], v2, s[40:43], s76 offen offset:3072 sc1
    s_mul_i32 s98, s44, 14336
    s_add_u32 m0, s98, 8192
    s_add_u32 s99, s62, 1433600
    s_add_u32 s100, s62, 1439744
    s_add_u32 s101, s62, 1546240
    s_add_u32 s75, s62, 1552384
    buffer_load_dwordx4 v6, s[28:31], s99 offen offset:0 lds
    buffer_load_dwordx4 v6, s[28:31], s100 offen offset:1024 lds
    buffer_load_dwordx4 v6, s[28:31], s101 offen offset:2048 lds
    buffer_load_dwordx4 v6, s[28:31], s75 offen offset:3072 lds
    s_xor_b32 s78, s60, 0
    s_lshl_b32 s78, s78, 18
    s_lshr_b32 s72, s78, 8
    s_xor_b32 s72, s72, s69
    s_and_b32 s72, s72, 0x2000
    s_or_b32 s78, s78, s72
    v_add_u32 v234, s78, v2
    s_xor_b32 s78, s60, 1
    s_lshl_b32 s78, s78, 18
    s_lshr_b32 s72, s78, 8
    s_xor_b32 s72, s72, s69
    s_and_b32 s72, s72, 0x2000
    s_or_b32 s78, s78, s72
    v_add_u32 v235, s78, v2
    s_lshl_b32 s78, s44, 10
    s_add_u32 s78, s78, s48
    s_add_u32 s78, s78, 33554432
    s_cmp_lg_u32 s44, 0
    s_cbranch_scc1 L_chk_36_done
    s_mov_b64 exec, s[80:81]
    s_mov_b32 s73, 0
    s_waitcnt vmcnt(6)
L_chk_36_loop:
    v_accvgpr_read_b32 v11, a232
    v_cmp_gt_u32 vcc, s57, v11
    s_cbranch_vccz L_chk_36_out
    buffer_load_dword a232, v3, s[40:43], s52 offen sc1
    s_add_u32 s73, s73, 1
    s_cmp_lt_u32 s73, 0x20000
    s_waitcnt vmcnt(0)
    s_cbranch_scc1 L_chk_36_loop
L_chk_36_out:
    s_mov_b64 exec, -1
L_chk_36_done:
    s_barrier
    buffer_load_dwordx4 v[16:19], v234, s[40:43], s78 offen sc1
    buffer_load_dwordx4 v[20:23], v235, s[40:43], s78 offen sc1
    s_add_u32 s78, s78, 16384
    buffer_load_dwordx4 v[24:27], v234, s[40:43], s78 offen sc1
    buffer_load_dwordx4 v[28:31], v235, s[40:43], s78 offen sc1
    s_add_u32 s78, s78, 16384
    buffer_load_dwordx4 v[32:35], v234, s[40:43], s78 offen sc1
    buffer_load_dwordx4 v[36:39], v235, s[40:43], s78 offen sc1
    s_add_u32 s78, s78, 16384
    buffer_load_dwordx4 v[40:43], v234, s[40:43], s78 offen sc1
    buffer_load_dwordx4 v[44:47], v235, s[40:43], s78 offen sc1
    s_add_u32 s78, s78, 16384
    buffer_load_dwordx4 v[48:51], v234, s[40:43], s78 offen sc1
    buffer_load_dwordx4 v[52:55], v235, s[40:43], s78 offen sc1
    s_mul_i32 s74, s44, 14336
    v_add_u32 v230, s74, v2
    s_xor_b32 s74, s44, 1
    s_mul_i32 s74, s74, 14336
    v_add_u32 v231, s74, v2
    s_xor_b32 s74, s44, 2
    s_mul_i32 s74, s74, 14336
    v_add_u32 v232, s74, v2
    s_xor_b32 s74, s44, 3
    s_mul_i32 s74, s74, 14336
    v_add_u32_e64 v233, s74, v2
    v_accvgpr_read_b32 v128, a240
    v_accvgpr_read_b32 v129, a241
    v_accvgpr_read_b32 v130, a242
    v_accvgpr_read_b32 v131, a243
    v_accvgpr_read_b32 v132, a244
    v_accvgpr_read_b32 v133, a245
    v_accvgpr_read_b32 v134, a246
    v_accvgpr_read_b32 v135, a247
    v_accvgpr_read_b32 v136, a248
    v_accvgpr_read_b32 v137, a249
    v_accvgpr_read_b32 v138, a250
    v_accvgpr_read_b32 v139, a251
    v_accvgpr_read_b32 v140, a252
    v_accvgpr_read_b32 v141, a253
    v_accvgpr_read_b32 v142, a254
    v_accvgpr_read_b32 v143, a255
    s_add_u32 s57, s47, 1
    s_mul_i32 s72, s57, 14
    s_mov_b32 s81, 0
    s_cmp_eq_u32 s63, 0
    s_cselect_b32 s57, s72, s57
    s_cselect_b32 s80, 1, 0x3fff
    s_cselect_b32 s52, 20, 0x280
    s_add_u32 s52, s52, s71
    s_waitcnt vmcnt(9)
    v_mfma_f32_32x32x16_bf16 v[128:143], a[128:131], v[16:19], v[128:143]
    s_barrier
    s_cmp_lg_u32 s44, 0
    s_cbranch_scc1 L_sig_37
    s_mov_b32 s87, 0
    s_mov_b32 s86, 0x3fff
    s_cmp_eq_u32 s46, 0
    s_cselect_b32 s86, 0xf0003fff, s86
    s_mov_b64 exec, s[86:87]
    s_cmp_eq_u32 s63, 0
    s_cbranch_scc1 L_sig_37_s
    s_add_u32 s72, s47, 1
    v_mov_b32 v10, s72
    s_lshl_b32 s72, s56, 2
    s_add_u32 s72, s72, s68
    buffer_store_dword v10, v0, s[40:43], s72 offen offset:624
    s_branch L_sig_37_e
L_sig_37_s:
    buffer_atomic_add a238, v0, s[40:43], s68 offen offset:4 sc1
L_sig_37_e:
    s_mov_b64 exec, -1
L_sig_37:
    s_add_u32 s78, s78, 16384
    buffer_load_dwordx4 v[56:59], v234, s[40:43], s78 offen sc1
    buffer_load_dwordx4 v[60:63], v235, s[40:43], s78 offen sc1
    s_waitcnt vmcnt(10)
    v_mfma_f32_32x32x16_bf16 v[144:159], a[128:131], v[20:23], 0
    v_mfma_f32_32x32x16_bf16 v[160:175], a[132:135], v[16:19], 0
    v_mfma_f32_32x32x16_bf16 v[176:191], a[132:135], v[20:23], 0
    s_waitcnt vmcnt(9)
    v_mfma_f32_32x32x16_bf16 v[128:143], a[136:139], v[24:27], v[128:143]
    s_add_u32 s78, s78, 16384
    buffer_load_dwordx4 v[64:67], v234, s[40:43], s78 offen sc1
    buffer_load_dwordx4 v[68:71], v235, s[40:43], s78 offen sc1
    s_waitcnt vmcnt(10)
    v_mfma_f32_32x32x16_bf16 v[144:159], a[136:139], v[28:31], v[144:159]
    v_mfma_f32_32x32x16_bf16 v[160:175], a[140:143], v[24:27], v[160:175]
    v_mfma_f32_32x32x16_bf16 v[176:191], a[140:143], v[28:31], v[176:191]
    s_waitcnt vmcnt(9)
    v_mfma_f32_32x32x16_bf16 v[128:143], a[144:147], v[32:35], v[128:143]
    s_add_u32 s78, s78, 16384
    buffer_load_dwordx4 v[72:75], v234, s[40:43], s78 offen sc1
    buffer_load_dwordx4 v[76:79], v235, s[40:43], s78 offen sc1
    s_waitcnt vmcnt(10)
    v_mfma_f32_32x32x16_bf16 v[144:159], a[144:147], v[36:39], v[144:159]
    s_cmp_lg_u32 s44, 0
    s_cbranch_scc1 L_kick_38
    s_mov_b64 exec, s[80:81]
    buffer_load_dword a232, v3, s[40:43], s52 offen sc1
    s_mov_b64 exec, -1
L_kick_38:
    v_mfma_f32_32x32x16_bf16 v[160:175], a[148:151], v[32:35], v[160:175]
    v_mfma_f32_32x32x16_bf16 v[176:191], a[148:151], v[36:39], v[176:191]
    s_waitcnt vmcnt(9)
    v_mfma_f32_32x32x16_bf16 v[128:143], a[152:155], v[40:43], v[128:143]
    s_add_u32 s78, s78, 16384
    buffer_load_dwordx4 v[80:83], v234, s[40:43], s78 offen sc1
    buffer_load_dwordx4 v[84:87], v235, s[40:43], s78 offen sc1
    s_waitcnt vmcnt(10)
    v_mfma_f32_32x32x16_bf16 v[144:159], a[152:155], v[44:47], v[144:159]
    v_mfma_f32_32x32x16_bf16 v[160:175], a[156:159], v[40:43], v[160:175]
    v_mfma_f32_32x32x16_bf16 v[176:191], a[156:159], v[44:47], v[176:191]
    s_waitcnt vmcnt(9)
    v_mfma_f32_32x32x16_bf16 v[128:143], a[160:163], v[48:51], v[128:143]
    s_add_u32 s78, s78, 16384
    buffer_load_dwordx4 v[88:91], v234, s[40:43], s78 offen sc1
    buffer_load_dwordx4 v[92:95], v235, s[40:43], s78 offen sc1
    s_waitcnt vmcnt(10)
    v_mfma_f32_32x32x16_bf16 v[144:159], a[160:163], v[52:55], v[144:159]
    v_mfma_f32_32x32x16_bf16 v[160:175], a[164:167], v[48:51], v[160:175]
    v_mfma_f32_32x32x16_bf16 v[176:191], a[164:167], v[52:55], v[176:191]
    s_waitcnt vmcnt(9)
    v_mfma_f32_32x32x16_bf16 v[128:143], a[168:171], v[56:59], v[128:143]
    s_add_u32 s78, s78, 16384
    buffer_load_dwordx4 v[96:99], v234, s[40:43], s78 offen sc1
    buffer_load_dwordx4 v[100:103], v235, s[40:43], s78 offen sc1
    s_waitcnt vmcnt(10)
    v_mfma_f32_32x32x16_bf16 v[144:159], a[168:171], v[60:63], v[144:159]
    v_mfma_f32_32x32x16_bf16 v[160:175], a[172:175], v[56:59], v[160:175]
    v_mfma_f32_32x32x16_bf16 v[176:191], a[172:175], v[60:63], v[176:191]
    s_waitcnt vmcnt(9)
    v_mfma_f32_32x32x16_bf16 v[128:143], a[176:179], v[64:67], v[128:143]
    s_add_u32 s78, s78, 16384
    buffer_load_dwordx4 v[104:107], v234, s[40:43], s78 offen sc1
    buffer_load_dwordx4 v[108:111], v235, s[40:43], s78 offen sc1
    s_waitcnt vmcnt(10)
    v_mfma_f32_32x32x16_bf16 v[144:159], a[176:179], v[68:71], v[144:159]
    v_mfma_f32_32x32x16_bf16 v[160:175], a[180:183], v[64:67], v[160:175]
    v_mfma_f32_32x32x16_bf16 v[176:191], a[180:183], v[68:71], v[176:191]
    s_waitcnt vmcnt(9)
    v_mfma_f32_32x32x16_bf16 v[128:143], a[184:187], v[72:75], v[128:143]
    s_add_u32 s78, s78, 16384
    buffer_load_dwordx4 v[112:115], v234, s[40:43], s78 offen sc1
    buffer_load_dwordx4 v[116:119], v235, s[40:43], s78 offen sc1
    s_waitcnt vmcnt(10)
    v_mfma_f32_32x32x16_bf16 v[144:159], a[184:187], v[76:79], v[144:159]
    v_mfma_f32_32x32x16_bf16 v[160:175], a[188:191], v[72:75], v[160:175]
    ds_read_b64_tr_b16 v[208:209], v224 offset:0
    ds_read_b64_tr_b16 v[210:211], v224 offset:1024
    v_mfma_f32_32x32x16_bf16 v[176:191], a[188:191], v[76:79], v[176:191]
    ds_read_b64_tr_b16 v[212:213], v225 offset:0
    ds_read_b64_tr_b16 v[214:215], v225 offset:1024
    s_waitcnt vmcnt(9)
    v_mfma_f32_32x32x16_bf16 v[128:143], a[192:195], v[80:83], v[128:143]
    s_add_u32 s78, s78, 16384
    buffer_load_dwordx4 v[120:123], v234, s[40:43], s78 offen sc1
    buffer_load_dwordx4 v[124:127], v235, s[40:43], s78 offen sc1
    s_waitcnt vmcnt(10)
    v_mfma_f32_32x32x16_bf16 v[144:159], a[192:195], v[84:87], v[144:159]
    v_mfma_f32_32x32x16_bf16 v[160:175], a[196:199], v[80:83], v[160:175]
    ds_read_b64_tr_b16 v[216:217], v224 offset:2048
    ds_read_b64_tr_b16 v[218:219], v224 offset:3072
    v_mfma_f32_32x32x16_bf16 v[176:191], a[196:199], v[84:87], v[176:191]
    ds_read_b64_tr_b16 v[220:221], v225 offset:2048
    ds_read_b64_tr_b16 v[222:223], v225 offset:3072
    s_waitcnt vmcnt(9)
    v_mfma_f32_32x32x16_bf16 v[128:143], a[200:203], v[88:91], v[128:143]
    s_cmp_lg_u32 s44, 0
    s_cbranch_scc1 L_chk_39_done
    s_mov_b64 exec, s[80:81]
    s_mov_b32 s73, 0
    s_waitcnt vmcnt(12)
L_chk_39_loop:
    v_accvgpr_read_b32 v11, a232
    v_cmp_gt_u32 vcc, s57, v11
    s_cbranch_vccz L_chk_39_out
    buffer_load_dword a232, v3, s[40:43], s52 offen sc1
    s_add_u32 s73, s73, 1
    s_cmp_lt_u32 s73, 0x20000
    s_waitcnt vmcnt(0)
    s_cbranch_scc1 L_chk_39_loop
L_chk_39_out:
    s_mov_b64 exec, -1
L_chk_39_done:
    s_barrier
    s_sub_u32 s78, s78, 208896
    buffer_load_dwordx4 v[16:19], v234, s[40:43], s78 offen sc1
    buffer_load_dwordx4 v[20:23], v235, s[40:43], s78 offen sc1
    s_waitcnt vmcnt(10)
    v_mfma_f32_32x32x16_bf16 v[144:159], a[200:203], v[92:95], v[144:159]
    v_mfma_f32_32x32x16_bf16 v[160:175], a[204:207], v[88:91], v[160:175]
    ds_read_b64_tr_b16 v[192:193], v224 offset:4096
    ds_read_b64_tr_b16 v[194:195], v224 offset:5120
    v_mfma_f32_32x32x16_bf16 v[176:191], a[204:207], v[92:95], v[176:191]
    ds_read_b64_tr_b16 v[196:197], v225 offset:4096
    ds_read_b64_tr_b16 v[198:199], v225 offset:5120
    s_waitcnt vmcnt(9) lgkmcnt(10)
    v_mfma_f32_32x32x16_bf16 v[128:143], v[208:211], v[96:99], v[128:143]
    s_add_u32 s78, s78, 16384
    buffer_load_dwordx4 v[24:27], v234, s[40:43], s78 offen sc1
    buffer_load_dwordx4 v[28:31], v235, s[40:43], s78 offen sc1
    s_waitcnt vmcnt(10)
    v_mfma_f32_32x32x16_bf16 v[144:159], v[208:211], v[100:103], v[144:159]
    s_waitcnt lgkmcnt(8)
    v_mfma_f32_32x32x16_bf16 v[160:175], v[212:215], v[96:99], v[160:175]
    ds_read_b64_tr_b16 v[200:201], v224 offset:6144
    ds_read_b64_tr_b16 v[202:203], v224 offset:7168
    v_mfma_f32_32x32x16_bf16 v[176:191], v[212:215], v[100:103], v[176:191]
    ds_read_b64_tr_b16 v[204:205], v225 offset:6144
    ds_read_b64_tr_b16 v[206:207], v225 offset:7168
    s_waitcnt vmcnt(9) lgkmcnt(10)
    v_mfma_f32_32x32x16_bf16 v[128:143], v[216:219], v[104:107], v[128:143]
    s_add_u32 s78, s78, 16384
    buffer_load_dwordx4 v[32:35], v234, s[40:43], s78 offen sc1
    buffer_load_dwordx4 v[36:39], v235, s[40:43], s78 offen sc1
    s_waitcnt vmcnt(10)
    v_mfma_f32_32x32x16_bf16 v[144:159], v[216:219], v[108:111], v[144:159]
    s_waitcnt lgkmcnt(8)
    v_mfma_f32_32x32x16_bf16 v[160:175], v[220:223], v[104:107], v[160:175]
    ds_read_b64_tr_b16 v[208:209], v224 offset:8192
    ds_read_b64_tr_b16 v[210:211], v224 offset:9216
    v_mfma_f32_32x32x16_bf16 v[176:191], v[220:223], v[108:111], v[176:191]
    ds_read_b64_tr_b16 v[212:213], v225 offset:8192
    ds_read_b64_tr_b16 v[214:215], v225 offset:9216
    s_waitcnt vmcnt(9) lgkmcnt(10)
    v_mfma_f32_32x32x16_bf16 v[128:143], v[192:195], v[112:115], v[128:143]
    s_add_u32 s78, s78, 16384
    buffer_load_dwordx4 v[40:43], v234, s[40:43], s78 offen sc1
    buffer_load_dwordx4 v[44:47], v235, s[40:43], s78 offen sc1
    s_waitcnt vmcnt(10)
    v_mfma_f32_32x32x16_bf16 v[144:159], v[192:195], v[116:119], v[144:159]
    s_waitcnt lgkmcnt(8)
    v_mfma_f32_32x32x16_bf16 v[160:175], v[196:199], v[112:115], v[160:175]
    ds_read_b64_tr_b16 v[216:217], v226 offset:0
    ds_read_b64_tr_b16 v[218:219], v226 offset:1024
    v_mfma_f32_32x32x16_bf16 v[176:191], v[196:199], v[116:119], v[176:191]
    ds_read_b64_tr_b16 v[220:221], v227 offset:0
    ds_read_b64_tr_b16 v[222:223], v227 offset:1024
    s_waitcnt vmcnt(9) lgkmcnt(10)
    v_mfma_f32_32x32x16_bf16 v[128:143], v[200:203], v[120:123], v[128:143]
    s_add_u32 s78, s78, 16384
    buffer_load_dwordx4 v[48:51], v234, s[40:43], s78 offen sc1
    buffer_load_dwordx4 v[52:55], v235, s[40:43], s78 offen sc1
    s_waitcnt vmcnt(10)
    v_mfma_f32_32x32x16_bf16 v[144:159], v[200:203], v[124:127], v[144:159]
    s_waitcnt lgkmcnt(8)
    v_mfma_f32_32x32x16_bf16 v[160:175], v[204:207], v[120:123], v[160:175]
    ds_read_b64_tr_b16 v[192:193], v226 offset:2048
    ds_read_b64_tr_b16 v[194:195], v226 offset:3072
    v_mfma_f32_32x32x16_bf16 v[176:191], v[204:207], v[124:127], v[176:191]
    ds_read_b64_tr_b16 v[196:197], v227 offset:2048
    ds_read_b64_tr_b16 v[198:199], v227 offset:3072
    s_waitcnt vmcnt(9) lgkmcnt(10)
    v_mfma_f32_32x32x16_bf16 v[128:143], v[208:211], v[16:19], v[128:143]
    s_add_u32 s78, s78, 16384
    buffer_load_dwordx4 v[56:59], v234, s[40:43], s78 offen sc1
    buffer_load_dwordx4 v[60:63], v235, s[40:43], s78 offen sc1
    s_waitcnt vmcnt(10)
    v_mfma_f32_32x32x16_bf16 v[144:159], v[208:211], v[20:23], v[144:159]
    s_waitcnt lgkmcnt(8)
    v_mfma_f32_32x32x16_bf16 v[160:175], v[212:215], v[16:19], v[160:175]
    ds_read_b64_tr_b16 v[200:201], v226 offset:4096
    ds_read_b64_tr_b16 v[202:203], v226 offset:5120
    v_mfma_f32_32x32x16_bf16 v[176:191], v[212:215], v[20:23], v[176:191]
    ds_read_b64_tr_b16 v[204:205], v227 offset:4096
    ds_read_b64_tr_b16 v[206:207], v227 offset:5120
    s_waitcnt vmcnt(9) lgkmcnt(10)
    v_mfma_f32_32x32x16_bf16 v[128:143], v[216:219], v[24:27], v[128:143]
    s_add_u32 s78, s78, 16384
    buffer_load_dwordx4 v[64:67], v234, s[40:43], s78 offen sc1
    buffer_load_dwordx4 v[68:71], v235, s[40:43], s78 offen sc1
    s_waitcnt vmcnt(10)
    v_mfma_f32_32x32x16_bf16 v[144:159], v[216:219], v[28:31], v[144:159]
    s_waitcnt lgkmcnt(8)
    v_mfma_f32_32x32x16_bf16 v[160:175], v[220:223], v[24:27], v[160:175]
    ds_read_b64_tr_b16 v[208:209], v226 offset:6144
    ds_read_b64_tr_b16 v[210:211], v226 offset:7168
    v_mfma_f32_32x32x16_bf16 v[176:191], v[220:223], v[28:31], v[176:191]
    ds_read_b64_tr_b16 v[212:213], v227 offset:6144
    ds_read_b64_tr_b16 v[214:215], v227 offset:7168
    s_waitcnt vmcnt(9) lgkmcnt(10)
    v_mfma_f32_32x32x16_bf16 v[128:143], v[192:195], v[32:35], v[128:143]
    s_add_u32 s78, s78, 16384
    buffer_load_dwordx4 v[72:75], v234, s[40:43], s78 offen sc1
    buffer_load_dwordx4 v[76:79], v235, s[40:43], s78 offen sc1
    s_waitcnt vmcnt(10)
    v_mfma_f32_32x32x16_bf16 v[144:159], v[192:195], v[36:39], v[144:159]
    s_waitcnt lgkmcnt(8)
    v_mfma_f32_32x32x16_bf16 v[160:175], v[196:199], v[32:35], v[160:175]
    ds_read_b64_tr_b16 v[216:217], v226 offset:8192
    ds_read_b64_tr_b16 v[218:219], v226 offset:9216
    v_mfma_f32_32x32x16_bf16 v[176:191], v[196:199], v[36:39], v[176:191]
    ds_read_b64_tr_b16 v[220:221], v227 offset:8192
    ds_read_b64_tr_b16 v[222:223], v227 offset:9216
    s_waitcnt vmcnt(9) lgkmcnt(10)
    v_mfma_f32_32x32x16_bf16 v[128:143], v[200:203], v[40:43], v[128:143]
    s_add_u32 s78, s78, 16384
    buffer_load_dwordx4 v[80:83], v234, s[40:43], s78 offen sc1
    buffer_load_dwordx4 v[84:87], v235, s[40:43], s78 offen sc1
    s_waitcnt vmcnt(10)
    v_mfma_f32_32x32x16_bf16 v[144:159], v[200:203], v[44:47], v[144:159]
    s_waitcnt lgkmcnt(8)
    v_mfma_f32_32x32x16_bf16 v[160:175], v[204:207], v[40:43], v[160:175]
    ds_read_b64_tr_b16 v[192:193], v226 offset:10240
    ds_read_b64_tr_b16 v[194:195], v226 offset:11264
    v_mfma_f32_32x32x16_bf16 v[176:191], v[204:207], v[44:47], v[176:191]
    ds_read_b64_tr_b16 v[196:197], v227 offset:10240
    ds_read_b64_tr_b16 v[198:199], v227 offset:11264
    s_waitcnt vmcnt(9) lgkmcnt(10)
    v_mfma_f32_32x32x16_bf16 v[128:143], v[208:211], v[48:51], v[128:143]
    s_add_u32 s78, s78, 16384
    buffer_load_dwordx4 v[88:91], v234, s[40:43], s78 offen sc1
    buffer_load_dwordx4 v[92:95], v235, s[40:43], s78 offen sc1
    s_waitcnt vmcnt(10)
    v_mfma_f32_32x32x16_bf16 v[144:159], v[208:211], v[52:55], v[144:159]
    s_waitcnt lgkmcnt(8)
    v_mfma_f32_32x32x16_bf16 v[160:175], v[212:215], v[48:51], v[160:175]
    ds_read_b64_tr_b16 v[200:201], v226 offset:12288
    ds_read_b64_tr_b16 v[202:203], v226 offset:13312
    v_mfma_f32_32x32x16_bf16 v[176:191], v[212:215], v[52:55], v[176:191]
    ds_read_b64_tr_b16 v[204:205], v227 offset:12288
    ds_read_b64_tr_b16 v[206:207], v227 offset:13312
    s_waitcnt vmcnt(9) lgkmcnt(10)
    v_mfma_f32_32x32x16_bf16 v[128:143], v[216:219], v[56:59], v[128:143]
    s_add_u32 s78, s78, 16384
    buffer_load_dwordx4 v[96:99], v234, s[40:43], s78 offen sc1
    buffer_load_dwordx4 v[100:103], v235, s[40:43], s78 offen sc1
    s_waitcnt vmcnt(10)
    v_mfma_f32_32x32x16_bf16 v[144:159], v[216:219], v[60:63], v[144:159]
    s_waitcnt lgkmcnt(8)
    v_mfma_f32_32x32x16_bf16 v[160:175], v[220:223], v[56:59], v[160:175]
    ds_read_b64_tr_b16 v[208:209], v228 offset:0
    ds_read_b64_tr_b16 v[210:211], v228 offset:1024
    v_mfma_f32_32x32x16_bf16 v[176:191], v[220:223], v[60:63], v[176:191]
    ds_read_b64_tr_b16 v[212:213], v229 offset:0
    ds_read_b64_tr_b16 v[214:215], v229 offset:1024
    s_waitcnt vmcnt(9) lgkmcnt(10)
    v_mfma_f32_32x32x16_bf16 v[128:143], v[192:195], v[64:67], v[128:143]
    s_add_u32 s78, s78, 16384
    buffer_load_dwordx4 v[104:107], v234, s[40:43], s78 offen sc1
    buffer_load_dwordx4 v[108:111], v235, s[40:43], s78 offen sc1
    s_waitcnt vmcnt(10)
    v_mfma_f32_32x32x16_bf16 v[144:159], v[192:195], v[68:71], v[144:159]
    s_waitcnt lgkmcnt(8)
    v_mfma_f32_32x32x16_bf16 v[160:175], v[196:199], v[64:67], v[160:175]
    ds_read_b64_tr_b16 v[216:217], v228 offset:2048
    ds_read_b64_tr_b16 v[218:219], v228 offset:3072
    v_mfma_f32_32x32x16_bf16 v[176:191], v[196:199], v[68:71], v[176:191]
    ds_read_b64_tr_b16 v[220:221], v229 offset:2048
    ds_read_b64_tr_b16 v[222:223], v229 offset:3072
    s_waitcnt vmcnt(9) lgkmcnt(10)
    v_mfma_f32_32x32x16_bf16 v[128:143], v[200:203], v[72:75], v[128:143]
    s_add_u32 s78, s78, 16384
    buffer_load_dwordx4 v[112:115], v234, s[40:43], s78 offen sc1
    buffer_load_dwordx4 v[116:119], v235, s[40:43], s78 offen sc1
    s_waitcnt vmcnt(10)
    v_mfma_f32_32x32x16_bf16 v[144:159], v[200:203], v[76:79], v[144:159]
    s_waitcnt lgkmcnt(8)
    v_mfma_f32_32x32x16_bf16 v[160:175], v[204:207], v[72:75], v[160:175]
    ds_read_b64_tr_b16 v[192:193], v228 offset:4096
    ds_read_b64_tr_b16 v[194:195], v228 offset:5120
    v_mfma_f32_32x32x16_bf16 v[176:191], v[204:207], v[76:79], v[176:191]
    ds_read_b64_tr_b16 v[196:197], v229 offset:4096
    ds_read_b64_tr_b16 v[198:199], v229 offset:5120
    s_waitcnt vmcnt(9) lgkmcnt(10)
    v_mfma_f32_32x32x16_bf16 v[128:143], v[208:211], v[80:83], v[128:143]
    s_add_u32 s78, s78, 16384
    buffer_load_dwordx4 v[120:123], v234, s[40:43], s78 offen sc1
    buffer_load_dwordx4 v[124:127], v235, s[40:43], s78 offen sc1
    s_waitcnt vmcnt(10)
    v_mfma_f32_32x32x16_bf16 v[144:159], v[208:211], v[84:87], v[144:159]
    s_waitcnt lgkmcnt(8)
    v_mfma_f32_32x32x16_bf16 v[160:175], v[212:215], v[80:83], v[160:175]
    ds_read_b64_tr_b16 v[200:201], v228 offset:6144
    ds_read_b64_tr_b16 v[202:203], v228 offset:7168
    v_mfma_f32_32x32x16_bf16 v[176:191], v[212:215], v[84:87], v[176:191]
    ds_read_b64_tr_b16 v[204:205], v229 offset:6144
    ds_read_b64_tr_b16 v[206:207], v229 offset:7168
    s_waitcnt vmcnt(9) lgkmcnt(10)
    v_mfma_f32_32x32x16_bf16 v[128:143], v[216:219], v[88:91], v[128:143]
    s_waitcnt vmcnt(8)
    v_mfma_f32_32x32x16_bf16 v[144:159], v[216:219], v[92:95], v[144:159]
    s_waitcnt lgkmcnt(8)
    v_mfma_f32_32x32x16_bf16 v[160:175], v[220:223], v[88:91], v[160:175]
    ds_read_b64_tr_b16 v[208:209], v228 offset:8192
    ds_read_b64_tr_b16 v[210:211], v228 offset:9216
    v_mfma_f32_32x32x16_bf16 v[176:191], v[220:223], v[92:95], v[176:191]
    ds_read_b64_tr_b16 v[212:213], v229 offset:8192
    ds_read_b64_tr_b16 v[214:215], v229 offset:9216
    s_waitcnt vmcnt(7) lgkmcnt(10)
    v_mfma_f32_32x32x16_bf16 v[128:143], v[192:195], v[96:99], v[128:143]
    s_waitcnt vmcnt(6)
    v_mfma_f32_32x32x16_bf16 v[144:159], v[192:195], v[100:103], v[144:159]
    s_waitcnt lgkmcnt(8)
    v_mfma_f32_32x32x16_bf16 v[160:175], v[196:199], v[96:99], v[160:175]
    ds_read_b64_tr_b16 v[216:217], v228 offset:10240
    ds_read_b64_tr_b16 v[218:219], v228 offset:11264
    v_mfma_f32_32x32x16_bf16 v[176:191], v[196:199], v[100:103], v[176:191]
    ds_read_b64_tr_b16 v[220:221], v229 offset:10240
    ds_read_b64_tr_b16 v[222:223], v229 offset:11264
    s_waitcnt vmcnt(5) lgkmcnt(10)
    v_mfma_f32_32x32x16_bf16 v[128:143], v[200:203], v[104:107], v[128:143]
    s_waitcnt vmcnt(4)
    v_mfma_f32_32x32x16_bf16 v[144:159], v[200:203], v[108:111], v[144:159]
    s_waitcnt lgkmcnt(8)
    v_mfma_f32_32x32x16_bf16 v[160:175], v[204:207], v[104:107], v[160:175]
    v_mfma_f32_32x32x16_bf16 v[176:191], v[204:207], v[108:111], v[176:191]
    s_waitcnt vmcnt(3) lgkmcnt(6)
    v_mfma_f32_32x32x16_bf16 v[128:143], v[208:211], v[112:115], v[128:143]
    s_waitcnt vmcnt(2)
    v_mfma_f32_32x32x16_bf16 v[144:159], v[208:211], v[116:119], v[144:159]
    s_waitcnt lgkmcnt(4)
    v_mfma_f32_32x32x16_bf16 v[160:175], v[212:215], v[112:115], v[160:175]
    v_mfma_f32_32x32x16_bf16 v[176:191], v[212:215], v[116:119], v[176:191]
    s_waitcnt vmcnt(0) lgkmcnt(2)
    v_mfma_f32_32x32x16_bf16 v[144:159], v[216:219], v[124:127], v[144:159]
    s_waitcnt lgkmcnt(0)
    v_mfma_f32_32x32x16_bf16 v[160:175], v[220:223], v[120:123], v[160:175]
    v_mfma_f32_32x32x16_bf16 v[176:191], v[220:223], v[124:127], v[176:191]
    v_mfma_f32_32x32x16_bf16 v[128:143], v[216:219], v[120:123], v[128:143]
    s_nop 7
    ds_write_b128 v230, v[144:147] offset:0
    ds_write_b128 v230, v[148:151] offset:1024
    ds_write_b128 v230, v[152:155] offset:2048
    ds_write_b128 v230, v[156:159] offset:3072
    ds_write_b128 v230, v[160:163] offset:4096
    ds_write_b128 v230, v[164:167] offset:5120
    ds_write_b128 v230, v[168:171] offset:6144
    ds_write_b128 v230, v[172:175] offset:7168
    ds_write_b128 v230, v[176:179] offset:8192
    ds_write_b128 v230, v[180:183] offset:9216
    ds_write_b128 v230, v[184:187] offset:10240
    ds_write_b128 v230, v[188:191] offset:11264
    s_waitcnt lgkmcnt(0)
    s_barrier
    ds_read_b128 v[16:19], v231 offset:0
    ds_read_b128 v[20:23], v231 offset:1024
    ds_read_b128 v[24:27], v231 offset:2048
    ds_read_b128 v[28:31], v231 offset:3072
    ds_read_b128 v[32:35], v232 offset:4096
    ds_read_b128 v[36:39], v232 offset:5120
    ds_read_b128 v[40:43], v232 offset:6144
    ds_read_b128 v[44:47], v232 offset:7168
    ds_read_b128 v[48:51], v233 offset:8192
    ds_read_b128 v[52:55], v233 offset:9216
    ds_read_b128 v[56:59], v233 offset:10240
    ds_read_b128 v[60:63], v233 offset:11264
    s_lshl_b32 s74, s60, 16
    s_lshr_b32 s78, s54, 1
    s_lshl_b32 s78, s78, 14
    s_add_u32 s74, s74, s78
    s_and_b32 s78, s54, 1
    s_lshl_b32 s78, s78, 12
    s_add_u32 s74, s74, s78
    s_lshl_b32 s78, s58, 11
    s_add_u32 s74, s74, s78
    s_add_u32 s74, s74, s48
    s_add_u32 s74, s74, 29360128
    s_lshr_b32 s78, s74, 8
    s_xor_b32 s78, s78, s69
    s_and_b32 s78, s78, 0x2000
    s_or_b32 s74, s74, s78
    s_waitcnt lgkmcnt(11)
    v_pk_add_f32 v[128:129], v[128:129], v[16:17]
    v_pk_add_f32 v[130:131], v[130:131], v[18:19]
    s_waitcnt lgkmcnt(10)
    v_pk_add_f32 v[132:133], v[132:133], v[20:21]
    v_pk_add_f32 v[134:135], v[134:135], v[22:23]
    s_waitcnt lgkmcnt(9)
    v_pk_add_f32 v[136:137], v[136:137], v[24:25]
    v_pk_add_f32 v[138:139], v[138:139], v[26:27]
    s_waitcnt lgkmcnt(8)
    v_pk_add_f32 v[140:141], v[140:141], v[28:29]
    v_pk_add_f32 v[142:143], v[142:143], v[30:31]
    s_waitcnt lgkmcnt(7)
    v_pk_add_f32 v[128:129], v[128:129], v[32:33]
    v_pk_add_f32 v[130:131], v[130:131], v[34:35]
    s_waitcnt lgkmcnt(6)
    v_pk_add_f32 v[132:133], v[132:133], v[36:37]
    v_pk_add_f32 v[134:135], v[134:135], v[38:39]
    s_waitcnt lgkmcnt(5)
    v_pk_add_f32 v[136:137], v[136:137], v[40:41]
    v_pk_add_f32 v[138:139], v[138:139], v[42:43]
    s_waitcnt lgkmcnt(4)
    v_pk_add_f32 v[140:141], v[140:141], v[44:45]
    v_pk_add_f32 v[142:143], v[142:143], v[46:47]
    s_waitcnt lgkmcnt(3)
    v_pk_add_f32 v[128:129], v[128:129], v[48:49]
    v_pk_add_f32 v[130:131], v[130:131], v[50:51]
    s_waitcnt lgkmcnt(2)
    v_pk_add_f32 v[132:133], v[132:133], v[52:53]
    v_pk_add_f32 v[134:135], v[134:135], v[54:55]
    s_waitcnt lgkmcnt(1)
    v_pk_add_f32 v[136:137], v[136:137], v[56:57]
    v_pk_add_f32 v[138:139], v[138:139], v[58:59]
    s_waitcnt lgkmcnt(0)
    v_pk_add_f32 v[140:141], v[140:141], v[60:61]
    v_pk_add_f32 v[142:143], v[142:143], v[62:63]
    s_nop 1
    s_cmp_lg_u32 s47, 0
    s_cbranch_scc1 L_final
    v_cvt_pk_bf16_f32 v16, v128, v129
    v_cvt_pk_bf16_f32 v17, v130, v131
    v_cvt_pk_bf16_f32 v18, v132, v133
    v_cvt_pk_bf16_f32 v19, v134, v135
    buffer_store_dwordx4 v[16:19], v2, s[40:43], s74 offen offset:0 sc1
    v_cvt_pk_bf16_f32 v20, v136, v137
    v_cvt_pk_bf16_f32 v21, v138, v139
    v_cvt_pk_bf16_f32 v22, v140, v141
    v_cvt_pk_bf16_f32 v23, v142, v143
    buffer_store_dwordx4 v[20:23], v2, s[40:43], s74 offen offset:1024 sc1
    v_pk_add_f32 v[24:25], v[128:129], v[130:131]
    v_pk_mul_f32 v[26:27], v[128:129], v[128:129]
    v_pk_fma_f32 v[26:27], v[130:131], v[130:131], v[26:27]
    v_pk_fma_f32 v[26:27], v[132:133], v[132:133], v[26:27]
    v_pk_add_f32 v[24:25], v[24:25], v[132:133]
    v_pk_fma_f32 v[26:27], v[134:135], v[134:135], v[26:27]
    v_pk_add_f32 v[24:25], v[24:25], v[134:135]
    v_pk_fma_f32 v[26:27], v[136:137], v[136:137], v[26:27]
    v_pk_add_f32 v[24:25], v[24:25], v[136:137]
    v_pk_fma_f32 v[26:27], v[138:139], v[138:139], v[26:27]
    v_pk_add_f32 v[24:25], v[24:25], v[138:139]
    v_pk_fma_f32 v[26:27], v[140:141], v[140:141], v[26:27]
    v_pk_add_f32 v[24:25], v[24:25], v[140:141]
    v_pk_fma_f32 v[26:27], v[142:143], v[142:143], v[26:27]
    v_pk_add_f32 v[24:25], v[24:25], v[142:143]
    v_add_f32 v24, v24, v25
    v_add_f32 v25, v26, v27
    s_lshl_b32 s77, s60, 14
    v_mov_b32 v26, v24
    v_mov_b32 v27, v25
    s_lshl_b32 s78, s54, 9
    s_add_u32 s77, s77, s78
    v_permlane32_swap_b32 v24, v26
    v_permlane32_swap_b32 v25, v27
    s_lshl_b32 s78, s58, 8
    s_add_u32 s77, s77, s78
    v_pk_add_f32 v[24:25], v[24:25], v[26:27]
    v_lshlrev_b32_e64 v26, 3, v1
    s_add_u32 s77, s77, s48
    s_add_u32 s77, s77, 52428800
    s_lshr_b32 s78, s77, 8
    s_xor_b32 s78, s78, s69
    s_and_b32 s78, s78, 0x2000
    s_or_b32 s77, s77, s78
    s_mov_b64 exec, 0xffffffff
    buffer_store_dwordx2 v[24:25], v26, s[40:43], s77 offen sc1
    s_mov_b64 exec, -1
    s_add_u32 s57, s47, 1
    s_mul_i32 s72, s57, 14
    s_mov_b32 s81, 0
    s_cmp_eq_u32 s63, 0
    s_cselect_b32 s57, s72, s57
    s_cselect_b32 s80, 1, 0x3fff
    s_cselect_b32 s52, 24, 0x300
    s_add_u32 s52, s52, s71
    s_and_b32 s100, s44, 1
    s_lshl_b32 s100, s100, 11
    s_lshr_b32 s75, s44, 1
    s_mul_i32 s101, s75, 57344
    s_add_u32 s101, s101, s100
    s_add_u32 m0, s101, 57344
    s_lshl_b32 s75, s75, 17
    s_add_u32 s100, s100, s75
    s_lshl_b32 s75, s50, 18
    s_add_u32 s75, s75, s100
    s_add_u32 s75, s75, 138412032
    s_lshr_b32 s100, s75, 8
    s_xor_b32 s100, s100, s69
    s_and_b32 s100, s100, 0x2000
    s_or_b32 s75, s75, s100
    buffer_load_dwordx4 v2, s[40:43], s75 offen offset:0 sc1 lds
    buffer_load_dwordx4 v2, s[40:43], s75 offen offset:1024 sc1 lds
    s_add_u32 s75, s75, 4096
    s_add_u32 m0, m0, 4096
    s_nop 0
    buffer_load_dwordx4 v2, s[40:43], s75 offen offset:0 sc1 lds
    buffer_load_dwordx4 v2, s[40:43], s75 offen offset:1024 sc1 lds
    s_add_u32 s75, s75, 12288
    s_add_u32 m0, m0, 4096
    s_nop 0
    buffer_load_dwordx4 v2, s[40:43], s75 offen offset:0 sc1 lds
    buffer_load_dwordx4 v2, s[40:43], s75 offen offset:1024 sc1 lds
    s_add_u32 s75, s75, 4096
    s_add_u32 m0, m0, 4096
    s_nop 0
    buffer_load_dwordx4 v2, s[40:43], s75 offen offset:0 sc1 lds
    buffer_load_dwordx4 v2, s[40:43], s75 offen offset:1024 sc1 lds
    v_accvgpr_write_b32 a240, v128
    v_accvgpr_write_b32 a241, v129
    v_accvgpr_write_b32 a242, v130
    v_accvgpr_write_b32 a243, v131
    v_accvgpr_write_b32 a244, v132
    v_accvgpr_write_b32 a245, v133
    v_accvgpr_write_b32 a246, v134
    v_accvgpr_write_b32 a247, v135
    v_accvgpr_write_b32 a248, v136
    v_accvgpr_write_b32 a249, v137
    v_accvgpr_write_b32 a250, v138
    v_accvgpr_write_b32 a251, v139
    v_accvgpr_write_b32 a252, v140
    v_accvgpr_write_b32 a253, v141
    v_accvgpr_write_b32 a254, v142
    v_accvgpr_write_b32 a255, v143
    s_waitcnt vmcnt(8)
    s_waitcnt lgkmcnt(0)
    s_barrier
    s_cmp_lg_u32 s44, 0
    s_cbranch_scc1 L_sig_40
    s_mov_b64 exec, 0xffff
    s_cmp_eq_u32 s63, 0
    s_cbranch_scc1 L_sig_40_s
    s_add_u32 s72, s47, 1
    v_mov_b32 v10, s72
    s_lshl_b32 s72, s56, 2
    s_add_u32 s72, s72, s70
    buffer_store_dword v10, v0, s[40:43], s72 offen offset:744
    s_branch L_sig_40_e
L_sig_40_s:
    buffer_atomic_add a238, v0, s[40:43], s70 offen offset:0 sc1
L_sig_40_e:
    s_mov_b64 exec, s[80:81]
    buffer_load_dword a232, v3, s[40:43], s52 offen sc1
    s_mov_b64 exec, -1
L_sig_40:
    s_add_u32 s75, s75, 12288
    s_add_u32 m0, m0, 4096
    s_nop 0
    buffer_load_dwordx4 v2, s[40:43], s75 offen offset:0 sc1 lds
    buffer_load_dwordx4 v2, s[40:43], s75 offen offset:1024 sc1 lds
    s_add_u32 s75, s75, 4096
    s_add_u32 m0, m0, 4096
    s_nop 0
    buffer_load_dwordx4 v2, s[40:43], s75 offen offset:0 sc1 lds
    buffer_load_dwordx4 v2, s[40:43], s75 offen offset:1024 sc1 lds
    s_add_u32 s75, s75, 12288
    s_add_u32 m0, m0, 4096
    s_nop 0
    buffer_load_dwordx4 v2, s[40:43], s75 offen offset:0 sc1 lds
    buffer_load_dwordx4 v2, s[40:43], s75 offen offset:1024 sc1 lds
    s_add_u32 s76, s61, 0
    s_mov_b32 m0, 143360
    s_mov_b64 exec, 0xffffff
    buffer_load_dwordx4 v2, s[40:43], s76 offen sc1 lds
    s_mov_b64 exec, -1
    s_branch L_next
L_idle:
    s_cmp_lg_u32 s47, 0
    s_cbranch_scc1 L_finish
    s_add_u32 s57, s47, 1
    s_mul_i32 s72, s57, 1
    s_mov_b32 s81, 0
    s_cmp_eq_u32 s63, 0
    s_cselect_b32 s57, s72, s57
    s_cselect_b32 s80, 1, 0x1
    s_cselect_b32 s52, 20, 0x280
    s_add_u32 s52, s52, s71
    s_cmp_lg_u32 s44, 0
    s_cbranch_scc1 L_poll_41_done
    s_mov_b64 exec, s[80:81]
    buffer_load_dword a232, v3, s[40:43], s52 offen sc1
    s_mov_b32 s73, 0
L_poll_41_loop:
    s_waitcnt vmcnt(0)
    v_accvgpr_read_b32 v11, a232
    v_cmp_gt_u32 vcc, s57, v11
    s_cbranch_vccz L_poll_41_out
    buffer_load_dword a232, v3, s[40:43], s52 offen sc1
    s_add_u32 s73, s73, 1
    s_cmp_lt_u32 s73, 0x20000
    s_cbranch_scc1 L_poll_41_loop
L_poll_41_out:
    s_mov_b64 exec, -1
    s_waitcnt vmcnt(0) lgkmcnt(0)
    s_branch L_poll_41_b
L_poll_41_done:
    s_waitcnt vmcnt(0) lgkmcnt(0)
L_poll_41_b:
    s_barrier
    s_and_b32 s100, s44, 1
    s_lshl_b32 s100, s100, 11
    s_lshr_b32 s75, s44, 1
    s_mul_i32 s101, s75, 57344
    s_add_u32 s101, s101, s100
    s_add_u32 m0, s101, 57344
    s_lshl_b32 s75, s75, 17
    s_add_u32 s100, s100, s75
    s_lshl_b32 s75, s50, 18
    s_add_u32 s75, s75, s100
    s_add_u32 s75, s75, 138412032
    s_lshr_b32 s100, s75, 8
    s_xor_b32 s100, s100, s69
    s_and_b32 s100, s100, 0x2000
    s_or_b32 s75, s75, s100
    buffer_load_dwordx4 v2, s[40:43], s75 offen offset:0 sc1 lds
    buffer_load_dwordx4 v2, s[40:43], s75 offen offset:1024 sc1 lds
    s_add_u32 s75, s75, 4096
    s_add_u32 m0, m0, 4096
    s_nop 0
    buffer_load_dwordx4 v2, s[40:43], s75 offen offset:0 sc1 lds
    buffer_load_dwordx4 v2, s[40:43], s75 offen offset:1024 sc1 lds
    s_add_u32 s75, s75, 12288
    s_add_u32 m0, m0, 4096
    s_nop 0
    buffer_load_dwordx4 v2, s[40:43], s75 offen offset:0 sc1 lds
    buffer_load_dwordx4 v2, s[40:43], s75 offen offset:1024 sc1 lds
    s_add_u32 s75, s75, 4096
    s_add_u32 m0, m0, 4096
    s_nop 0
    buffer_load_dwordx4 v2, s[40:43], s75 offen offset:0 sc1 lds
    buffer_load_dwordx4 v2, s[40:43], s75 offen offset:1024 sc1 lds
    s_add_u32 s75, s75, 12288
    s_add_u32 m0, m0, 4096
    s_nop 0
    buffer_load_dwordx4 v2, s[40:43], s75 offen offset:0 sc1 lds
    buffer_load_dwordx4 v2, s[40:43], s75 offen offset:1024 sc1 lds
    s_add_u32 s75, s75, 4096
    s_add_u32 m0, m0, 4096
    s_nop 0
    buffer_load_dwordx4 v2, s[40:43], s75 offen offset:0 sc1 lds
    buffer_load_dwordx4 v2, s[40:43], s75 offen offset:1024 sc1 lds
    s_add_u32 s75, s75, 12288
    s_add_u32 m0, m0, 4096
    s_nop 0
    buffer_load_dwordx4 v2, s[40:43], s75 offen offset:0 sc1 lds
    buffer_load_dwordx4 v2, s[40:43], s75 offen offset:1024 sc1 lds
    s_add_u32 s76, s61, 0
    s_mov_b32 m0, 143360
    s_mov_b64 exec, 0xffffff
    buffer_load_dwordx4 v2, s[40:43], s76 offen sc1 lds
    s_mov_b64 exec, -1
    s_add_u32 s57, s47, 1
    s_mul_i32 s72, s57, 14
    s_mov_b32 s81, 0
    s_cmp_eq_u32 s63, 0
    s_cselect_b32 s57, s72, s57
    s_cselect_b32 s80, 1, 0x3fff
    s_cselect_b32 s52, 24, 0x300
    s_add_u32 s52, s52, s71
    s_cmp_lg_u32 s44, 0
    s_cbranch_scc1 L_ik_42
    s_mov_b64 exec, s[80:81]
    buffer_load_dword a232, v3, s[40:43], s52 offen sc1
    s_mov_b64 exec, -1
L_ik_42:
L_next:
    s_mov_b32 s47, 1
    s_mov_b32 s48, 71303168
    s_branch L_qkv1
L_final:
    v_cvt_pk_bf16_f32 v16, v128, v129
    v_cvt_pk_bf16_f32 v17, v130, v131
    v_cvt_pk_bf16_f32 v18, v132, v133
    v_cvt_pk_bf16_f32 v19, v134, v135
    v_cvt_pk_bf16_f32 v20, v136, v137
    v_cvt_pk_bf16_f32 v21, v138, v139
    v_cvt_pk_bf16_f32 v22, v140, v141
    v_cvt_pk_bf16_f32 v23, v142, v143
    s_lshl_b32 s74, s44, 11
    s_add_u32 s74, s74, 57344
    v_and_b32 v10, 31, v1
    v_lshlrev_b32 v10, 6, v10
    v_lshrrev_b32 v11, 5, v1
    v_lshl_add_u32 v10, v11, 3, v10
    v_bfe_u32 v11, v1, 1, 2
    v_lshl_add_u32 v10, v11, 4, v10
    v_add_u32 v10, s74, v10
    v_xor_b32 v32, 16, v10
    v_xor_b32 v33, 32, v10
    v_xor_b32 v34, 48, v10
    v_bfe_u32 v11, v1, 3, 2
    v_lshlrev_b32 v11, 4, v11
    v_xor_b32 v11, v11, v2
    v_add_u32 v11, s74, v11
    ds_write_b64 v10, v[16:17]
    ds_write_b64 v32, v[18:19]
    ds_write_b64 v33, v[20:21]
    ds_write_b64 v34, v[22:23]
    ds_read_b128 v[24:27], v11
    ds_read_b128 v[28:31], v11 offset:1024
    v_lshrrev_b32 v10, 2, v1
    v_mul_u32_u24 v10, 896, v10
    v_and_b32_e64 v11, 3, v1
    v_lshl_add_u32 v10, v11, 4, v10
    s_mul_i32 s74, s60, 28672
    s_lshl_b32 s75, s54, 7
    s_add_u32 s74, s74, s75
    s_lshl_b32 s75, s58, 6
    s_add_u32 s74, s74, s75
    s_add_u32 s75, s74, 14336
    s_waitcnt lgkmcnt(1)
    buffer_store_dwordx4 v[24:27], v10, s[32:35], s74 offen nt
    s_waitcnt lgkmcnt(0)
    buffer_store_dwordx4 v[28:31], v10, s[32:35], s75 offen nt
L_finish:
L_exit:
    s_endpgm
.section .rodata,"a"
.p2align 6
.amdhsa_kernel interleave_layers__softmax_full_mha__mixer_s_mlp__prompt_kernel
  .amdhsa_next_free_vgpr 512
  .amdhsa_next_free_sgpr 102
  .amdhsa_accum_offset 256
  .amdhsa_group_segment_fixed_size 0
  .amdhsa_kernarg_size 88
  .amdhsa_user_sgpr_count 2
  .amdhsa_user_sgpr_kernarg_segment_ptr 1
  .amdhsa_system_sgpr_workgroup_id_x 1
.end_amdhsa_kernel
```
